```python
import torch

def _softmax(x, axis=-1):
    return torch.softmax(x, dim=axis)
def _gelu(x):
    return torch.nn.functional.gelu(x, approximate="tanh")
def _silu(x):
    return torch.nn.functional.silu(x)
def _sigmoid(x):
    return torch.sigmoid(x)
def _layernorm(x, axis=-1, eps=1e-5):
    m = x.mean(dim=axis, keepdim=True)
    v = x.var(dim=axis, keepdim=True, unbiased=False)
    return (x - m) / torch.sqrt(v + eps)
def _scatter_add(tgt, idx, src, axis=0):
    return tgt.clone().index_add_(axis, idx, src)
def _segment_sum(src, seg, n):
    out = torch.zeros((n,) + src.shape[1:], dtype=src.dtype)
    return out.index_add_(0, seg, src)
def _pad(x, pw):
    flat = tuple(v for pair in reversed(pw) for v in pair)
    return torch.nn.functional.pad(x, flat)

kernel_name = 'parallel_sum__grouped_kv_mqa__dense_activation_silu__prompt'

def setup_inputs():

    _w = (lambda a: (lambda t: t.to(torch.bfloat16) if t.is_floating_point() else t)(torch.as_tensor(a)))
    def _A_setup():
        B, S, D, H = 1, 2048, 640, 32
        Dh = D // H
        return {
            "x": _w((lambda *s: torch.randn(*s, dtype=torch.bfloat16) * 0.05)(B, S, D)),
            "wq": _w((lambda *s: torch.randn(*s, dtype=torch.bfloat16) * 0.05)(D, H * Dh)),
            "wk": _w((lambda *s: torch.randn(*s, dtype=torch.bfloat16) * 0.05)(D, Dh)),
            "wv": _w((lambda *s: torch.randn(*s, dtype=torch.bfloat16) * 0.05)(D, Dh)),
            "wo": _w((lambda *s: torch.randn(*s, dtype=torch.bfloat16) * 0.05)(H * Dh, D)),
        }
    _A_in = _A_setup()

    def _B_setup():
        B, S, D, F = 1, 2048, 640, 1728
        return {
            "x": _w((lambda *s: torch.randn(*s, dtype=torch.bfloat16) * 0.05)(B, S, D)),
            "w1": _w((lambda *s: torch.randn(*s, dtype=torch.bfloat16) * 0.8)(D, F) * (D ** -0.5)),
            "w2": _w((lambda *s: torch.randn(*s, dtype=torch.bfloat16) * 0.8)(F, D) * (F ** -0.5)),
        }
    _B_in = _B_setup()

    return {
        "A_x": _A_in["x"],
        "A_wq": _A_in["wq"],
        "A_wk": _A_in["wk"],
        "A_wv": _A_in["wv"],
        "A_wo": _A_in["wo"],
        "B_x": _B_in["x"],
        "B_w1": _B_in["w1"],
        "B_w2": _B_in["w2"],
    }

def reference(A_x, A_wq, A_wk, A_wv, A_wo, B_x, B_w1, B_w2):
    def _A_ref(x, wq, wk, wv, wo):
        B, S, D = x.shape
        H = 32
        Dh = D // H
        q = (lambda x, *d: x.permute(*d))((x @ wq).reshape(B, S, H, Dh), 0, 2, 1, 3)
        k = x @ wk
        v = x @ wv
        scores = torch.einsum("bhqd,bkd->bhqk", q, k) * (Dh ** -0.5)
        p = _softmax(scores, axis=-1)
        o = torch.einsum("bhqk,bkd->bhqd", p, v)
        return (lambda x, *d: x.permute(*d))(o, 0, 2, 1, 3).reshape(B, S, H * Dh) @ wo

    def _B_ref(x, w1, w2):
        h = torch.einsum("bsd,df->bsf", x, w1)
        h = _silu(h)
        out = torch.einsum("bsf,fd->bsd", h, w2)
        return out

    x = A_x
    xn = _layernorm(x, axis=-1)
    return x + _A_ref(xn, A_wq, A_wk, A_wv, A_wo) + _B_ref(xn, B_w1, B_w2)
```

```asm
; @launch grid=(256,1,1) block=(768,1,1) lds=163840
.amdgcn_target "amdgcn-amd-amdhsa--gfx950"
.text
.globl parallel_sum__grouped_kv_mqa__dense_activation_silu__prompt_kernel
.p2align 8
.type parallel_sum__grouped_kv_mqa__dense_activation_silu__prompt_kernel,@function
parallel_sum__grouped_kv_mqa__dense_activation_silu__prompt_kernel:
    s_cmp_ge_u32 s2, 256
    s_cbranch_scc1 parallel_sum__grouped_kv_mqa__dense_activation_silu__prompt_kernel_end
    s_load_dwordx2 s[22:23], s[0:1], 0
    s_load_dwordx8 s[8:15], s[0:1], 8
    s_load_dwordx4 s[16:19], s[0:1], 48
    s_load_dwordx2 s[90:91], s[0:1], 72
    s_load_dwordx2 s[20:21], s[0:1], 80
    s_load_dwordx2 s[88:89], s[0:1], 64
    v_lshrrev_b32 v1, 6, v0
    v_and_b32 v0, 63, v0
    v_readfirstlane_b32 s3, v1
    v_lshlrev_b32 v3, 4, v0
    s_lshr_b32 s4, s2, 3
    s_and_b32 s4, s4, 7
    s_lshr_b32 s5, s2, 6
    s_lshl_b32 s5, s5, 3
    s_and_b32 s6, s2, 7
    s_add_u32 s5, s5, s6
    s_waitcnt lgkmcnt(0)
    s_cmp_ge_u32 s3, 8
    s_cbranch_scc1 parallel_sum__grouped_kv_mqa__dense_activation_silu__prompt_kernel_ffn
    s_mov_b32 s24, s22
    s_mov_b32 s25, s23
    s_mov_b32 s26, 2621440
    s_mov_b32 s27, 0x20000
    s_mov_b32 s32, s8
    s_mov_b32 s33, s9
    s_mov_b32 s34, 819200
    s_mov_b32 s35, 0x20000
    v_lshrrev_b32 v10, 4, v0
    v_and_b32 v11, 15, v0
    s_and_b32 s11, s4, 6
    s_add_u32 s11, s11, s3
    s_and_b32 s11, s11, 7
    s_lshl_b32 s8, s11, 3
    v_add_u32 v12, s8, v10
    s_lshl_b32 s9, s5, 6
    v_add_u32 v13, s9, v12
    v_mul_u32_u24 v13, 1280, v13
    v_lshl_add_u32 v13, v11, 4, v13
    s_mov_b32 s10, 0
    buffer_load_dwordx4 v[88:91], v13, s[24:27], s10 offen offset:0
    buffer_load_dwordx4 v[92:95], v13, s[24:27], s10 offen offset:256
    buffer_load_dwordx4 v[96:99], v13, s[24:27], s10 offen offset:512
    buffer_load_dwordx4 v[100:103], v13, s[24:27], s10 offen offset:768
    buffer_load_dwordx4 v[104:107], v13, s[24:27], s10 offen offset:1024
    s_mov_b32 s10, 5120
    buffer_load_dwordx4 v[108:111], v13, s[24:27], s10 offen offset:0
    buffer_load_dwordx4 v[112:115], v13, s[24:27], s10 offen offset:256
    buffer_load_dwordx4 v[116:119], v13, s[24:27], s10 offen offset:512
    buffer_load_dwordx4 v[120:123], v13, s[24:27], s10 offen offset:768
    buffer_load_dwordx4 v[124:127], v13, s[24:27], s10 offen offset:1024
    s_add_u32 s28, s20, 3145728
    s_addc_u32 s29, s21, 0
    s_mov_b32 s30, 262144
    s_mov_b32 s31, 0x20000
    s_mov_b32 s36, s20
    s_mov_b32 s37, s21
    s_mov_b32 s38, 28311552
    s_mov_b32 s39, 0x20000
    s_lshr_b32 s6, s3, 1
    s_lshl_b32 s7, s4, 2
    s_add_u32 s6, s6, s7
    s_and_b32 s7, s3, 1
    s_cmp_lt_u32 s3, 4
    s_cbranch_scc1 a_notouch_1
    s_cmp_ge_u32 s3, 6
    s_cbranch_scc1 a_touchb_2
    s_lshr_b32 s10, s5, 3
    s_mul_i32 s10, s10, 96
    s_sub_u32 s42, s3, 4
    s_lshl_b32 s42, s42, 6
    s_add_u32 s10, s10, s42
    v_add_u32 v150, s10, v0
    v_cmp_gt_u32 vcc, 192, v150
    v_add_u32 v151, 128, v150
    v_add_u32 v152, 256, v150
    v_cndmask_b32 v151, v152, v151, vcc
    v_mul_u32_u24 v151, 1280, v151
    s_mul_i32 s10, s4, 160
    s_cmp_eq_u32 s3, 5
    s_cselect_b32 exec_hi, 0, -1
    buffer_load_dword v153, v151, s[32:35], s10 offen
    buffer_load_dword v154, v151, s[32:35], s10 offen offset:128
    s_mov_b64 exec, -1
    s_branch a_notouch_1
a_touchb_2:
    s_sub_u32 s83, s2, 220
    s_cmp_ge_u32 s2, 220
    s_cselect_b32 s83, s83, s2
    s_cmp_ge_u32 s83, 180
    s_cbranch_scc1 h_j2o_3
    s_mul_hi_u32 s80, s83, 429496730
    s_mul_i32 s81, s80, 10
    s_sub_u32 s81, s83, s81
    s_mul_i32 s92, s80, 122880
    s_lshl_b32 s82, s81, 7
    s_add_u32 s92, s92, s82
    s_mul_i32 s93, s81, 221184
    s_mul_i32 s82, s80, 6144
    s_add_u32 s93, s93, s82
    s_add_u32 s93, s93, 9437184
    s_mov_b32 s94, 110592
    s_mov_b32 s95, 4
    s_movk_i32 s99, 1024
    s_branch h_j2g_4
h_j2o_3:
    s_sub_u32 s83, s83, 180
    s_mul_hi_u32 s80, s83, 429496730
    s_mul_i32 s81, s80, 10
    s_sub_u32 s81, s83, s81
    s_mul_i32 s80, s80, 5
    s_add_u32 s80, s80, 20
    s_min_u32 s80, s80, 34
    s_mul_i32 s92, s80, 20480
    s_lshl_b32 s82, s81, 7
    s_add_u32 s92, s92, s82
    s_mul_i32 s93, s81, 81920
    s_lshl_b32 s82, s80, 10
    s_add_u32 s93, s93, s82
    s_add_u32 s93, s93, 12582912
    s_mov_b32 s94, 40960
    s_mov_b32 s95, 8
    s_movk_i32 s99, 512
h_j2g_4:
    s_cmp_eq_u32 s99, 512
    s_cbranch_scc1 a_t2o_5
    s_mov_b32 s32, s18
    s_mov_b32 s33, s19
    s_mov_b32 s34, 2211840
    s_mov_b32 s35, 0x20000
    s_branch a_t2g_6
a_t2o_5:
    s_mov_b32 s32, s14
    s_mov_b32 s33, s15
    s_mov_b32 s34, 819200
    s_mov_b32 s35, 0x20000
a_t2g_6:
    s_sub_u32 s42, s3, 6
    s_mul_i32 s42, s42, 81920
    s_add_u32 s42, s42, s92
    v_mul_u32_u24 v151, 1280, v0
    s_cmp_eq_u32 s3, 7
    s_cselect_b32 exec_hi, 0, -1
    buffer_load_dword v153, v151, s[32:35], s42 offen
    s_mov_b64 exec, -1
a_notouch_1:
    s_barrier
    s_lshr_b32 s10, s11, 2
    s_mul_i32 s10, s10, 42240
    v_and_b32 v14, 31, v12
    v_lshlrev_b32 v14, 4, v14
    v_mul_u32_u24 v15, 528, v11
    v_add3_u32 v14, v14, v15, s10
    v_add_u32 v1, 84480, v3
    v_lshlrev_b32 v2, 3, v0
    v_add_u32 v2, 84480, v2
    v_mov_b32 v16, 0x3f803f80
    v_mov_b32 v17, 0
    v_mov_b32 v18, 0
    s_cmp_lt_u32 s3, 4
    s_cbranch_scc1 a_wx_7
    s_cmp_lt_u32 s3, 6
    s_cbranch_scc1 a_wx_8
    s_waitcnt vmcnt(6)
    s_branch a_wx_9
a_wx_8:
    s_waitcnt vmcnt(7)
    s_branch a_wx_9
a_wx_7:
    s_waitcnt vmcnt(5)
a_wx_9:
    v_dot2_f32_bf16 v17, v88, v16, v17
    v_dot2_f32_bf16 v18, v88, v88, v18
    v_dot2_f32_bf16 v17, v89, v16, v17
    v_dot2_f32_bf16 v18, v89, v89, v18
    v_dot2_f32_bf16 v17, v90, v16, v17
    v_dot2_f32_bf16 v18, v90, v90, v18
    v_dot2_f32_bf16 v17, v91, v16, v17
    v_dot2_f32_bf16 v18, v91, v91, v18
    v_dot2_f32_bf16 v17, v92, v16, v17
    v_dot2_f32_bf16 v18, v92, v92, v18
    v_dot2_f32_bf16 v17, v93, v16, v17
    v_dot2_f32_bf16 v18, v93, v93, v18
    v_dot2_f32_bf16 v17, v94, v16, v17
    v_dot2_f32_bf16 v18, v94, v94, v18
    v_dot2_f32_bf16 v17, v95, v16, v17
    v_dot2_f32_bf16 v18, v95, v95, v18
    v_dot2_f32_bf16 v17, v96, v16, v17
    v_dot2_f32_bf16 v18, v96, v96, v18
    v_dot2_f32_bf16 v17, v97, v16, v17
    v_dot2_f32_bf16 v18, v97, v97, v18
    v_dot2_f32_bf16 v17, v98, v16, v17
    v_dot2_f32_bf16 v18, v98, v98, v18
    v_dot2_f32_bf16 v17, v99, v16, v17
    v_dot2_f32_bf16 v18, v99, v99, v18
    v_dot2_f32_bf16 v17, v100, v16, v17
    v_dot2_f32_bf16 v18, v100, v100, v18
    v_dot2_f32_bf16 v17, v101, v16, v17
    v_dot2_f32_bf16 v18, v101, v101, v18
    v_dot2_f32_bf16 v17, v102, v16, v17
    v_dot2_f32_bf16 v18, v102, v102, v18
    v_dot2_f32_bf16 v17, v103, v16, v17
    v_dot2_f32_bf16 v18, v103, v103, v18
    v_dot2_f32_bf16 v17, v104, v16, v17
    v_dot2_f32_bf16 v18, v104, v104, v18
    v_dot2_f32_bf16 v17, v105, v16, v17
    v_dot2_f32_bf16 v18, v105, v105, v18
    v_dot2_f32_bf16 v17, v106, v16, v17
    v_dot2_f32_bf16 v18, v106, v106, v18
    v_dot2_f32_bf16 v17, v107, v16, v17
    v_dot2_f32_bf16 v18, v107, v107, v18
    s_nop 1
    v_add_f32_dpp v17, v17, v17 row_ror:8 row_mask:0xf bank_mask:0xf
    v_add_f32_dpp v18, v18, v18 row_ror:8 row_mask:0xf bank_mask:0xf
    s_nop 1
    v_add_f32_dpp v17, v17, v17 row_ror:4 row_mask:0xf bank_mask:0xf
    v_add_f32_dpp v18, v18, v18 row_ror:4 row_mask:0xf bank_mask:0xf
    s_nop 1
    v_add_f32_dpp v17, v17, v17 row_ror:2 row_mask:0xf bank_mask:0xf
    v_add_f32_dpp v18, v18, v18 row_ror:2 row_mask:0xf bank_mask:0xf
    s_nop 1
    v_add_f32_dpp v17, v17, v17 row_ror:1 row_mask:0xf bank_mask:0xf
    v_add_f32_dpp v18, v18, v18 row_ror:1 row_mask:0xf bank_mask:0xf
    s_nop 0
    v_mul_f32 v17, 0x3acccccd, v17
    v_mul_f32 v18, 0x3acccccd, v18
    v_fma_f32 v18, -v17, v17, v18
    v_max_f32 v18, 0, v18
    v_add_f32 v18, 0x3727c5ac, v18
    v_rsq_f32 v18, v18
    s_nop 0
    v_mul_f32 v18, 0x3fb8aa3b, v18
    v_mul_f32 v19, v17, v18
    v_lshlrev_b32 v20, 16, v88
    v_and_b32 v21, 0xffff0000, v88
    v_fma_f32 v20, v20, v18, -v19
    v_fma_f32 v21, v21, v18, -v19
    v_cvt_pk_bf16_f32 v88, v20, v21
    v_lshlrev_b32 v22, 16, v89
    v_and_b32 v23, 0xffff0000, v89
    v_fma_f32 v22, v22, v18, -v19
    v_fma_f32 v23, v23, v18, -v19
    v_cvt_pk_bf16_f32 v89, v22, v23
    v_lshlrev_b32 v20, 16, v90
    v_and_b32 v21, 0xffff0000, v90
    v_fma_f32 v20, v20, v18, -v19
    v_fma_f32 v21, v21, v18, -v19
    v_cvt_pk_bf16_f32 v90, v20, v21
    v_lshlrev_b32 v22, 16, v91
    v_and_b32 v23, 0xffff0000, v91
    v_fma_f32 v22, v22, v18, -v19
    v_fma_f32 v23, v23, v18, -v19
    v_cvt_pk_bf16_f32 v91, v22, v23
    ds_write_b128 v14, v[88:91] offset:0
    v_lshlrev_b32 v20, 16, v92
    v_and_b32 v21, 0xffff0000, v92
    v_fma_f32 v20, v20, v18, -v19
    v_fma_f32 v21, v21, v18, -v19
    v_cvt_pk_bf16_f32 v92, v20, v21
    v_lshlrev_b32 v22, 16, v93
    v_and_b32 v23, 0xffff0000, v93
    v_fma_f32 v22, v22, v18, -v19
    v_fma_f32 v23, v23, v18, -v19
    v_cvt_pk_bf16_f32 v93, v22, v23
    v_lshlrev_b32 v20, 16, v94
    v_and_b32 v21, 0xffff0000, v94
    v_fma_f32 v20, v20, v18, -v19
    v_fma_f32 v21, v21, v18, -v19
    v_cvt_pk_bf16_f32 v94, v20, v21
    v_lshlrev_b32 v22, 16, v95
    v_and_b32 v23, 0xffff0000, v95
    v_fma_f32 v22, v22, v18, -v19
    v_fma_f32 v23, v23, v18, -v19
    v_cvt_pk_bf16_f32 v95, v22, v23
    ds_write_b128 v14, v[92:95] offset:8448
    v_lshlrev_b32 v20, 16, v96
    v_and_b32 v21, 0xffff0000, v96
    v_fma_f32 v20, v20, v18, -v19
    v_fma_f32 v21, v21, v18, -v19
    v_cvt_pk_bf16_f32 v96, v20, v21
    v_lshlrev_b32 v22, 16, v97
    v_and_b32 v23, 0xffff0000, v97
    v_fma_f32 v22, v22, v18, -v19
    v_fma_f32 v23, v23, v18, -v19
    v_cvt_pk_bf16_f32 v97, v22, v23
    v_lshlrev_b32 v20, 16, v98
    v_and_b32 v21, 0xffff0000, v98
    v_fma_f32 v20, v20, v18, -v19
    v_fma_f32 v21, v21, v18, -v19
    v_cvt_pk_bf16_f32 v98, v20, v21
    v_lshlrev_b32 v22, 16, v99
    v_and_b32 v23, 0xffff0000, v99
    v_fma_f32 v22, v22, v18, -v19
    v_fma_f32 v23, v23, v18, -v19
    v_cvt_pk_bf16_f32 v99, v22, v23
    ds_write_b128 v14, v[96:99] offset:16896
    v_lshlrev_b32 v20, 16, v100
    v_and_b32 v21, 0xffff0000, v100
    v_fma_f32 v20, v20, v18, -v19
    v_fma_f32 v21, v21, v18, -v19
    v_cvt_pk_bf16_f32 v100, v20, v21
    v_lshlrev_b32 v22, 16, v101
    v_and_b32 v23, 0xffff0000, v101
    v_fma_f32 v22, v22, v18, -v19
    v_fma_f32 v23, v23, v18, -v19
    v_cvt_pk_bf16_f32 v101, v22, v23
    v_lshlrev_b32 v20, 16, v102
    v_and_b32 v21, 0xffff0000, v102
    v_fma_f32 v20, v20, v18, -v19
    v_fma_f32 v21, v21, v18, -v19
    v_cvt_pk_bf16_f32 v102, v20, v21
    v_lshlrev_b32 v22, 16, v103
    v_and_b32 v23, 0xffff0000, v103
    v_fma_f32 v22, v22, v18, -v19
    v_fma_f32 v23, v23, v18, -v19
    v_cvt_pk_bf16_f32 v103, v22, v23
    ds_write_b128 v14, v[100:103] offset:25344
    v_lshlrev_b32 v20, 16, v104
    v_and_b32 v21, 0xffff0000, v104
    v_fma_f32 v20, v20, v18, -v19
    v_fma_f32 v21, v21, v18, -v19
    v_cvt_pk_bf16_f32 v104, v20, v21
    v_lshlrev_b32 v22, 16, v105
    v_and_b32 v23, 0xffff0000, v105
    v_fma_f32 v22, v22, v18, -v19
    v_fma_f32 v23, v23, v18, -v19
    v_cvt_pk_bf16_f32 v105, v22, v23
    v_lshlrev_b32 v20, 16, v106
    v_and_b32 v21, 0xffff0000, v106
    v_fma_f32 v20, v20, v18, -v19
    v_fma_f32 v21, v21, v18, -v19
    v_cvt_pk_bf16_f32 v106, v20, v21
    v_lshlrev_b32 v22, 16, v107
    v_and_b32 v23, 0xffff0000, v107
    v_fma_f32 v22, v22, v18, -v19
    v_fma_f32 v23, v23, v18, -v19
    v_cvt_pk_bf16_f32 v107, v22, v23
    ds_write_b128 v14, v[104:107] offset:33792
    v_mov_b32 v17, 0
    v_mov_b32 v18, 0
    s_cmp_lt_u32 s3, 4
    s_cbranch_scc1 a_wx_10
    s_cmp_lt_u32 s3, 6
    s_cbranch_scc1 a_wx_11
    s_waitcnt vmcnt(1)
    s_branch a_wx_12
a_wx_11:
    s_waitcnt vmcnt(2)
    s_branch a_wx_12
a_wx_10:
    s_waitcnt vmcnt(0)
a_wx_12:
    v_dot2_f32_bf16 v17, v108, v16, v17
    v_dot2_f32_bf16 v18, v108, v108, v18
    v_dot2_f32_bf16 v17, v109, v16, v17
    v_dot2_f32_bf16 v18, v109, v109, v18
    v_dot2_f32_bf16 v17, v110, v16, v17
    v_dot2_f32_bf16 v18, v110, v110, v18
    v_dot2_f32_bf16 v17, v111, v16, v17
    v_dot2_f32_bf16 v18, v111, v111, v18
    v_dot2_f32_bf16 v17, v112, v16, v17
    v_dot2_f32_bf16 v18, v112, v112, v18
    v_dot2_f32_bf16 v17, v113, v16, v17
    v_dot2_f32_bf16 v18, v113, v113, v18
    v_dot2_f32_bf16 v17, v114, v16, v17
    v_dot2_f32_bf16 v18, v114, v114, v18
    v_dot2_f32_bf16 v17, v115, v16, v17
    v_dot2_f32_bf16 v18, v115, v115, v18
    v_dot2_f32_bf16 v17, v116, v16, v17
    v_dot2_f32_bf16 v18, v116, v116, v18
    v_dot2_f32_bf16 v17, v117, v16, v17
    v_dot2_f32_bf16 v18, v117, v117, v18
    v_dot2_f32_bf16 v17, v118, v16, v17
    v_dot2_f32_bf16 v18, v118, v118, v18
    v_dot2_f32_bf16 v17, v119, v16, v17
    v_dot2_f32_bf16 v18, v119, v119, v18
    v_dot2_f32_bf16 v17, v120, v16, v17
    v_dot2_f32_bf16 v18, v120, v120, v18
    v_dot2_f32_bf16 v17, v121, v16, v17
    v_dot2_f32_bf16 v18, v121, v121, v18
    v_dot2_f32_bf16 v17, v122, v16, v17
    v_dot2_f32_bf16 v18, v122, v122, v18
    v_dot2_f32_bf16 v17, v123, v16, v17
    v_dot2_f32_bf16 v18, v123, v123, v18
    v_dot2_f32_bf16 v17, v124, v16, v17
    v_dot2_f32_bf16 v18, v124, v124, v18
    v_dot2_f32_bf16 v17, v125, v16, v17
    v_dot2_f32_bf16 v18, v125, v125, v18
    v_dot2_f32_bf16 v17, v126, v16, v17
    v_dot2_f32_bf16 v18, v126, v126, v18
    v_dot2_f32_bf16 v17, v127, v16, v17
    v_dot2_f32_bf16 v18, v127, v127, v18
    s_nop 1
    v_add_f32_dpp v17, v17, v17 row_ror:8 row_mask:0xf bank_mask:0xf
    v_add_f32_dpp v18, v18, v18 row_ror:8 row_mask:0xf bank_mask:0xf
    s_nop 1
    v_add_f32_dpp v17, v17, v17 row_ror:4 row_mask:0xf bank_mask:0xf
    v_add_f32_dpp v18, v18, v18 row_ror:4 row_mask:0xf bank_mask:0xf
    s_nop 1
    v_add_f32_dpp v17, v17, v17 row_ror:2 row_mask:0xf bank_mask:0xf
    v_add_f32_dpp v18, v18, v18 row_ror:2 row_mask:0xf bank_mask:0xf
    s_nop 1
    v_add_f32_dpp v17, v17, v17 row_ror:1 row_mask:0xf bank_mask:0xf
    v_add_f32_dpp v18, v18, v18 row_ror:1 row_mask:0xf bank_mask:0xf
    s_nop 0
    v_mul_f32 v17, 0x3acccccd, v17
    v_mul_f32 v18, 0x3acccccd, v18
    v_fma_f32 v18, -v17, v17, v18
    v_max_f32 v18, 0, v18
    v_add_f32 v18, 0x3727c5ac, v18
    v_rsq_f32 v18, v18
    s_nop 0
    v_mul_f32 v18, 0x3fb8aa3b, v18
    v_mul_f32 v19, v17, v18
    v_lshlrev_b32 v20, 16, v108
    v_and_b32 v21, 0xffff0000, v108
    v_fma_f32 v20, v20, v18, -v19
    v_fma_f32 v21, v21, v18, -v19
    v_cvt_pk_bf16_f32 v108, v20, v21
    v_lshlrev_b32 v22, 16, v109
    v_and_b32 v23, 0xffff0000, v109
    v_fma_f32 v22, v22, v18, -v19
    v_fma_f32 v23, v23, v18, -v19
    v_cvt_pk_bf16_f32 v109, v22, v23
    v_lshlrev_b32 v20, 16, v110
    v_and_b32 v21, 0xffff0000, v110
    v_fma_f32 v20, v20, v18, -v19
    v_fma_f32 v21, v21, v18, -v19
    v_cvt_pk_bf16_f32 v110, v20, v21
    v_lshlrev_b32 v22, 16, v111
    v_and_b32 v23, 0xffff0000, v111
    v_fma_f32 v22, v22, v18, -v19
    v_fma_f32 v23, v23, v18, -v19
    v_cvt_pk_bf16_f32 v111, v22, v23
    ds_write_b128 v14, v[108:111] offset:64
    v_lshlrev_b32 v20, 16, v112
    v_and_b32 v21, 0xffff0000, v112
    v_fma_f32 v20, v20, v18, -v19
    v_fma_f32 v21, v21, v18, -v19
    v_cvt_pk_bf16_f32 v112, v20, v21
    v_lshlrev_b32 v22, 16, v113
    v_and_b32 v23, 0xffff0000, v113
    v_fma_f32 v22, v22, v18, -v19
    v_fma_f32 v23, v23, v18, -v19
    v_cvt_pk_bf16_f32 v113, v22, v23
    v_lshlrev_b32 v20, 16, v114
    v_and_b32 v21, 0xffff0000, v114
    v_fma_f32 v20, v20, v18, -v19
    v_fma_f32 v21, v21, v18, -v19
    v_cvt_pk_bf16_f32 v114, v20, v21
    v_lshlrev_b32 v22, 16, v115
    v_and_b32 v23, 0xffff0000, v115
    v_fma_f32 v22, v22, v18, -v19
    v_fma_f32 v23, v23, v18, -v19
    v_cvt_pk_bf16_f32 v115, v22, v23
    ds_write_b128 v14, v[112:115] offset:8512
    v_lshlrev_b32 v20, 16, v116
    v_and_b32 v21, 0xffff0000, v116
    v_fma_f32 v20, v20, v18, -v19
    v_fma_f32 v21, v21, v18, -v19
    v_cvt_pk_bf16_f32 v116, v20, v21
    v_lshlrev_b32 v22, 16, v117
    v_and_b32 v23, 0xffff0000, v117
    v_fma_f32 v22, v22, v18, -v19
    v_fma_f32 v23, v23, v18, -v19
    v_cvt_pk_bf16_f32 v117, v22, v23
    v_lshlrev_b32 v20, 16, v118
    v_and_b32 v21, 0xffff0000, v118
    v_fma_f32 v20, v20, v18, -v19
    v_fma_f32 v21, v21, v18, -v19
    v_cvt_pk_bf16_f32 v118, v20, v21
    v_lshlrev_b32 v22, 16, v119
    v_and_b32 v23, 0xffff0000, v119
    v_fma_f32 v22, v22, v18, -v19
    v_fma_f32 v23, v23, v18, -v19
    v_cvt_pk_bf16_f32 v119, v22, v23
    ds_write_b128 v14, v[116:119] offset:16960
    v_lshlrev_b32 v20, 16, v120
    v_and_b32 v21, 0xffff0000, v120
    v_fma_f32 v20, v20, v18, -v19
    v_fma_f32 v21, v21, v18, -v19
    v_cvt_pk_bf16_f32 v120, v20, v21
    v_lshlrev_b32 v22, 16, v121
    v_and_b32 v23, 0xffff0000, v121
    v_fma_f32 v22, v22, v18, -v19
    v_fma_f32 v23, v23, v18, -v19
    v_cvt_pk_bf16_f32 v121, v22, v23
    v_lshlrev_b32 v20, 16, v122
    v_and_b32 v21, 0xffff0000, v122
    v_fma_f32 v20, v20, v18, -v19
    v_fma_f32 v21, v21, v18, -v19
    v_cvt_pk_bf16_f32 v122, v20, v21
    v_lshlrev_b32 v22, 16, v123
    v_and_b32 v23, 0xffff0000, v123
    v_fma_f32 v22, v22, v18, -v19
    v_fma_f32 v23, v23, v18, -v19
    v_cvt_pk_bf16_f32 v123, v22, v23
    ds_write_b128 v14, v[120:123] offset:25408
    v_lshlrev_b32 v20, 16, v124
    v_and_b32 v21, 0xffff0000, v124
    v_fma_f32 v20, v20, v18, -v19
    v_fma_f32 v21, v21, v18, -v19
    v_cvt_pk_bf16_f32 v124, v20, v21
    v_lshlrev_b32 v22, 16, v125
    v_and_b32 v23, 0xffff0000, v125
    v_fma_f32 v22, v22, v18, -v19
    v_fma_f32 v23, v23, v18, -v19
    v_cvt_pk_bf16_f32 v125, v22, v23
    v_lshlrev_b32 v20, 16, v126
    v_and_b32 v21, 0xffff0000, v126
    v_fma_f32 v20, v20, v18, -v19
    v_fma_f32 v21, v21, v18, -v19
    v_cvt_pk_bf16_f32 v126, v20, v21
    v_lshlrev_b32 v22, 16, v127
    v_and_b32 v23, 0xffff0000, v127
    v_fma_f32 v22, v22, v18, -v19
    v_fma_f32 v23, v23, v18, -v19
    v_cvt_pk_bf16_f32 v127, v22, v23
    ds_write_b128 v14, v[124:127] offset:33856
    v_mov_b32 v20, 163816
    v_mov_b32 v22, 0
    v_mov_b32 v23, 0
    ds_write_b64 v20, v[22:23]
    s_waitcnt lgkmcnt(0)
    s_barrier
    v_lshrrev_b32 v16, 5, v0
    v_and_b32 v17, 31, v0
    v_mul_u32_u24 v10, 528, v16
    v_lshl_add_u32 v10, v17, 4, v10
    s_mul_i32 s10, s7, 21120
    v_add_u32 v10, s10, v10
    v_add_u32 v11, 42240, v10
    v_and_b32 v17, 15, v0
    v_lshrrev_b32 v18, 2, v17
    v_lshl_add_u32 v18, v16, 3, v18
    s_lshl_b32 s10, s7, 6
    v_add_u32 v18, s10, v18
    v_mul_u32_u24 v18, 160, v18
    v_bfe_u32 v19, v0, 4, 1
    v_lshl_add_u32 v18, v19, 5, v18
    v_and_b32 v19, 3, v17
    v_lshl_add_u32 v18, v19, 3, v18
    s_lshr_b32 s10, s3, 1
    s_mul_i32 s10, s10, 40
    v_add_u32 v18, s10, v18
    v_add_u32 v12, 110080, v18
    v_add_u32 v13, 130560, v18
    v_add_u32 v14, 84480, v18
    ds_read_b128 v[104:107], v10 offset:0
    ds_read_b128 v[108:111], v11 offset:0
    ds_read_b128 v[112:115], v10 offset:1056
    ds_read_b128 v[116:119], v11 offset:1056
    ds_read_b128 v[120:123], v10 offset:2112
    ds_read_b128 v[124:127], v11 offset:2112
    ds_read_b128 v[128:131], v10 offset:3168
    ds_read_b128 v[132:135], v11 offset:3168
    ds_read_b64_tr_b16 v[88:89], v12 offset:0
    ds_read_b64_tr_b16 v[90:91], v12 offset:640
    ds_read_b64_tr_b16 v[92:93], v12 offset:2560
    ds_read_b64_tr_b16 v[94:95], v12 offset:3200
    ds_read_b64_tr_b16 v[96:97], v12 offset:5120
    ds_read_b64_tr_b16 v[98:99], v12 offset:5760
    ds_read_b64_tr_b16 v[100:101], v12 offset:7680
    ds_read_b64_tr_b16 v[102:103], v12 offset:8320
    s_waitcnt lgkmcnt(6)
    v_mfma_f32_32x32x16_bf16 v[32:47], v[88:91], v[104:107], 0
    v_mfma_f32_32x32x16_bf16 v[48:63], v[88:91], v[108:111], 0
    ds_read_b128 v[136:139], v10 offset:4224
    ds_read_b128 v[140:143], v11 offset:4224
    ds_read_b128 v[144:147], v10 offset:5280
    ds_read_b128 v[148:151], v11 offset:5280
    ds_read_b128 v[152:155], v10 offset:6336
    ds_read_b128 v[156:159], v11 offset:6336
    ds_read_b128 v[160:163], v10 offset:7392
    ds_read_b128 v[164:167], v11 offset:7392
    s_waitcnt lgkmcnt(12)
    v_mfma_f32_32x32x16_bf16 v[32:47], v[92:95], v[112:115], v[32:47]
    v_mfma_f32_32x32x16_bf16 v[48:63], v[92:95], v[116:119], v[48:63]
    s_waitcnt lgkmcnt(10)
    v_mfma_f32_32x32x16_bf16 v[32:47], v[96:99], v[120:123], v[32:47]
    v_mfma_f32_32x32x16_bf16 v[48:63], v[96:99], v[124:127], v[48:63]
    s_waitcnt lgkmcnt(8)
    v_mfma_f32_32x32x16_bf16 v[32:47], v[100:103], v[128:131], v[32:47]
    v_mfma_f32_32x32x16_bf16 v[48:63], v[100:103], v[132:135], v[48:63]
    s_waitcnt lgkmcnt(0)
    s_barrier
    ds_read_b64_tr_b16 v[88:89], v13 offset:0
    ds_read_b64_tr_b16 v[90:91], v13 offset:640
    ds_read_b64_tr_b16 v[92:93], v13 offset:2560
    ds_read_b64_tr_b16 v[94:95], v13 offset:3200
    ds_read_b64_tr_b16 v[96:97], v13 offset:5120
    ds_read_b64_tr_b16 v[98:99], v13 offset:5760
    ds_read_b64_tr_b16 v[100:101], v13 offset:7680
    ds_read_b64_tr_b16 v[102:103], v13 offset:8320
    s_waitcnt lgkmcnt(6)
    v_mfma_f32_32x32x16_bf16 v[32:47], v[88:91], v[136:139], v[32:47]
    v_mfma_f32_32x32x16_bf16 v[48:63], v[88:91], v[140:143], v[48:63]
    ds_read_b128 v[104:107], v10 offset:8448
    ds_read_b128 v[108:111], v11 offset:8448
    ds_read_b128 v[112:115], v10 offset:9504
    ds_read_b128 v[116:119], v11 offset:9504
    ds_read_b128 v[120:123], v10 offset:10560
    ds_read_b128 v[124:127], v11 offset:10560
    ds_read_b128 v[128:131], v10 offset:11616
    ds_read_b128 v[132:135], v11 offset:11616
    s_waitcnt lgkmcnt(12)
    v_mfma_f32_32x32x16_bf16 v[32:47], v[92:95], v[144:147], v[32:47]
    v_mfma_f32_32x32x16_bf16 v[48:63], v[92:95], v[148:151], v[48:63]
    s_waitcnt lgkmcnt(10)
    v_mfma_f32_32x32x16_bf16 v[32:47], v[96:99], v[152:155], v[32:47]
    v_mfma_f32_32x32x16_bf16 v[48:63], v[96:99], v[156:159], v[48:63]
    s_waitcnt lgkmcnt(8)
    v_mfma_f32_32x32x16_bf16 v[32:47], v[100:103], v[160:163], v[32:47]
    v_mfma_f32_32x32x16_bf16 v[48:63], v[100:103], v[164:167], v[48:63]
    s_waitcnt lgkmcnt(0)
    s_barrier
    ds_read_b64_tr_b16 v[88:89], v12 offset:0
    ds_read_b64_tr_b16 v[90:91], v12 offset:640
    ds_read_b64_tr_b16 v[92:93], v12 offset:2560
    ds_read_b64_tr_b16 v[94:95], v12 offset:3200
    ds_read_b64_tr_b16 v[96:97], v12 offset:5120
    ds_read_b64_tr_b16 v[98:99], v12 offset:5760
    ds_read_b64_tr_b16 v[100:101], v12 offset:7680
    ds_read_b64_tr_b16 v[102:103], v12 offset:8320
    s_waitcnt lgkmcnt(6)
    v_mfma_f32_32x32x16_bf16 v[32:47], v[88:91], v[104:107], v[32:47]
    v_mfma_f32_32x32x16_bf16 v[48:63], v[88:91], v[108:111], v[48:63]
    ds_read_b128 v[136:139], v10 offset:12672
    ds_read_b128 v[140:143], v11 offset:12672
    ds_read_b128 v[144:147], v10 offset:13728
    ds_read_b128 v[148:151], v11 offset:13728
    ds_read_b128 v[152:155], v10 offset:14784
    ds_read_b128 v[156:159], v11 offset:14784
    ds_read_b128 v[160:163], v10 offset:15840
    ds_read_b128 v[164:167], v11 offset:15840
    s_waitcnt lgkmcnt(12)
    v_mfma_f32_32x32x16_bf16 v[32:47], v[92:95], v[112:115], v[32:47]
    v_mfma_f32_32x32x16_bf16 v[48:63], v[92:95], v[116:119], v[48:63]
    s_waitcnt lgkmcnt(10)
    v_mfma_f32_32x32x16_bf16 v[32:47], v[96:99], v[120:123], v[32:47]
    v_mfma_f32_32x32x16_bf16 v[48:63], v[96:99], v[124:127], v[48:63]
    s_waitcnt lgkmcnt(8)
    v_mfma_f32_32x32x16_bf16 v[32:47], v[100:103], v[128:131], v[32:47]
    v_mfma_f32_32x32x16_bf16 v[48:63], v[100:103], v[132:135], v[48:63]
    s_waitcnt lgkmcnt(0)
    s_barrier
    ds_read_b64_tr_b16 v[88:89], v14 offset:0
    ds_read_b64_tr_b16 v[90:91], v14 offset:640
    ds_read_b64_tr_b16 v[92:93], v14 offset:2560
    ds_read_b64_tr_b16 v[94:95], v14 offset:3200
    ds_read_b64_tr_b16 v[96:97], v14 offset:5120
    ds_read_b64_tr_b16 v[98:99], v14 offset:5760
    ds_read_b64_tr_b16 v[100:101], v14 offset:7680
    ds_read_b64_tr_b16 v[102:103], v14 offset:8320
    s_waitcnt lgkmcnt(6)
    v_mfma_f32_32x32x16_bf16 v[32:47], v[88:91], v[136:139], v[32:47]
    v_mfma_f32_32x32x16_bf16 v[48:63], v[88:91], v[140:143], v[48:63]
    ds_read_b128 v[104:107], v10 offset:16896
    ds_read_b128 v[108:111], v11 offset:16896
    ds_read_b128 v[112:115], v10 offset:17952
    ds_read_b128 v[116:119], v11 offset:17952
    ds_read_b128 v[120:123], v10 offset:19008
    ds_read_b128 v[124:127], v11 offset:19008
    ds_read_b128 v[128:131], v10 offset:20064
    ds_read_b128 v[132:135], v11 offset:20064
    s_waitcnt lgkmcnt(12)
    v_mfma_f32_32x32x16_bf16 v[32:47], v[92:95], v[144:147], v[32:47]
    v_mfma_f32_32x32x16_bf16 v[48:63], v[92:95], v[148:151], v[48:63]
    s_waitcnt lgkmcnt(10)
    v_mfma_f32_32x32x16_bf16 v[32:47], v[96:99], v[152:155], v[32:47]
    v_mfma_f32_32x32x16_bf16 v[48:63], v[96:99], v[156:159], v[48:63]
    s_waitcnt lgkmcnt(8)
    v_mfma_f32_32x32x16_bf16 v[32:47], v[100:103], v[160:163], v[32:47]
    v_mfma_f32_32x32x16_bf16 v[48:63], v[100:103], v[164:167], v[48:63]
    s_waitcnt lgkmcnt(0)
    s_barrier
    ds_read_b64_tr_b16 v[88:89], v13 offset:0
    ds_read_b64_tr_b16 v[90:91], v13 offset:640
    ds_read_b64_tr_b16 v[92:93], v13 offset:2560
    ds_read_b64_tr_b16 v[94:95], v13 offset:3200
    ds_read_b64_tr_b16 v[96:97], v13 offset:5120
    ds_read_b64_tr_b16 v[98:99], v13 offset:5760
    ds_read_b64_tr_b16 v[100:101], v13 offset:7680
    ds_read_b64_tr_b16 v[102:103], v13 offset:8320
    s_waitcnt lgkmcnt(6)
    v_mfma_f32_32x32x16_bf16 v[32:47], v[88:91], v[104:107], v[32:47]
    v_mfma_f32_32x32x16_bf16 v[48:63], v[88:91], v[108:111], v[48:63]
    s_waitcnt lgkmcnt(4)
    v_mfma_f32_32x32x16_bf16 v[32:47], v[92:95], v[112:115], v[32:47]
    v_mfma_f32_32x32x16_bf16 v[48:63], v[92:95], v[116:119], v[48:63]
    s_waitcnt lgkmcnt(2)
    v_mfma_f32_32x32x16_bf16 v[32:47], v[96:99], v[120:123], v[32:47]
    v_mfma_f32_32x32x16_bf16 v[48:63], v[96:99], v[124:127], v[48:63]
    s_waitcnt lgkmcnt(0)
    v_mfma_f32_32x32x16_bf16 v[32:47], v[100:103], v[128:131], v[32:47]
    v_mfma_f32_32x32x16_bf16 v[48:63], v[100:103], v[132:135], v[48:63]
    s_mul_i32 s44, s3, 3072
    s_add_u32 s44, s44, 84480
    v_add_u32 v12, s44, v3
    s_xor_b32 s45, s3, 1
    s_mul_i32 s45, s45, 3072
    s_add_u32 s45, s45, 84480
    v_add_u32 v13, s45, v3
    s_nop 7
    s_cmp_eq_u32 s7, 1
    s_cbranch_scc1 qx1_13
    ds_write_b128 v12, v[48:51] offset:0
    ds_write_b128 v12, v[52:55] offset:1024
    ds_write_b128 v12, v[56:59] offset:2048
    s_branch qxd_14
qx1_13:
    ds_write_b128 v12, v[32:35] offset:0
    ds_write_b128 v12, v[36:39] offset:1024
    ds_write_b128 v12, v[40:43] offset:2048
    s_waitcnt lgkmcnt(0)
    v_mov_b32 v32, v48
    v_mov_b32 v33, v49
    v_mov_b32 v34, v50
    v_mov_b32 v35, v51
    v_mov_b32 v36, v52
    v_mov_b32 v37, v53
    v_mov_b32 v38, v54
    v_mov_b32 v39, v55
    v_mov_b32 v40, v56
    v_mov_b32 v41, v57
    v_mov_b32 v42, v58
    v_mov_b32 v43, v59
qxd_14:
    s_waitcnt lgkmcnt(0)
    s_barrier
    s_cmp_lg_u32 s3, 0
    s_cbranch_scc1 a_g0_15
    s_mov_b32 s43, 3801088
    buffer_load_dwordx4 v[140:143], v3, s[36:39], s43 offen sc1
    buffer_load_dwordx4 v[144:147], v3, s[36:39], s43 offen offset:1024 sc1
a_g0_15:
    ds_read_b128 v[48:51], v13 offset:0
    ds_read_b128 v[52:55], v13 offset:1024
    ds_read_b128 v[56:59], v13 offset:2048
    v_cmp_gt_u32 vcc, 32, v0
    s_waitcnt lgkmcnt(0)
    v_add_f32 v32, v32, v48
    v_add_f32 v33, v33, v49
    v_add_f32 v34, v34, v50
    v_add_f32 v35, v35, v51
    v_add_f32 v36, v36, v52
    v_add_f32 v37, v37, v53
    v_add_f32 v38, v38, v54
    v_add_f32 v39, v39, v55
    v_add_f32 v40, v40, v56
    v_add_f32 v41, v41, v57
    v_add_f32 v42, v42, v58
    v_add_f32 v43, v43, v59
    v_cndmask_b32 v40, 0, v40, vcc
    v_cndmask_b32 v41, 0, v41, vcc
    v_cndmask_b32 v42, 0, v42, vcc
    v_cndmask_b32 v43, 0, v43, vcc
    s_mov_b32 s45, 0x3e64f92e
    v_mul_f32 v32, s45, v32
    v_mul_f32 v33, s45, v33
    v_mul_f32 v34, s45, v34
    v_mul_f32 v35, s45, v35
    v_mul_f32 v36, s45, v36
    v_mul_f32 v37, s45, v37
    v_mul_f32 v38, s45, v38
    v_mul_f32 v39, s45, v39
    v_mul_f32 v40, s45, v40
    v_mul_f32 v41, s45, v41
    v_mul_f32 v42, s45, v42
    v_mul_f32 v43, s45, v43
    v_mul_f32 v136, v32, v32
    v_fmac_f32 v136, v33, v33
    v_fmac_f32 v136, v34, v34
    v_fmac_f32 v136, v35, v35
    v_fmac_f32 v136, v36, v36
    v_fmac_f32 v136, v37, v37
    v_fmac_f32 v136, v38, v38
    v_fmac_f32 v136, v39, v39
    v_fmac_f32 v136, v40, v40
    v_fmac_f32 v136, v41, v41
    v_fmac_f32 v136, v42, v42
    v_fmac_f32 v136, v43, v43
    v_cvt_pk_bf16_f32 v4, v32, v33
    v_cvt_pk_bf16_f32 v5, v34, v35
    v_cvt_pk_bf16_f32 v6, v36, v37
    v_cvt_pk_bf16_f32 v7, v38, v39
    v_cvt_pk_bf16_f32 v8, v40, v41
    v_cvt_pk_bf16_f32 v9, v42, v43
    v_mov_b32 v137, v136
    s_nop 1
    v_permlane32_swap_b32 v136, v137
    s_nop 1
    v_add_f32 v136, v136, v137
    s_cmp_lg_u32 s3, 0
    s_cbranch_scc1 a_gw_16
    v_mov_b32 v148, 163824
    ds_read_b32 v149, v148
    s_mov_b32 s42, 0x8000
    s_mov_b32 s43, 3801088
    s_waitcnt vmcnt(0) lgkmcnt(0)
    v_readfirstlane_b32 s44, v149
    s_branch a_gf_18
a_gp_17:
    buffer_load_dwordx4 v[140:143], v3, s[36:39], s43 offen sc1
    buffer_load_dwordx4 v[144:147], v3, s[36:39], s43 offen offset:1024 sc1
    s_waitcnt vmcnt(0)
a_gf_18:
    v_xor_b32 v140, s44, v140
    v_xor_b32 v141, s44, v141
    v_xor_b32 v142, s44, v142
    v_xor_b32 v143, s44, v143
    v_xor_b32 v144, s44, v144
    v_xor_b32 v145, s44, v145
    v_xor_b32 v146, s44, v146
    v_xor_b32 v147, s44, v147
    v_or_b32 v140, v140, v141
    v_or_b32 v140, v140, v142
    v_or_b32 v140, v140, v143
    v_or_b32 v140, v140, v144
    v_or_b32 v140, v140, v145
    v_or_b32 v140, v140, v146
    v_or_b32 v140, v140, v147
    v_cmp_ne_u32 vcc, 0, v140
    s_sub_u32 s42, s42, 1
    s_nop 3
    s_cbranch_vccz a_gw_16
    s_cmp_eq_u32 s42, 0
    s_cbranch_scc1 a_gw_16
    s_sleep 4
    s_branch a_gp_17
a_gw_16:
    s_barrier
    s_mov_b32 s43, 3670016
    buffer_load_dwordx4 v[140:143], v3, s[36:39], s43 offen sc1
    v_mov_b32 v64, 0
    v_mov_b32 v65, 0
    v_mov_b32 v66, 0
    v_mov_b32 v67, 0
    v_mov_b32 v68, 0
    v_mov_b32 v69, 0
    v_mov_b32 v70, 0
    v_mov_b32 v71, 0
    v_mov_b32 v72, 0
    v_mov_b32 v73, 0
    v_mov_b32 v74, 0
    v_mov_b32 v75, 0
    v_mov_b32 v76, 0
    v_mov_b32 v77, 0
    v_mov_b32 v78, 0
    v_mov_b32 v79, 0
    v_mov_b32 v24, 0
    v_mov_b32 v25, 0
    v_mov_b32 v26, 0
    v_mov_b32 v27, 0
    v_mov_b32 v28, 0
    v_mov_b32 v29, 0
    v_mov_b32 v30, 0
    v_mov_b32 v31, 0
    v_mov_b32 v80, 0
    v_mov_b32 v81, 0
    v_mov_b32 v82, 0
    v_mov_b32 v83, 0
    v_mov_b32 v84, 0
    v_mov_b32 v85, 0
    v_mov_b32 v86, 0
    v_mov_b32 v87, 0
    v_mov_b32 v100, 0
    v_mov_b32 v101, 0
    v_mov_b32 v102, 0
    v_mov_b32 v103, 0
    v_lshrrev_b32 v163, 5, v0
    s_mul_i32 s50, s6, 5
    v_add_u32 v164, s50, v163
    v_and_b32 v165, 31, v0
    v_lshlrev_b32 v165, 4, v165
    v_lshrrev_b32 v166, 2, v164
    v_lshlrev_b32 v160, 10, v166
    v_bfe_u32 v166, v164, 1, 1
    v_lshl_add_u32 v160, v166, 9, v160
    v_and_b32 v166, 1, v164
    v_lshl_add_u32 v160, v166, 3, v160
    v_add_u32 v160, v160, v165
    v_add_u32 v164, 2, v164
    v_lshrrev_b32 v166, 2, v164
    v_lshlrev_b32 v161, 10, v166
    v_bfe_u32 v166, v164, 1, 1
    v_lshl_add_u32 v161, v166, 9, v161
    v_and_b32 v166, 1, v164
    v_lshl_add_u32 v161, v166, 3, v161
    v_add_u32 v161, v161, v165
    s_add_u32 s50, s50, 4
    v_mov_b32 v164, s50
    v_lshrrev_b32 v166, 2, v164
    v_lshlrev_b32 v162, 10, v166
    v_bfe_u32 v166, v164, 1, 1
    v_lshl_add_u32 v162, v166, 9, v162
    v_and_b32 v166, 1, v164
    v_lshl_add_u32 v162, v166, 3, v162
    v_add_u32 v162, v162, v165
    s_lshl_b32 s87, s5, 1
    s_add_u32 s87, s87, s7
    s_mul_i32 s87, s87, 40960
    s_add_u32 s87, s87, 13631488
    s_add_u32 s52, s20, 12582912
    s_addc_u32 s53, s21, 0
    s_mov_b32 s54, 819200
    s_mov_b32 s55, 0x20000
    s_add_u32 s56, s20, 13631488
    s_addc_u32 s57, s21, 0
    s_mov_b32 s58, 2621440
    s_mov_b32 s59, 0x20000
    s_mul_i32 s80, s3, 43
    s_lshr_b32 s80, s80, 7
    s_mul_i32 s81, s80, 3
    s_sub_u32 s81, s3, s81
    s_lshr_b32 s82, s4, 1
    s_mul_i32 s82, s82, 5
    s_and_b32 s83, s4, 1
    s_mul_i32 s84, s83, 3
    s_add_u32 s82, s82, s84
    s_add_u32 s82, s82, s81
    s_mul_i32 s84, s82, 40960
    s_mul_i32 s82, s80, 10240
    s_add_u32 s84, s84, s82
    s_lshl_b32 s86, s80, 0
    s_mul_i32 s86, s80, 10240
    s_cmp_eq_u32 s81, 2
    s_cselect_b32 s85, s83, 0
    s_xor_b32 s85, s85, 1
    s_add_u32 s80, s3, 0
    s_mul_i32 s81, s80, 52429
    s_lshr_b32 s81, s81, 18
    s_mul_i32 s82, s81, 5
    s_sub_u32 s82, s80, s82
    s_mul_i32 s81, s81, 10240
    s_lshl_b32 s82, s82, 10
    s_add_u32 s92, s81, s82
    s_add_u32 s80, s3, 12
    s_mul_i32 s81, s80, 52429
    s_lshr_b32 s81, s81, 18
    s_mul_i32 s82, s81, 5
    s_sub_u32 s82, s80, s82
    s_mul_i32 s81, s81, 10240
    s_lshl_b32 s82, s82, 10
    s_add_u32 s93, s81, s82
    s_add_u32 s80, s3, 24
    s_mul_i32 s81, s80, 52429
    s_lshr_b32 s81, s81, 18
    s_mul_i32 s82, s81, 5
    s_sub_u32 s82, s80, s82
    s_mul_i32 s81, s81, 10240
    s_lshl_b32 s82, s82, 10
    s_add_u32 s94, s81, s82
    s_add_u32 s80, s3, 36
    s_mul_i32 s81, s80, 52429
    s_lshr_b32 s81, s81, 18
    s_mul_i32 s82, s81, 5
    s_sub_u32 s82, s80, s82
    s_mul_i32 s81, s81, 10240
    s_lshl_b32 s82, s82, 10
    s_add_u32 s95, s81, s82
    s_mul_i32 s97, s5, 81920
    s_waitcnt vmcnt(0)
    v_max_f32 v140, v140, v142
    v_max_f32 v141, v141, v143
    s_nop 1
    v_max_f32_dpp v140, v140, v140 row_ror:8 row_mask:0xf bank_mask:0xf
    v_max_f32_dpp v141, v141, v141 row_ror:8 row_mask:0xf bank_mask:0xf
    s_nop 1
    v_max_f32_dpp v140, v140, v140 row_ror:4 row_mask:0xf bank_mask:0xf
    v_max_f32_dpp v141, v141, v141 row_ror:4 row_mask:0xf bank_mask:0xf
    s_nop 1
    v_max_f32_dpp v140, v140, v140 row_ror:2 row_mask:0xf bank_mask:0xf
    v_max_f32_dpp v141, v141, v141 row_ror:2 row_mask:0xf bank_mask:0xf
    s_nop 1
    v_max_f32_dpp v140, v140, v140 row_ror:1 row_mask:0xf bank_mask:0xf
    v_max_f32_dpp v141, v141, v141 row_ror:1 row_mask:0xf bank_mask:0xf
    v_mov_b32 v142, v140
    v_mov_b32 v143, v141
    s_nop 1
    v_permlane16_swap_b32 v140, v142
    v_permlane16_swap_b32 v141, v143
    s_nop 1
    v_max_f32 v140, v140, v142
    v_max_f32 v141, v141, v143
    v_mov_b32 v142, v140
    v_mov_b32 v143, v141
    s_nop 1
    v_permlane32_swap_b32 v140, v142
    v_permlane32_swap_b32 v141, v143
    s_nop 1
    v_max_f32 v140, v140, v142
    v_max_f32 v141, v141, v143
    v_add_f32 v140, v140, v141
    v_mul_f32 v136, v136, v140
    s_mov_b32 s45, 0x45c80000
    v_cmp_nle_f32 vcc, v136, s45
    s_nop 4
    s_cbranch_vccz attn_fast_19
    v_mov_b32 v136, 0xff800000
    s_mov_b32 s46, 0
    v_lshlrev_b32 v137, 3, v0
attn_maxloop_20:
    buffer_load_dwordx4 v[140:143], v3, s[28:31], s46 offen sc1
    buffer_load_dwordx2 v[144:145], v137, s[28:31], s46 offen offset:1024 sc1
    s_waitcnt vmcnt(0)
    v_mfma_f32_32x32x16_bf16 v[48:63], v[140:143], v[4:7], 0
    v_mfma_f32_32x32x8bf16_1k v[48:63], v[144:145], v[8:9], v[48:63]
    s_add_u32 s46, s46, 4096
    s_nop 15
    v_max3_f32 v136, v136, v48, v49
    v_max3_f32 v136, v136, v50, v51
    v_max3_f32 v136, v136, v52, v53
    v_max3_f32 v136, v136, v54, v55
    v_max3_f32 v136, v136, v56, v57
    v_max3_f32 v136, v136, v58, v59
    v_max3_f32 v136, v136, v60, v61
    v_max3_f32 v136, v136, v62, v63
    s_cmp_lt_u32 s46, 262144
    s_cbranch_scc1 attn_maxloop_20
    v_mov_b32 v138, v136
    s_nop 1
    v_permlane32_swap_b32 v136, v138
    s_nop 1
    v_max_f32 v136, v136, v138
    v_xor_b32 v136, 0x80000000, v136
    v_and_b32 v137, 0xffff0000, v136
    v_sub_f32 v138, v136, v137
    v_and_b32 v139, 0xffff0000, v138
    v_sub_f32 v138, v138, v139
    v_lshrrev_b32 v138, 16, v138
    v_lshrrev_b32 v137, 16, v137
    v_or_b32 v137, v137, v139
    v_cmp_lt_u32 vcc, 31, v0
    s_nop 1
    v_cndmask_b32 v8, v8, v137, vcc
    v_cndmask_b32 v9, v9, v138, vcc
attn_fast_19:
    s_barrier
    ds_read_b128 v[12:15], v1 offset:0
    ds_read_b64 v[10:11], v2 offset:1024
    s_waitcnt lgkmcnt(0)
    v_mfma_f32_32x32x16_bf16 v[32:47], v[12:15], v[4:7], 0
    v_mfma_f32_32x32x8bf16_1k v[32:47], v[10:11], v[8:9], v[32:47]
    ds_read_b128 v[88:91], v1 offset:4096
    ds_read_b64 v[92:93], v2 offset:5120
    ds_read_b128 v[16:19], v1 offset:2048
    ds_read_b128 v[20:23], v1 offset:3072
    s_nop 7
    s_mov_b32 s47, 4
attn_loop_21:
    s_waitcnt lgkmcnt(0)
    v_mfma_f32_32x32x16_bf16 v[48:63], v[88:91], v[4:7], 0
    ds_read_b128 v[96:99], v1 offset:6144
    v_cvt_pk_bf16_f32 v30, v84, v85
    v_cvt_pk_bf16_f32 v31, v86, v87
    v_exp_f32 v80, v32
    v_exp_f32 v81, v33
    v_exp_f32 v82, v34
    v_exp_f32 v83, v35
    v_mfma_f32_32x32x16_bf16 v[64:79], v[100:103], v[28:31], v[64:79]
    ds_read_b128 v[12:15], v1 offset:8192
    ds_read_b64 v[10:11], v2 offset:9216
    ds_read_b128 v[100:103], v1 offset:7168
    v_cvt_pk_bf16_f32 v24, v80, v81
    v_cvt_pk_bf16_f32 v25, v82, v83
    v_exp_f32 v84, v36
    v_exp_f32 v85, v37
    v_exp_f32 v86, v38
    v_exp_f32 v87, v39
    v_mfma_f32_32x32x8bf16_1k v[48:63], v[92:93], v[8:9], v[48:63]
    v_cvt_pk_bf16_f32 v26, v84, v85
    v_cvt_pk_bf16_f32 v27, v86, v87
    v_exp_f32 v80, v40
    v_exp_f32 v81, v41
    v_exp_f32 v82, v42
    v_exp_f32 v83, v43
    v_mfma_f32_32x32x16_bf16 v[64:79], v[16:19], v[24:27], v[64:79]
    v_cvt_pk_bf16_f32 v28, v80, v81
    v_cvt_pk_bf16_f32 v29, v82, v83
    v_exp_f32 v84, v44
    v_exp_f32 v85, v45
    v_exp_f32 v86, v46
    v_exp_f32 v87, v47
    s_waitcnt lgkmcnt(0)
    v_mfma_f32_32x32x16_bf16 v[32:47], v[12:15], v[4:7], 0
    ds_read_b128 v[16:19], v1 offset:10240
    v_cvt_pk_bf16_f32 v30, v84, v85
    v_cvt_pk_bf16_f32 v31, v86, v87
    v_exp_f32 v80, v48
    v_exp_f32 v81, v49
    v_exp_f32 v82, v50
    v_exp_f32 v83, v51
    v_mfma_f32_32x32x16_bf16 v[64:79], v[20:23], v[28:31], v[64:79]
    ds_read_b128 v[88:91], v1 offset:12288
    ds_read_b64 v[92:93], v2 offset:13312
    ds_read_b128 v[20:23], v1 offset:11264
    v_cvt_pk_bf16_f32 v24, v80, v81
    v_cvt_pk_bf16_f32 v25, v82, v83
    v_exp_f32 v84, v52
    v_exp_f32 v85, v53
    v_exp_f32 v86, v54
    v_exp_f32 v87, v55
    v_mfma_f32_32x32x8bf16_1k v[32:47], v[10:11], v[8:9], v[32:47]
    v_cvt_pk_bf16_f32 v26, v84, v85
    v_cvt_pk_bf16_f32 v27, v86, v87
    v_exp_f32 v80, v56
    v_exp_f32 v81, v57
    v_exp_f32 v82, v58
    v_exp_f32 v83, v59
    v_mfma_f32_32x32x16_bf16 v[64:79], v[96:99], v[24:27], v[64:79]
    v_cvt_pk_bf16_f32 v28, v80, v81
    v_cvt_pk_bf16_f32 v29, v82, v83
    v_exp_f32 v84, v60
    v_exp_f32 v85, v61
    v_exp_f32 v86, v62
    v_exp_f32 v87, v63
    s_waitcnt lgkmcnt(0)
    v_mfma_f32_32x32x16_bf16 v[48:63], v[88:91], v[4:7], 0
    ds_read_b128 v[96:99], v1 offset:14336
    v_cvt_pk_bf16_f32 v30, v84, v85
    v_cvt_pk_bf16_f32 v31, v86, v87
    v_exp_f32 v80, v32
    v_exp_f32 v81, v33
    v_exp_f32 v82, v34
    v_exp_f32 v83, v35
    v_mfma_f32_32x32x16_bf16 v[64:79], v[100:103], v[28:31], v[64:79]
    ds_read_b128 v[12:15], v1 offset:16384
    ds_read_b64 v[10:11], v2 offset:17408
    ds_read_b128 v[100:103], v1 offset:15360
    v_cvt_pk_bf16_f32 v24, v80, v81
    v_cvt_pk_bf16_f32 v25, v82, v83
    v_exp_f32 v84, v36
    v_exp_f32 v85, v37
    v_exp_f32 v86, v38
    v_exp_f32 v87, v39
    v_mfma_f32_32x32x8bf16_1k v[48:63], v[92:93], v[8:9], v[48:63]
    v_cvt_pk_bf16_f32 v26, v84, v85
    v_cvt_pk_bf16_f32 v27, v86, v87
    v_exp_f32 v80, v40
    v_exp_f32 v81, v41
    v_exp_f32 v82, v42
    v_exp_f32 v83, v43
    v_mfma_f32_32x32x16_bf16 v[64:79], v[16:19], v[24:27], v[64:79]
    v_cvt_pk_bf16_f32 v28, v80, v81
    v_cvt_pk_bf16_f32 v29, v82, v83
    v_exp_f32 v84, v44
    v_exp_f32 v85, v45
    v_exp_f32 v86, v46
    v_exp_f32 v87, v47
    s_waitcnt lgkmcnt(0)
    v_mfma_f32_32x32x16_bf16 v[32:47], v[12:15], v[4:7], 0
    ds_read_b128 v[16:19], v1 offset:18432
    v_cvt_pk_bf16_f32 v30, v84, v85
    v_cvt_pk_bf16_f32 v31, v86, v87
    v_exp_f32 v80, v48
    v_exp_f32 v81, v49
    v_exp_f32 v82, v50
    v_exp_f32 v83, v51
    v_mfma_f32_32x32x16_bf16 v[64:79], v[20:23], v[28:31], v[64:79]
    ds_read_b128 v[88:91], v1 offset:20480
    ds_read_b64 v[92:93], v2 offset:21504
    ds_read_b128 v[20:23], v1 offset:19456
    v_cvt_pk_bf16_f32 v24, v80, v81
    v_cvt_pk_bf16_f32 v25, v82, v83
    v_exp_f32 v84, v52
    v_exp_f32 v85, v53
    v_exp_f32 v86, v54
    v_exp_f32 v87, v55
    v_mfma_f32_32x32x8bf16_1k v[32:47], v[10:11], v[8:9], v[32:47]
    v_cvt_pk_bf16_f32 v26, v84, v85
    v_cvt_pk_bf16_f32 v27, v86, v87
    v_exp_f32 v80, v56
    v_exp_f32 v81, v57
    v_exp_f32 v82, v58
    v_exp_f32 v83, v59
    v_mfma_f32_32x32x16_bf16 v[64:79], v[96:99], v[24:27], v[64:79]
    v_cvt_pk_bf16_f32 v28, v80, v81
    v_cvt_pk_bf16_f32 v29, v82, v83
    v_exp_f32 v84, v60
    v_exp_f32 v85, v61
    v_exp_f32 v86, v62
    v_exp_f32 v87, v63
    s_barrier
    s_waitcnt lgkmcnt(0)
    v_mfma_f32_32x32x16_bf16 v[48:63], v[88:91], v[4:7], 0
    ds_read_b128 v[96:99], v1 offset:22528
    v_cvt_pk_bf16_f32 v30, v84, v85
    v_cvt_pk_bf16_f32 v31, v86, v87
    v_exp_f32 v80, v32
    v_exp_f32 v81, v33
    v_exp_f32 v82, v34
    v_exp_f32 v83, v35
    v_mfma_f32_32x32x16_bf16 v[64:79], v[100:103], v[28:31], v[64:79]
    ds_read_b128 v[12:15], v1 offset:24576
    ds_read_b64 v[10:11], v2 offset:25600
    ds_read_b128 v[100:103], v1 offset:23552
    v_cvt_pk_bf16_f32 v24, v80, v81
    v_cvt_pk_bf16_f32 v25, v82, v83
    v_exp_f32 v84, v36
    v_exp_f32 v85, v37
    v_exp_f32 v86, v38
    v_exp_f32 v87, v39
    v_mfma_f32_32x32x8bf16_1k v[48:63], v[92:93], v[8:9], v[48:63]
    v_cvt_pk_bf16_f32 v26, v84, v85
    v_cvt_pk_bf16_f32 v27, v86, v87
    v_exp_f32 v80, v40
    v_exp_f32 v81, v41
    v_exp_f32 v82, v42
    v_exp_f32 v83, v43
    v_mfma_f32_32x32x16_bf16 v[64:79], v[16:19], v[24:27], v[64:79]
    v_cvt_pk_bf16_f32 v28, v80, v81
    v_cvt_pk_bf16_f32 v29, v82, v83
    v_exp_f32 v84, v44
    v_exp_f32 v85, v45
    v_exp_f32 v86, v46
    v_exp_f32 v87, v47
    s_waitcnt lgkmcnt(0)
    v_mfma_f32_32x32x16_bf16 v[32:47], v[12:15], v[4:7], 0
    ds_read_b128 v[16:19], v1 offset:26624
    v_cvt_pk_bf16_f32 v30, v84, v85
    v_cvt_pk_bf16_f32 v31, v86, v87
    v_exp_f32 v80, v48
    v_exp_f32 v81, v49
    v_exp_f32 v82, v50
    v_exp_f32 v83, v51
    v_mfma_f32_32x32x16_bf16 v[64:79], v[20:23], v[28:31], v[64:79]
    ds_read_b128 v[88:91], v1 offset:28672
    ds_read_b64 v[92:93], v2 offset:29696
    ds_read_b128 v[20:23], v1 offset:27648
    v_cvt_pk_bf16_f32 v24, v80, v81
    v_cvt_pk_bf16_f32 v25, v82, v83
    v_exp_f32 v84, v52
    v_exp_f32 v85, v53
    v_exp_f32 v86, v54
    v_exp_f32 v87, v55
    v_mfma_f32_32x32x8bf16_1k v[32:47], v[10:11], v[8:9], v[32:47]
    v_cvt_pk_bf16_f32 v26, v84, v85
    v_cvt_pk_bf16_f32 v27, v86, v87
    v_exp_f32 v80, v56
    v_exp_f32 v81, v57
    v_exp_f32 v82, v58
    v_exp_f32 v83, v59
    v_mfma_f32_32x32x16_bf16 v[64:79], v[96:99], v[24:27], v[64:79]
    v_cvt_pk_bf16_f32 v28, v80, v81
    v_cvt_pk_bf16_f32 v29, v82, v83
    v_exp_f32 v84, v60
    v_exp_f32 v85, v61
    v_exp_f32 v86, v62
    v_exp_f32 v87, v63
    s_waitcnt lgkmcnt(0)
    v_mfma_f32_32x32x16_bf16 v[48:63], v[88:91], v[4:7], 0
    ds_read_b128 v[96:99], v1 offset:30720
    v_cvt_pk_bf16_f32 v30, v84, v85
    v_cvt_pk_bf16_f32 v31, v86, v87
    v_exp_f32 v80, v32
    v_exp_f32 v81, v33
    v_exp_f32 v82, v34
    v_exp_f32 v83, v35
    v_mfma_f32_32x32x16_bf16 v[64:79], v[100:103], v[28:31], v[64:79]
    ds_read_b128 v[12:15], v1 offset:32768
    ds_read_b64 v[10:11], v2 offset:33792
    ds_read_b128 v[100:103], v1 offset:31744
    v_cvt_pk_bf16_f32 v24, v80, v81
    v_cvt_pk_bf16_f32 v25, v82, v83
    v_exp_f32 v84, v36
    v_exp_f32 v85, v37
    v_exp_f32 v86, v38
    v_exp_f32 v87, v39
    v_mfma_f32_32x32x8bf16_1k v[48:63], v[92:93], v[8:9], v[48:63]
    v_cvt_pk_bf16_f32 v26, v84, v85
    v_cvt_pk_bf16_f32 v27, v86, v87
    v_exp_f32 v80, v40
    v_exp_f32 v81, v41
    v_exp_f32 v82, v42
    v_exp_f32 v83, v43
    v_mfma_f32_32x32x16_bf16 v[64:79], v[16:19], v[24:27], v[64:79]
    v_cvt_pk_bf16_f32 v28, v80, v81
    v_cvt_pk_bf16_f32 v29, v82, v83
    v_exp_f32 v84, v44
    v_exp_f32 v85, v45
    v_exp_f32 v86, v46
    v_exp_f32 v87, v47
    s_waitcnt lgkmcnt(0)
    v_mfma_f32_32x32x16_bf16 v[32:47], v[12:15], v[4:7], 0
    ds_read_b128 v[16:19], v1 offset:34816
    v_cvt_pk_bf16_f32 v30, v84, v85
    v_cvt_pk_bf16_f32 v31, v86, v87
    v_exp_f32 v80, v48
    v_exp_f32 v81, v49
    v_exp_f32 v82, v50
    v_exp_f32 v83, v51
    v_mfma_f32_32x32x16_bf16 v[64:79], v[20:23], v[28:31], v[64:79]
    ds_read_b128 v[88:91], v1 offset:36864
    ds_read_b64 v[92:93], v2 offset:37888
    ds_read_b128 v[20:23], v1 offset:35840
    v_cvt_pk_bf16_f32 v24, v80, v81
    v_cvt_pk_bf16_f32 v25, v82, v83
    v_exp_f32 v84, v52
    v_exp_f32 v85, v53
    v_exp_f32 v86, v54
    v_exp_f32 v87, v55
    v_mfma_f32_32x32x8bf16_1k v[32:47], v[10:11], v[8:9], v[32:47]
    v_cvt_pk_bf16_f32 v26, v84, v85
    v_cvt_pk_bf16_f32 v27, v86, v87
    v_exp_f32 v80, v56
    v_exp_f32 v81, v57
    v_exp_f32 v82, v58
    v_exp_f32 v83, v59
    v_mfma_f32_32x32x16_bf16 v[64:79], v[96:99], v[24:27], v[64:79]
    v_cvt_pk_bf16_f32 v28, v80, v81
    v_cvt_pk_bf16_f32 v29, v82, v83
    v_exp_f32 v84, v60
    v_exp_f32 v85, v61
    v_exp_f32 v86, v62
    v_exp_f32 v87, v63
    s_barrier
    s_waitcnt lgkmcnt(0)
    v_mfma_f32_32x32x16_bf16 v[48:63], v[88:91], v[4:7], 0
    ds_read_b128 v[96:99], v1 offset:38912
    v_cvt_pk_bf16_f32 v30, v84, v85
    v_cvt_pk_bf16_f32 v31, v86, v87
    v_exp_f32 v80, v32
    v_exp_f32 v81, v33
    v_exp_f32 v82, v34
    v_exp_f32 v83, v35
    v_mfma_f32_32x32x16_bf16 v[64:79], v[100:103], v[28:31], v[64:79]
    ds_read_b128 v[12:15], v1 offset:40960
    ds_read_b64 v[10:11], v2 offset:41984
    ds_read_b128 v[100:103], v1 offset:39936
    v_cvt_pk_bf16_f32 v24, v80, v81
    v_cvt_pk_bf16_f32 v25, v82, v83
    v_exp_f32 v84, v36
    v_exp_f32 v85, v37
    v_exp_f32 v86, v38
    v_exp_f32 v87, v39
    v_mfma_f32_32x32x8bf16_1k v[48:63], v[92:93], v[8:9], v[48:63]
    v_cvt_pk_bf16_f32 v26, v84, v85
    v_cvt_pk_bf16_f32 v27, v86, v87
    v_exp_f32 v80, v40
    v_exp_f32 v81, v41
    v_exp_f32 v82, v42
    v_exp_f32 v83, v43
    v_mfma_f32_32x32x16_bf16 v[64:79], v[16:19], v[24:27], v[64:79]
    v_cvt_pk_bf16_f32 v28, v80, v81
    v_cvt_pk_bf16_f32 v29, v82, v83
    v_exp_f32 v84, v44
    v_exp_f32 v85, v45
    v_exp_f32 v86, v46
    v_exp_f32 v87, v47
    s_waitcnt lgkmcnt(0)
    v_mfma_f32_32x32x16_bf16 v[32:47], v[12:15], v[4:7], 0
    ds_read_b128 v[16:19], v1 offset:43008
    v_cvt_pk_bf16_f32 v30, v84, v85
    v_cvt_pk_bf16_f32 v31, v86, v87
    v_exp_f32 v80, v48
    v_exp_f32 v81, v49
    v_exp_f32 v82, v50
    v_exp_f32 v83, v51
    v_mfma_f32_32x32x16_bf16 v[64:79], v[20:23], v[28:31], v[64:79]
    ds_read_b128 v[88:91], v1 offset:45056
    ds_read_b64 v[92:93], v2 offset:46080
    ds_read_b128 v[20:23], v1 offset:44032
    v_cvt_pk_bf16_f32 v24, v80, v81
    v_cvt_pk_bf16_f32 v25, v82, v83
    v_exp_f32 v84, v52
    v_exp_f32 v85, v53
    v_exp_f32 v86, v54
    v_exp_f32 v87, v55
    v_mfma_f32_32x32x8bf16_1k v[32:47], v[10:11], v[8:9], v[32:47]
    v_cvt_pk_bf16_f32 v26, v84, v85
    v_cvt_pk_bf16_f32 v27, v86, v87
    v_exp_f32 v80, v56
    v_exp_f32 v81, v57
    v_exp_f32 v82, v58
    v_exp_f32 v83, v59
    v_mfma_f32_32x32x16_bf16 v[64:79], v[96:99], v[24:27], v[64:79]
    v_cvt_pk_bf16_f32 v28, v80, v81
    v_cvt_pk_bf16_f32 v29, v82, v83
    v_exp_f32 v84, v60
    v_exp_f32 v85, v61
    v_exp_f32 v86, v62
    v_exp_f32 v87, v63
    s_waitcnt lgkmcnt(0)
    v_mfma_f32_32x32x16_bf16 v[48:63], v[88:91], v[4:7], 0
    ds_read_b128 v[96:99], v1 offset:47104
    v_cvt_pk_bf16_f32 v30, v84, v85
    v_cvt_pk_bf16_f32 v31, v86, v87
    v_exp_f32 v80, v32
    v_exp_f32 v81, v33
    v_exp_f32 v82, v34
    v_exp_f32 v83, v35
    v_mfma_f32_32x32x16_bf16 v[64:79], v[100:103], v[28:31], v[64:79]
    ds_read_b128 v[12:15], v1 offset:49152
    ds_read_b64 v[10:11], v2 offset:50176
    ds_read_b128 v[100:103], v1 offset:48128
    v_cvt_pk_bf16_f32 v24, v80, v81
    v_cvt_pk_bf16_f32 v25, v82, v83
    v_exp_f32 v84, v36
    v_exp_f32 v85, v37
    v_exp_f32 v86, v38
    v_exp_f32 v87, v39
    v_mfma_f32_32x32x8bf16_1k v[48:63], v[92:93], v[8:9], v[48:63]
    v_cvt_pk_bf16_f32 v26, v84, v85
    v_cvt_pk_bf16_f32 v27, v86, v87
    v_exp_f32 v80, v40
    v_exp_f32 v81, v41
    v_exp_f32 v82, v42
    v_exp_f32 v83, v43
    v_mfma_f32_32x32x16_bf16 v[64:79], v[16:19], v[24:27], v[64:79]
    v_cvt_pk_bf16_f32 v28, v80, v81
    v_cvt_pk_bf16_f32 v29, v82, v83
    v_exp_f32 v84, v44
    v_exp_f32 v85, v45
    v_exp_f32 v86, v46
    v_exp_f32 v87, v47
    s_waitcnt lgkmcnt(0)
    v_mfma_f32_32x32x16_bf16 v[32:47], v[12:15], v[4:7], 0
    ds_read_b128 v[16:19], v1 offset:51200
    v_cvt_pk_bf16_f32 v30, v84, v85
    v_cvt_pk_bf16_f32 v31, v86, v87
    v_exp_f32 v80, v48
    v_exp_f32 v81, v49
    v_exp_f32 v82, v50
    v_exp_f32 v83, v51
    v_mfma_f32_32x32x16_bf16 v[64:79], v[20:23], v[28:31], v[64:79]
    ds_read_b128 v[88:91], v1 offset:53248
    ds_read_b64 v[92:93], v2 offset:54272
    ds_read_b128 v[20:23], v1 offset:52224
    v_cvt_pk_bf16_f32 v24, v80, v81
    v_cvt_pk_bf16_f32 v25, v82, v83
    v_exp_f32 v84, v52
    v_exp_f32 v85, v53
    v_exp_f32 v86, v54
    v_exp_f32 v87, v55
    v_mfma_f32_32x32x8bf16_1k v[32:47], v[10:11], v[8:9], v[32:47]
    v_cvt_pk_bf16_f32 v26, v84, v85
    v_cvt_pk_bf16_f32 v27, v86, v87
    v_exp_f32 v80, v56
    v_exp_f32 v81, v57
    v_exp_f32 v82, v58
    v_exp_f32 v83, v59
    v_mfma_f32_32x32x16_bf16 v[64:79], v[96:99], v[24:27], v[64:79]
    v_cvt_pk_bf16_f32 v28, v80, v81
    v_cvt_pk_bf16_f32 v29, v82, v83
    v_exp_f32 v84, v60
    v_exp_f32 v85, v61
    v_exp_f32 v86, v62
    v_exp_f32 v87, v63
    s_barrier
    s_cmp_lg_u32 s47, 1
    s_cbranch_scc1 nowo_22
    s_add_u32 s80, s84, 0
    buffer_load_dwordx4 v[104:107], v3, s[52:55], s80 offen offset:0 sc1
    s_add_u32 s80, s84, 0
    buffer_load_dwordx4 v[108:111], v3, s[52:55], s80 offen offset:1024 sc1
    s_add_u32 s80, s84, 0
    buffer_load_dwordx4 v[112:115], v3, s[52:55], s80 offen offset:2048 sc1
    s_add_u32 s80, s84, 0
    buffer_load_dwordx4 v[116:119], v3, s[52:55], s80 offen offset:3072 sc1
    s_add_u32 s80, s84, 4096
    buffer_load_dwordx4 v[120:123], v3, s[52:55], s80 offen offset:0 sc1
    s_add_u32 s80, s84, 4096
    buffer_load_dwordx4 v[124:127], v3, s[52:55], s80 offen offset:1024 sc1
    s_add_u32 s80, s84, 4096
    buffer_load_dwordx4 v[128:131], v3, s[52:55], s80 offen offset:2048 sc1
    s_add_u32 s80, s84, 4096
    buffer_load_dwordx4 v[132:135], v3, s[52:55], s80 offen offset:3072 sc1
    s_add_u32 s80, s84, 8192
    buffer_load_dwordx4 v[136:139], v3, s[52:55], s80 offen offset:0 sc1
    s_add_u32 s80, s84, 8192
    buffer_load_dwordx4 v[140:143], v3, s[52:55], s80 offen offset:1024 sc1
nowo_22:
    s_waitcnt lgkmcnt(0)
    v_mfma_f32_32x32x16_bf16 v[48:63], v[88:91], v[4:7], 0
    ds_read_b128 v[96:99], v1 offset:55296
    v_cvt_pk_bf16_f32 v30, v84, v85
    v_cvt_pk_bf16_f32 v31, v86, v87
    v_exp_f32 v80, v32
    v_exp_f32 v81, v33
    v_exp_f32 v82, v34
    v_exp_f32 v83, v35
    v_mfma_f32_32x32x16_bf16 v[64:79], v[100:103], v[28:31], v[64:79]
    ds_read_b128 v[12:15], v1 offset:57344
    ds_read_b64 v[10:11], v2 offset:58368
    ds_read_b128 v[100:103], v1 offset:56320
    v_cvt_pk_bf16_f32 v24, v80, v81
    v_cvt_pk_bf16_f32 v25, v82, v83
    v_exp_f32 v84, v36
    v_exp_f32 v85, v37
    v_exp_f32 v86, v38
    v_exp_f32 v87, v39
    v_mfma_f32_32x32x8bf16_1k v[48:63], v[92:93], v[8:9], v[48:63]
    v_cvt_pk_bf16_f32 v26, v84, v85
    v_cvt_pk_bf16_f32 v27, v86, v87
    v_exp_f32 v80, v40
    v_exp_f32 v81, v41
    v_exp_f32 v82, v42
    v_exp_f32 v83, v43
    v_mfma_f32_32x32x16_bf16 v[64:79], v[16:19], v[24:27], v[64:79]
    v_cvt_pk_bf16_f32 v28, v80, v81
    v_cvt_pk_bf16_f32 v29, v82, v83
    v_exp_f32 v84, v44
    v_exp_f32 v85, v45
    v_exp_f32 v86, v46
    v_exp_f32 v87, v47
    s_waitcnt lgkmcnt(0)
    v_mfma_f32_32x32x16_bf16 v[32:47], v[12:15], v[4:7], 0
    ds_read_b128 v[16:19], v1 offset:59392
    v_cvt_pk_bf16_f32 v30, v84, v85
    v_cvt_pk_bf16_f32 v31, v86, v87
    v_exp_f32 v80, v48
    v_exp_f32 v81, v49
    v_exp_f32 v82, v50
    v_exp_f32 v83, v51
    v_mfma_f32_32x32x16_bf16 v[64:79], v[20:23], v[28:31], v[64:79]
    ds_read_b128 v[88:91], v1 offset:61440
    ds_read_b64 v[92:93], v2 offset:62464
    ds_read_b128 v[20:23], v1 offset:60416
    v_cvt_pk_bf16_f32 v24, v80, v81
    v_cvt_pk_bf16_f32 v25, v82, v83
    v_exp_f32 v84, v52
    v_exp_f32 v85, v53
    v_exp_f32 v86, v54
    v_exp_f32 v87, v55
    v_mfma_f32_32x32x8bf16_1k v[32:47], v[10:11], v[8:9], v[32:47]
    v_cvt_pk_bf16_f32 v26, v84, v85
    v_cvt_pk_bf16_f32 v27, v86, v87
    v_exp_f32 v80, v56
    v_exp_f32 v81, v57
    v_exp_f32 v82, v58
    v_exp_f32 v83, v59
    v_mfma_f32_32x32x16_bf16 v[64:79], v[96:99], v[24:27], v[64:79]
    v_cvt_pk_bf16_f32 v28, v80, v81
    v_cvt_pk_bf16_f32 v29, v82, v83
    v_exp_f32 v84, v60
    v_exp_f32 v85, v61
    v_exp_f32 v86, v62
    v_exp_f32 v87, v63
    s_waitcnt lgkmcnt(0)
    v_mfma_f32_32x32x16_bf16 v[48:63], v[88:91], v[4:7], 0
    ds_read_b128 v[96:99], v1 offset:63488
    v_cvt_pk_bf16_f32 v30, v84, v85
    v_cvt_pk_bf16_f32 v31, v86, v87
    v_exp_f32 v80, v32
    v_exp_f32 v81, v33
    v_exp_f32 v82, v34
    v_exp_f32 v83, v35
    v_mfma_f32_32x32x16_bf16 v[64:79], v[100:103], v[28:31], v[64:79]
    ds_read_b128 v[12:15], v1 offset:0
    ds_read_b64 v[10:11], v2 offset:1024
    ds_read_b128 v[100:103], v1 offset:64512
    v_cvt_pk_bf16_f32 v24, v80, v81
    v_cvt_pk_bf16_f32 v25, v82, v83
    v_exp_f32 v84, v36
    v_exp_f32 v85, v37
    v_exp_f32 v86, v38
    v_exp_f32 v87, v39
    v_mfma_f32_32x32x8bf16_1k v[48:63], v[92:93], v[8:9], v[48:63]
    v_cvt_pk_bf16_f32 v26, v84, v85
    v_cvt_pk_bf16_f32 v27, v86, v87
    v_exp_f32 v80, v40
    v_exp_f32 v81, v41
    v_exp_f32 v82, v42
    v_exp_f32 v83, v43
    v_mfma_f32_32x32x16_bf16 v[64:79], v[16:19], v[24:27], v[64:79]
    v_cvt_pk_bf16_f32 v28, v80, v81
    v_cvt_pk_bf16_f32 v29, v82, v83
    v_exp_f32 v84, v44
    v_exp_f32 v85, v45
    v_exp_f32 v86, v46
    v_exp_f32 v87, v47
    s_waitcnt lgkmcnt(0)
    v_mfma_f32_32x32x16_bf16 v[32:47], v[12:15], v[4:7], 0
    ds_read_b128 v[16:19], v1 offset:2048
    v_cvt_pk_bf16_f32 v30, v84, v85
    v_cvt_pk_bf16_f32 v31, v86, v87
    v_exp_f32 v80, v48
    v_exp_f32 v81, v49
    v_exp_f32 v82, v50
    v_exp_f32 v83, v51
    v_mfma_f32_32x32x16_bf16 v[64:79], v[20:23], v[28:31], v[64:79]
    ds_read_b128 v[88:91], v1 offset:4096
    ds_read_b64 v[92:93], v2 offset:5120
    ds_read_b128 v[20:23], v1 offset:3072
    v_cvt_pk_bf16_f32 v24, v80, v81
    v_cvt_pk_bf16_f32 v25, v82, v83
    v_exp_f32 v84, v52
    v_exp_f32 v85, v53
    v_exp_f32 v86, v54
    v_exp_f32 v87, v55
    v_mfma_f32_32x32x8bf16_1k v[32:47], v[10:11], v[8:9], v[32:47]
    v_cvt_pk_bf16_f32 v26, v84, v85
    v_cvt_pk_bf16_f32 v27, v86, v87
    v_exp_f32 v80, v56
    v_exp_f32 v81, v57
    v_exp_f32 v82, v58
    v_exp_f32 v83, v59
    v_mfma_f32_32x32x16_bf16 v[64:79], v[96:99], v[24:27], v[64:79]
    v_cvt_pk_bf16_f32 v28, v80, v81
    v_cvt_pk_bf16_f32 v29, v82, v83
    v_exp_f32 v84, v60
    v_exp_f32 v85, v61
    v_exp_f32 v86, v62
    v_exp_f32 v87, v63
    s_sub_u32 s47, s47, 1
    s_cmp_eq_u32 s47, 0
    s_cbranch_scc1 attn_out_23
    s_barrier
    s_branch attn_loop_21
attn_out_23:
    v_cvt_pk_bf16_f32 v30, v84, v85
    v_cvt_pk_bf16_f32 v31, v86, v87
    s_waitcnt lgkmcnt(0)
    s_nop 0
    v_mfma_f32_32x32x16_bf16 v[64:79], v[100:103], v[28:31], v[64:79]
    s_nop 11
    v_mov_b32 v152, v72
    v_mov_b32 v153, v72
    s_nop 1
    v_permlane32_swap_b32 v152, v153
    s_nop 1
    v_rcp_f32 v153, v153
    s_nop 0
    v_mul_f32 v64, v64, v153
    v_mul_f32 v65, v65, v153
    v_mul_f32 v66, v66, v153
    v_mul_f32 v67, v67, v153
    v_mul_f32 v68, v68, v153
    v_mul_f32 v69, v69, v153
    v_mul_f32 v70, v70, v153
    v_mul_f32 v71, v71, v153
    v_mul_f32 v72, v72, v153
    v_mul_f32 v73, v73, v153
    v_mul_f32 v74, v74, v153
    v_mul_f32 v75, v75, v153
    v_cvt_pk_bf16_f32 v154, v64, v65
    v_cvt_pk_bf16_f32 v155, v66, v67
    v_cvt_pk_bf16_f32 v156, v68, v69
    v_cvt_pk_bf16_f32 v157, v70, v71
    v_cvt_pk_bf16_f32 v158, v72, v73
    v_cvt_pk_bf16_f32 v159, v74, v75
    s_mul_i32 s48, s7, 5120
    s_mul_i32 s49, s4, 5120
    s_sub_u32 s48, s48, s49
    s_add_u32 s48, s48, 84480
    v_add_u32 v160, s48, v160
    v_add_u32 v161, s48, v161
    v_add_u32 v162, s48, v162
    ds_write_b64 v160, v[154:155]
    ds_write_b64 v161, v[156:157]
    s_mov_b32 exec_hi, 0
    ds_write_b64 v162, v[158:159]
    s_mov_b64 exec, -1
    v_mov_b32 v144, 163816
    v_mov_b32 v145, 1
    s_waitcnt lgkmcnt(0)
    s_mov_b64 exec, 1
    ds_add_u32 v144, v145
    s_mov_b64 exec, -1
    s_mov_b32 s43, 0x100000
    s_lshl_b32 s48, s3, 10
    s_add_u32 s48, s48, 84480
    v_add_u32 v146, s48, v3
    s_cmp_ge_u32 s3, 5
    s_cselect_b32 s48, 1, 0
    s_mul_i32 s49, s48, 5
    s_sub_u32 s49, s3, s49
    s_lshl_b32 s50, s5, 1
    s_add_u32 s50, s50, s48
    s_mul_i32 s50, s50, 40960
    s_mul_i32 s51, s4, 5
    s_add_u32 s49, s49, s51
    s_lshl_b32 s49, s49, 10
    s_add_u32 s50, s50, s49
    s_add_u32 s50, s50, 13631488
    s_lshl_b32 s48, s5, 1
    s_add_u32 s48, s48, 1
    s_mul_i32 s48, s48, 40960
    s_add_u32 s49, s51, s3
    s_add_u32 s49, s49, 3
    s_lshl_b32 s49, s49, 10
    s_add_u32 s48, s48, s49
    s_add_u32 s48, s48, 13631488
t_c1_24:
    ds_read_b32 v147, v144
    s_waitcnt lgkmcnt(0)
    v_readfirstlane_b32 s45, v147
    s_sub_u32 s43, s43, 1
    s_cmp_eq_u32 s43, 0
    s_cbranch_scc1 t_c1d_25
    s_cmp_lt_u32 s45, 8
    s_cbranch_scc1 t_c1_24
t_c1d_25:
    ds_read_b128 v[148:151], v146
    ds_read_b128 v[152:155], v146 offset:8192
    s_waitcnt lgkmcnt(0)
    buffer_store_dwordx4 v[148:151], v3, s[36:39], s50 offen sc1
    s_cmp_ge_u32 s3, 2
    s_cbranch_scc1 t_no2_26
    buffer_store_dwordx4 v[152:155], v3, s[36:39], s48 offen sc1
t_no2_26:
    v_mov_b32 v144, 163820
    v_mov_b32 v145, 1
    v_mov_b32 v146, 163824
    ds_read_b32 v147, v146
    s_waitcnt vmcnt(0)
    s_mov_b64 exec, 1
    ds_add_u32 v144, v145
    s_mov_b64 exec, -1
    s_cmp_lg_u32 s3, 0
    s_cbranch_scc1 t_w_27
    s_lshl_b32 s48, s5, 7
    s_add_u32 s48, s48, 3809280
    s_lshl_b32 s49, s4, 2
    s_add_u32 s49, s49, s48
    v_and_b32 v148, 7, v0
    v_lshlrev_b32 v148, 2, v148
    v_mov_b32 v149, 0
    s_mov_b32 s43, 0x100000
    s_waitcnt lgkmcnt(0)
    v_readfirstlane_b32 s44, v147
t_c_28:
    ds_read_b32 v150, v144
    s_waitcnt lgkmcnt(0)
    v_readfirstlane_b32 s45, v150
    s_sub_u32 s43, s43, 1
    s_cmp_eq_u32 s43, 0
    s_cbranch_scc1 t_w_27
    s_cmp_lt_u32 s45, 8
    s_cbranch_scc1 t_c_28
    v_mov_b32 v150, s44
    s_mov_b64 exec, 1
    buffer_store_dword v150, v149, s[36:39], s49 offen sc1
    s_mov_b64 exec, -1
    s_mov_b32 s43, 0x8000
t_p_29:
    buffer_load_dword v150, v148, s[36:39], s48 offen sc1
    s_waitcnt vmcnt(0)
    v_cmp_ne_u32 vcc, s44, v150
    s_sub_u32 s43, s43, 1
    s_nop 3
    s_cbranch_vccz t_w_27
    s_cmp_eq_u32 s43, 0
    s_cbranch_scc1 t_w_27
    s_branch t_p_29
t_w_27:
    s_waitcnt lgkmcnt(0)
    s_barrier
    s_add_u32 s80, s92, 0
    s_add_u32 m0, s80, 73728
    s_add_u32 s80, s80, s97
    buffer_load_dwordx4 v3, s[56:59], s80 offen sc1 lds
    s_add_u32 s80, s93, 0
    s_add_u32 m0, s80, 73728
    s_add_u32 s80, s80, s97
    buffer_load_dwordx4 v3, s[56:59], s80 offen sc1 lds
    s_add_u32 s80, s94, 0
    s_add_u32 m0, s80, 73728
    s_add_u32 s80, s80, s97
    buffer_load_dwordx4 v3, s[56:59], s80 offen sc1 lds
    s_cmp_ge_u32 s3, 4
    s_cbranch_scc1 t_no4_30
    s_add_u32 s80, s95, 0
    s_add_u32 m0, s80, 73728
    s_add_u32 s80, s80, s97
    buffer_load_dwordx4 v3, s[56:59], s80 offen sc1 lds
t_no4_30:
    s_add_u32 s80, s92, 5120
    s_add_u32 m0, s80, 73728
    s_add_u32 s80, s80, s97
    buffer_load_dwordx4 v3, s[56:59], s80 offen sc1 lds
    s_add_u32 s80, s93, 5120
    s_add_u32 m0, s80, 73728
    s_add_u32 s80, s80, s97
    buffer_load_dwordx4 v3, s[56:59], s80 offen sc1 lds
    s_add_u32 s80, s94, 5120
    s_add_u32 m0, s80, 73728
    s_add_u32 s80, s80, s97
    buffer_load_dwordx4 v3, s[56:59], s80 offen sc1 lds
    s_cmp_ge_u32 s3, 4
    s_cbranch_scc1 t_no4_31
    s_add_u32 s80, s95, 5120
    s_add_u32 m0, s80, 73728
    s_add_u32 s80, s80, s97
    buffer_load_dwordx4 v3, s[56:59], s80 offen sc1 lds
t_no4_31:
    s_cmp_lt_u32 s3, 4
    s_cbranch_scc1 t_w4_34
    s_waitcnt vmcnt(3)
    s_branch t_wd_35
t_w4_34:
    s_waitcnt vmcnt(4)
t_wd_35:
    s_add_u32 s80, s86, 73728
    v_add_u32 v1, s80, v3
    v_add_u32 v2, 40960, v1
    s_barrier
    s_cmp_eq_u32 s85, 0
    s_cbranch_scc1 t_skip_32
    ds_read_b128 v[64:67], v1 offset:0
    ds_read_b128 v[68:71], v2 offset:0
    ds_read_b128 v[72:75], v1 offset:1024
    ds_read_b128 v[76:79], v2 offset:1024
    ds_read_b128 v[80:83], v1 offset:2048
    ds_read_b128 v[84:87], v2 offset:2048
    ds_read_b128 v[88:91], v1 offset:3072
    ds_read_b128 v[92:95], v2 offset:3072
    s_waitcnt lgkmcnt(6)
    v_mfma_f32_32x32x16_bf16 v[32:47], v[104:107], v[64:67], 0
    v_mfma_f32_32x32x16_bf16 v[48:63], v[104:107], v[68:71], 0
    ds_read_b128 v[64:67], v1 offset:4096
    ds_read_b128 v[68:71], v2 offset:4096
    s_waitcnt lgkmcnt(6)
    v_mfma_f32_32x32x16_bf16 v[32:47], v[108:111], v[72:75], v[32:47]
    v_mfma_f32_32x32x16_bf16 v[48:63], v[108:111], v[76:79], v[48:63]
    s_waitcnt lgkmcnt(4)
    v_mfma_f32_32x32x16_bf16 v[32:47], v[112:115], v[80:83], v[32:47]
    v_mfma_f32_32x32x16_bf16 v[48:63], v[112:115], v[84:87], v[48:63]
    s_waitcnt lgkmcnt(2)
    v_mfma_f32_32x32x16_bf16 v[32:47], v[116:119], v[88:91], v[32:47]
    v_mfma_f32_32x32x16_bf16 v[48:63], v[116:119], v[92:95], v[48:63]
    s_waitcnt lgkmcnt(0)
    v_mfma_f32_32x32x16_bf16 v[32:47], v[120:123], v[64:67], v[32:47]
    v_mfma_f32_32x32x16_bf16 v[48:63], v[120:123], v[68:71], v[48:63]
    s_waitcnt vmcnt(0)
    s_barrier
    ds_read_b128 v[72:75], v1 offset:5120
    ds_read_b128 v[76:79], v2 offset:5120
    ds_read_b128 v[80:83], v1 offset:6144
    ds_read_b128 v[84:87], v2 offset:6144
    ds_read_b128 v[88:91], v1 offset:7168
    ds_read_b128 v[92:95], v2 offset:7168
    ds_read_b128 v[64:67], v1 offset:8192
    ds_read_b128 v[68:71], v2 offset:8192
    s_waitcnt lgkmcnt(6)
    v_mfma_f32_32x32x16_bf16 v[32:47], v[124:127], v[72:75], v[32:47]
    v_mfma_f32_32x32x16_bf16 v[48:63], v[124:127], v[76:79], v[48:63]
    ds_read_b128 v[72:75], v1 offset:9216
    ds_read_b128 v[76:79], v2 offset:9216
    s_waitcnt lgkmcnt(6)
    v_mfma_f32_32x32x16_bf16 v[32:47], v[128:131], v[80:83], v[32:47]
    v_mfma_f32_32x32x16_bf16 v[48:63], v[128:131], v[84:87], v[48:63]
    s_waitcnt lgkmcnt(4)
    v_mfma_f32_32x32x16_bf16 v[32:47], v[132:135], v[88:91], v[32:47]
    v_mfma_f32_32x32x16_bf16 v[48:63], v[132:135], v[92:95], v[48:63]
    s_waitcnt lgkmcnt(2)
    v_mfma_f32_32x32x16_bf16 v[32:47], v[136:139], v[64:67], v[32:47]
    v_mfma_f32_32x32x16_bf16 v[48:63], v[136:139], v[68:71], v[48:63]
    s_waitcnt lgkmcnt(0)
    v_mfma_f32_32x32x16_bf16 v[32:47], v[140:143], v[72:75], v[32:47]
    v_mfma_f32_32x32x16_bf16 v[48:63], v[140:143], v[76:79], v[48:63]
    s_barrier
    s_lshl_b32 s80, s3, 13
    v_add_u32 v1, s80, v3
    s_nop 7
    ds_write_b128 v1, v[32:35] offset:0
    ds_write_b128 v1, v[36:39] offset:1024
    ds_write_b128 v1, v[40:43] offset:2048
    ds_write_b128 v1, v[44:47] offset:3072
    ds_write_b128 v1, v[48:51] offset:4096
    ds_write_b128 v1, v[52:55] offset:5120
    ds_write_b128 v1, v[56:59] offset:6144
    ds_write_b128 v1, v[60:63] offset:7168
    s_waitcnt lgkmcnt(0)
    s_branch t_done_33
t_skip_32:
    s_waitcnt vmcnt(0)
    s_barrier
    s_barrier
t_done_33:
    s_barrier
    s_endpgm
parallel_sum__grouped_kv_mqa__dense_activation_silu__prompt_kernel_ffn:
    s_sub_u32 s6, s3, 8
    s_setprio 3
    s_add_u32 s28, s20, 3145728
    s_addc_u32 s29, s21, 0
    s_mov_b32 s30, 262144
    s_mov_b32 s31, 0x20000
    s_mov_b32 s36, s20
    s_mov_b32 s37, s21
    s_mov_b32 s38, 28311552
    s_mov_b32 s39, 0x20000
    s_mov_b32 s24, s16
    s_mov_b32 s25, s17
    s_mov_b32 s26, 2211840
    s_mov_b32 s27, 0x20000
    v_mov_b32 v8, v3
    s_mov_b32 s48, 0
    s_mov_b32 s49, 0
    s_cmp_lt_u32 s6, 2
    s_cbranch_scc1 h_kvw_36
    s_mov_b32 s32, s8
    s_mov_b32 s33, s9
    s_mov_b32 s34, 819200
    s_mov_b32 s35, 0x20000
    s_cmp_eq_u32 s6, 3
    s_cbranch_scc1 h_w3_38
    s_cmp_ge_u32 s2, 216
    s_cbranch_scc1 h_jo_40
    s_mov_b32 s24, s16
    s_mov_b32 s25, s17
    s_mov_b32 s26, 2211840
    s_mov_b32 s27, 0x20000
    s_mul_hi_u32 s54, s2, 159072863
    s_mul_i32 s55, s54, 27
    s_sub_u32 s55, s2, s55
    s_mov_b32 s48, 3456
    s_mul_i32 s49, s54, 276480
    s_lshl_b32 s43, s55, 7
    s_add_u32 s49, s49, s43
    s_mul_i32 s50, s55, 81920
    s_mul_i32 s43, s54, 5120
    s_add_u32 s50, s50, s43
    s_add_u32 s50, s50, 6291456
    s_branch h_jg_41
h_jo_40:
    s_mov_b32 s24, s14
    s_mov_b32 s25, s15
    s_mov_b32 s26, 819200
    s_mov_b32 s27, 0x20000
    s_sub_u32 s42, s2, 216
    s_mul_hi_u32 s54, s42, 429496730
    s_mul_i32 s55, s54, 10
    s_sub_u32 s55, s42, s55
    s_mov_b32 s48, 1280
    s_mul_i32 s49, s54, 102400
    s_lshl_b32 s43, s55, 7
    s_add_u32 s49, s49, s43
    s_mul_i32 s50, s55, 81920
    s_mul_i32 s43, s54, 5120
    s_add_u32 s50, s50, s43
    s_add_u32 s50, s50, 12582912
h_jg_41:
    v_lshrrev_b32 v4, 3, v0
    v_mul_lo_u32 v4, v4, s48
    v_and_b32 v5, 7, v0
    v_lshl_add_u32 v4, v5, 4, v4
    v_mov_b32 v8, v4
    s_branch h_wq_39
h_w3_38:
    s_cmp_lg_u32 s2, 0
    s_cbranch_scc1 h_wq_39
    s_memrealtime s[54:55]
    s_waitcnt lgkmcnt(0)
    s_or_b32 s54, s54, 1
    v_mov_b32 v4, 0
    v_mov_b32 v5, s54
    s_mov_b64 exec, 1
    global_store_dword v4, v5, s[90:91] sc1
    s_mov_b64 exec, -1
h_wq_39:
    s_sub_u32 s56, s6, 2
    v_mul_u32_u24 v4, 26, v0
    v_lshrrev_b32 v4, 8, v4
    v_mul_u32_u24 v5, 10, v4
    v_sub_u32 v5, v0, v5
    v_mul_u32_u24 v4, 1280, v4
    v_lshl_add_u32 v148, v5, 4, v4
    s_mul_i32 s57, s4, 160
    s_mul_i32 s58, s56, 409600
    s_add_u32 s58, s58, s57
    s_mul_i32 s59, s56, 10240
    s_mov_b32 s76, -1
    s_mov_b32 s77, 0x0fffffff
    s_mov_b32 s78, -1
    s_mov_b32 s79, 0xff
    s_barrier
    s_add_u32 s41, s58, 0
    s_mov_b64 exec, s[76:77]
    s_add_u32 m0, s59, 110080
    s_nop 0
    buffer_load_dwordx4 v148, s[32:35], s41 offen lds
    s_add_u32 s41, s41, 7680
    s_add_u32 m0, s59, 111040
    s_nop 0
    buffer_load_dwordx4 v148, s[32:35], s41 offen lds
    s_add_u32 s41, s41, 7680
    s_add_u32 m0, s59, 112000
    s_nop 0
    buffer_load_dwordx4 v148, s[32:35], s41 offen lds
    s_add_u32 s41, s41, 7680
    s_add_u32 m0, s59, 112960
    s_nop 0
    buffer_load_dwordx4 v148, s[32:35], s41 offen lds
    s_add_u32 s41, s41, 7680
    s_add_u32 m0, s59, 113920
    s_nop 0
    buffer_load_dwordx4 v148, s[32:35], s41 offen lds
    s_add_u32 s41, s41, 7680
    s_add_u32 m0, s59, 114880
    s_nop 0
    buffer_load_dwordx4 v148, s[32:35], s41 offen lds
    s_add_u32 s41, s41, 7680
    s_add_u32 m0, s59, 115840
    s_nop 0
    buffer_load_dwordx4 v148, s[32:35], s41 offen lds
    s_add_u32 s41, s41, 7680
    s_add_u32 m0, s59, 116800
    s_nop 0
    buffer_load_dwordx4 v148, s[32:35], s41 offen lds
    s_add_u32 s41, s41, 7680
    s_add_u32 m0, s59, 117760
    s_nop 0
    buffer_load_dwordx4 v148, s[32:35], s41 offen lds
    s_add_u32 s41, s41, 7680
    s_add_u32 m0, s59, 118720
    s_nop 0
    buffer_load_dwordx4 v148, s[32:35], s41 offen lds
    s_add_u32 s41, s41, 7680
    s_mov_b64 exec, s[78:79]
    s_add_u32 m0, s59, 119680
    s_nop 0
    buffer_load_dwordx4 v148, s[32:35], s41 offen lds
    s_mov_b64 exec, -1
    s_add_u32 s41, s58, 81920
    s_mov_b64 exec, s[76:77]
    s_add_u32 m0, s59, 130560
    s_nop 0
    buffer_load_dwordx4 v148, s[32:35], s41 offen lds
    s_add_u32 s41, s41, 7680
    s_add_u32 m0, s59, 131520
    s_nop 0
    buffer_load_dwordx4 v148, s[32:35], s41 offen lds
    s_add_u32 s41, s41, 7680
    s_add_u32 m0, s59, 132480
    s_nop 0
    buffer_load_dwordx4 v148, s[32:35], s41 offen lds
    s_add_u32 s41, s41, 7680
    s_add_u32 m0, s59, 133440
    s_nop 0
    buffer_load_dwordx4 v148, s[32:35], s41 offen lds
    s_add_u32 s41, s41, 7680
    s_add_u32 m0, s59, 134400
    s_nop 0
    buffer_load_dwordx4 v148, s[32:35], s41 offen lds
    s_add_u32 s41, s41, 7680
    s_add_u32 m0, s59, 135360
    s_nop 0
    buffer_load_dwordx4 v148, s[32:35], s41 offen lds
    s_add_u32 s41, s41, 7680
    s_add_u32 m0, s59, 136320
    s_nop 0
    buffer_load_dwordx4 v148, s[32:35], s41 offen lds
    s_add_u32 s41, s41, 7680
    s_add_u32 m0, s59, 137280
    s_nop 0
    buffer_load_dwordx4 v148, s[32:35], s41 offen lds
    s_add_u32 s41, s41, 7680
    s_add_u32 m0, s59, 138240
    s_nop 0
    buffer_load_dwordx4 v148, s[32:35], s41 offen lds
    s_add_u32 s41, s41, 7680
    s_add_u32 m0, s59, 139200
    s_nop 0
    buffer_load_dwordx4 v148, s[32:35], s41 offen lds
    s_add_u32 s41, s41, 7680
    s_mov_b64 exec, s[78:79]
    s_add_u32 m0, s59, 140160
    s_nop 0
    buffer_load_dwordx4 v148, s[32:35], s41 offen lds
    s_mov_b64 exec, -1
    s_cmp_eq_u32 s6, 3
    s_cbranch_scc1 h_w3b_42
    s_lshl_b32 s43, s48, 3
    s_mov_b32 m0, 151040
    s_nop 0
    buffer_load_dwordx4 v8, s[24:27], s49 offen lds
    s_add_u32 s49, s49, s43
    s_mov_b32 m0, 152064
    s_nop 0
    buffer_load_dwordx4 v8, s[24:27], s49 offen lds
    s_add_u32 s49, s49, s43
    s_mov_b32 m0, 153088
    s_nop 0
    buffer_load_dwordx4 v8, s[24:27], s49 offen lds
    s_add_u32 s49, s49, s43
    s_mov_b32 m0, 154112
    s_nop 0
    buffer_load_dwordx4 v8, s[24:27], s49 offen lds
    s_add_u32 s49, s49, s43
    s_mov_b32 m0, 155136
    s_nop 0
    buffer_load_dwordx4 v8, s[24:27], s49 offen lds
    s_add_u32 s49, s49, s43
    s_mov_b32 m0, 156160
    s_nop 0
    buffer_load_dwordx4 v8, s[24:27], s49 offen lds
    s_add_u32 s49, s49, s43
    s_mov_b32 m0, 157184
    s_nop 0
    buffer_load_dwordx4 v8, s[24:27], s49 offen lds
    s_add_u32 s49, s49, s43
    s_mov_b32 m0, 158208
    s_nop 0
    buffer_load_dwordx4 v8, s[24:27], s49 offen lds
    s_add_u32 s49, s49, s43
    s_mov_b32 m0, 159232
    s_nop 0
    buffer_load_dwordx4 v8, s[24:27], s49 offen lds
    s_add_u32 s49, s49, s43
    s_mov_b32 m0, 160256
    s_nop 0
    buffer_load_dwordx4 v8, s[24:27], s49 offen lds
    s_add_u32 s49, s49, s43
    s_sub_u32 s83, s2, 220
    s_cmp_ge_u32 s2, 220
    s_cselect_b32 s83, s83, s2
    s_cmp_ge_u32 s83, 180
    s_cbranch_scc1 h_j2o_44
    s_mul_hi_u32 s80, s83, 429496730
    s_mul_i32 s81, s80, 10
    s_sub_u32 s81, s83, s81
    s_mul_i32 s92, s80, 122880
    s_lshl_b32 s82, s81, 7
    s_add_u32 s92, s92, s82
    s_mul_i32 s93, s81, 221184
    s_mul_i32 s82, s80, 6144
    s_add_u32 s93, s93, s82
    s_add_u32 s93, s93, 9437184
    s_mov_b32 s94, 110592
    s_mov_b32 s95, 4
    s_movk_i32 s99, 1024
    s_branch h_j2g_45
h_j2o_44:
    s_sub_u32 s83, s83, 180
    s_mul_hi_u32 s80, s83, 429496730
    s_mul_i32 s81, s80, 10
    s_sub_u32 s81, s83, s81
    s_mul_i32 s80, s80, 5
    s_add_u32 s80, s80, 20
    s_min_u32 s80, s80, 34
    s_mul_i32 s92, s80, 20480
    s_lshl_b32 s82, s81, 7
    s_add_u32 s92, s92, s82
    s_mul_i32 s93, s81, 81920
    s_lshl_b32 s82, s80, 10
    s_add_u32 s93, s93, s82
    s_add_u32 s93, s93, 12582912
    s_mov_b32 s94, 40960
    s_mov_b32 s95, 8
    s_movk_i32 s99, 512
h_j2g_45:
    v_lshrrev_b32 v5, 5, v0
    v_mul_lo_u32 v5, v5, 8
    v_and_b32 v6, 15, v0
    v_lshrrev_b32 v7, 2, v6
    v_add_u32 v5, v5, v7
    v_lshlrev_b32 v5, 7, v5
    v_bfe_u32 v7, v0, 4, 1
    v_lshl_add_u32 v5, v7, 5, v5
    v_and_b32 v7, 3, v6
    v_lshl_add_u32 v5, v7, 3, v5
    v_add_u32 v5, 151040, v5
    v_add_u32 v6, 512, v5
    s_waitcnt vmcnt(21)
    s_barrier
    s_waitcnt vmcnt(0)
    ds_read_b64_tr_b16 v[16:17], v5 offset:0
    ds_read_b64_tr_b16 v[18:19], v6 offset:0
    ds_read_b64_tr_b16 v[20:21], v5 offset:2048
    ds_read_b64_tr_b16 v[22:23], v6 offset:2048
    ds_read_b64_tr_b16 v[24:25], v5 offset:4096
    ds_read_b64_tr_b16 v[26:27], v6 offset:4096
    ds_read_b64_tr_b16 v[28:29], v5 offset:6144
    ds_read_b64_tr_b16 v[30:31], v6 offset:6144
    ds_read_b64_tr_b16 v[32:33], v5 offset:8192
    ds_read_b64_tr_b16 v[34:35], v6 offset:8192
    s_waitcnt lgkmcnt(0)
    s_add_u32 s42, s50, 0
    buffer_store_dwordx4 v[16:19], v3, s[36:39], s42 offen sc1
    s_add_u32 s42, s50, 1024
    buffer_store_dwordx4 v[20:23], v3, s[36:39], s42 offen sc1
    s_add_u32 s42, s50, 2048
    buffer_store_dwordx4 v[24:27], v3, s[36:39], s42 offen sc1
    s_add_u32 s42, s50, 3072
    buffer_store_dwordx4 v[28:31], v3, s[36:39], s42 offen sc1
    s_add_u32 s42, s50, 4096
    buffer_store_dwordx4 v[32:35], v3, s[36:39], s42 offen sc1
    ds_read_b64_tr_b16 v[36:37], v5 offset:64
    ds_read_b64_tr_b16 v[38:39], v6 offset:64
    ds_read_b64_tr_b16 v[40:41], v5 offset:2112
    ds_read_b64_tr_b16 v[42:43], v6 offset:2112
    ds_read_b64_tr_b16 v[44:45], v5 offset:4160
    ds_read_b64_tr_b16 v[46:47], v6 offset:4160
    ds_read_b64_tr_b16 v[48:49], v5 offset:6208
    ds_read_b64_tr_b16 v[50:51], v6 offset:6208
    ds_read_b64_tr_b16 v[52:53], v5 offset:8256
    ds_read_b64_tr_b16 v[54:55], v6 offset:8256
    s_waitcnt lgkmcnt(0)
    s_add_u32 s42, s50, 40960
    buffer_store_dwordx4 v[36:39], v3, s[36:39], s42 offen sc1
    s_add_u32 s42, s50, 41984
    buffer_store_dwordx4 v[40:43], v3, s[36:39], s42 offen sc1
    s_add_u32 s42, s50, 43008
    buffer_store_dwordx4 v[44:47], v3, s[36:39], s42 offen sc1
    s_add_u32 s42, s50, 44032
    buffer_store_dwordx4 v[48:51], v3, s[36:39], s42 offen sc1
    s_add_u32 s42, s50, 45056
    buffer_store_dwordx4 v[52:55], v3, s[36:39], s42 offen sc1
    s_branch h_bln_43
h_w3b_42:
    s_sub_u32 s83, s2, 220
    s_cmp_ge_u32 s2, 220
    s_cselect_b32 s83, s83, s2
    s_cmp_ge_u32 s83, 180
    s_cbranch_scc1 h_j2o_46
    s_mul_hi_u32 s80, s83, 429496730
    s_mul_i32 s81, s80, 10
    s_sub_u32 s81, s83, s81
    s_mul_i32 s92, s80, 122880
    s_lshl_b32 s82, s81, 7
    s_add_u32 s92, s92, s82
    s_mul_i32 s93, s81, 221184
    s_mul_i32 s82, s80, 6144
    s_add_u32 s93, s93, s82
    s_add_u32 s93, s93, 9437184
    s_mov_b32 s94, 110592
    s_mov_b32 s95, 4
    s_movk_i32 s99, 1024
    s_branch h_j2g_47
h_j2o_46:
    s_sub_u32 s83, s83, 180
    s_mul_hi_u32 s80, s83, 429496730
    s_mul_i32 s81, s80, 10
    s_sub_u32 s81, s83, s81
    s_mul_i32 s80, s80, 5
    s_add_u32 s80, s80, 20
    s_min_u32 s80, s80, 34
    s_mul_i32 s92, s80, 20480
    s_lshl_b32 s82, s81, 7
    s_add_u32 s92, s92, s82
    s_mul_i32 s93, s81, 81920
    s_lshl_b32 s82, s80, 10
    s_add_u32 s93, s93, s82
    s_add_u32 s93, s93, 12582912
    s_mov_b32 s94, 40960
    s_mov_b32 s95, 8
    s_movk_i32 s99, 512
h_j2g_47:
    s_waitcnt vmcnt(11)
    s_barrier
    s_mov_b32 s42, 0x8000
    v_mov_b32 v4, 0
h_np_48:
    global_load_dword v5, v4, s[90:91] sc1
    s_waitcnt vmcnt(0)
    v_readfirstlane_b32 s43, v5
    s_sub_u32 s42, s42, 1
    s_cmp_lg_u32 s43, 0
    s_cbranch_scc1 h_npd_49
    s_cmp_eq_u32 s42, 0
    s_cbranch_scc1 h_npd_49
    s_sleep 1
    s_branch h_np_48
h_npd_49:
    v_mov_b32 v4, 163824
    ds_write_b32 v4, v5
    s_waitcnt lgkmcnt(0)
h_bln_43:
    s_barrier
    s_add_u32 s41, s58, 163840
    s_mov_b64 exec, s[76:77]
    s_add_u32 m0, s59, 110080
    s_nop 0
    buffer_load_dwordx4 v148, s[32:35], s41 offen lds
    s_add_u32 s41, s41, 7680
    s_add_u32 m0, s59, 111040
    s_nop 0
    buffer_load_dwordx4 v148, s[32:35], s41 offen lds
    s_add_u32 s41, s41, 7680
    s_add_u32 m0, s59, 112000
    s_nop 0
    buffer_load_dwordx4 v148, s[32:35], s41 offen lds
    s_add_u32 s41, s41, 7680
    s_add_u32 m0, s59, 112960
    s_nop 0
    buffer_load_dwordx4 v148, s[32:35], s41 offen lds
    s_add_u32 s41, s41, 7680
    s_add_u32 m0, s59, 113920
    s_nop 0
    buffer_load_dwordx4 v148, s[32:35], s41 offen lds
    s_add_u32 s41, s41, 7680
    s_add_u32 m0, s59, 114880
    s_nop 0
    buffer_load_dwordx4 v148, s[32:35], s41 offen lds
    s_add_u32 s41, s41, 7680
    s_add_u32 m0, s59, 115840
    s_nop 0
    buffer_load_dwordx4 v148, s[32:35], s41 offen lds
    s_add_u32 s41, s41, 7680
    s_add_u32 m0, s59, 116800
    s_nop 0
    buffer_load_dwordx4 v148, s[32:35], s41 offen lds
    s_add_u32 s41, s41, 7680
    s_add_u32 m0, s59, 117760
    s_nop 0
    buffer_load_dwordx4 v148, s[32:35], s41 offen lds
    s_add_u32 s41, s41, 7680
    s_add_u32 m0, s59, 118720
    s_nop 0
    buffer_load_dwordx4 v148, s[32:35], s41 offen lds
    s_add_u32 s41, s41, 7680
    s_mov_b64 exec, s[78:79]
    s_add_u32 m0, s59, 119680
    s_nop 0
    buffer_load_dwordx4 v148, s[32:35], s41 offen lds
    s_mov_b64 exec, -1
    s_add_u32 s41, s58, 245760
    s_mov_b64 exec, s[76:77]
    s_add_u32 m0, s59, 84480
    s_nop 0
    buffer_load_dwordx4 v148, s[32:35], s41 offen lds
    s_add_u32 s41, s41, 7680
    s_add_u32 m0, s59, 85440
    s_nop 0
    buffer_load_dwordx4 v148, s[32:35], s41 offen lds
    s_add_u32 s41, s41, 7680
    s_add_u32 m0, s59, 86400
    s_nop 0
    buffer_load_dwordx4 v148, s[32:35], s41 offen lds
    s_add_u32 s41, s41, 7680
    s_add_u32 m0, s59, 87360
    s_nop 0
    buffer_load_dwordx4 v148, s[32:35], s41 offen lds
    s_add_u32 s41, s41, 7680
    s_add_u32 m0, s59, 88320
    s_nop 0
    buffer_load_dwordx4 v148, s[32:35], s41 offen lds
    s_add_u32 s41, s41, 7680
    s_add_u32 m0, s59, 89280
    s_nop 0
    buffer_load_dwordx4 v148, s[32:35], s41 offen lds
    s_add_u32 s41, s41, 7680
    s_add_u32 m0, s59, 90240
    s_nop 0
    buffer_load_dwordx4 v148, s[32:35], s41 offen lds
    s_add_u32 s41, s41, 7680
    s_add_u32 m0, s59, 91200
    s_nop 0
    buffer_load_dwordx4 v148, s[32:35], s41 offen lds
    s_add_u32 s41, s41, 7680
    s_add_u32 m0, s59, 92160
    s_nop 0
    buffer_load_dwordx4 v148, s[32:35], s41 offen lds
    s_add_u32 s41, s41, 7680
    s_add_u32 m0, s59, 93120
    s_nop 0
    buffer_load_dwordx4 v148, s[32:35], s41 offen lds
    s_add_u32 s41, s41, 7680
    s_mov_b64 exec, s[78:79]
    s_add_u32 m0, s59, 94080
    s_nop 0
    buffer_load_dwordx4 v148, s[32:35], s41 offen lds
    s_mov_b64 exec, -1
    v_mov_b32 v4, 163824
    ds_read_b32 v5, v4
    s_waitcnt lgkmcnt(0)
    v_readfirstlane_b32 s98, v5
    s_waitcnt vmcnt(11)
    s_barrier
    s_add_u32 s41, s58, 327680
    s_mov_b64 exec, s[76:77]
    s_add_u32 m0, s59, 130560
    s_nop 0
    buffer_load_dwordx4 v148, s[32:35], s41 offen lds
    s_add_u32 s41, s41, 7680
    s_add_u32 m0, s59, 131520
    s_nop 0
    buffer_load_dwordx4 v148, s[32:35], s41 offen lds
    s_add_u32 s41, s41, 7680
    s_add_u32 m0, s59, 132480
    s_nop 0
    buffer_load_dwordx4 v148, s[32:35], s41 offen lds
    s_add_u32 s41, s41, 7680
    s_add_u32 m0, s59, 133440
    s_nop 0
    buffer_load_dwordx4 v148, s[32:35], s41 offen lds
    s_add_u32 s41, s41, 7680
    s_add_u32 m0, s59, 134400
    s_nop 0
    buffer_load_dwordx4 v148, s[32:35], s41 offen lds
    s_add_u32 s41, s41, 7680
    s_add_u32 m0, s59, 135360
    s_nop 0
    buffer_load_dwordx4 v148, s[32:35], s41 offen lds
    s_add_u32 s41, s41, 7680
    s_add_u32 m0, s59, 136320
    s_nop 0
    buffer_load_dwordx4 v148, s[32:35], s41 offen lds
    s_add_u32 s41, s41, 7680
    s_add_u32 m0, s59, 137280
    s_nop 0
    buffer_load_dwordx4 v148, s[32:35], s41 offen lds
    s_add_u32 s41, s41, 7680
    s_add_u32 m0, s59, 138240
    s_nop 0
    buffer_load_dwordx4 v148, s[32:35], s41 offen lds
    s_add_u32 s41, s41, 7680
    s_add_u32 m0, s59, 139200
    s_nop 0
    buffer_load_dwordx4 v148, s[32:35], s41 offen lds
    s_add_u32 s41, s41, 7680
    s_mov_b64 exec, s[78:79]
    s_add_u32 m0, s59, 140160
    s_nop 0
    buffer_load_dwordx4 v148, s[32:35], s41 offen lds
    s_mov_b64 exec, -1
    s_cmp_eq_u32 s99, 512
    s_cbranch_scc1 h_j2so_50
    s_mov_b32 s24, s18
    s_mov_b32 s25, s19
    s_mov_b32 s26, 2211840
    s_mov_b32 s27, 0x20000
    s_branch h_j2sg_51
h_j2so_50:
    s_mov_b32 s24, s14
    s_mov_b32 s25, s15
    s_mov_b32 s26, 819200
    s_mov_b32 s27, 0x20000
h_j2sg_51:
    v_lshrrev_b32 v4, 3, v0
    v_mul_u32_u24 v4, 1280, v4
    v_and_b32 v5, 7, v0
    v_lshl_add_u32 v4, v5, 4, v4
    s_mul_i32 s48, s56, 61440
    s_add_u32 s48, s48, s92
    s_mul_i32 s49, s56, 6144
    s_add_u32 m0, s49, 151040
    s_nop 0
    buffer_load_dwordx4 v4, s[24:27], s48 offen lds
    s_add_u32 s48, s48, 10240
    s_add_u32 m0, s49, 152064
    s_nop 0
    buffer_load_dwordx4 v4, s[24:27], s48 offen lds
    s_add_u32 s48, s48, 10240
    s_add_u32 m0, s49, 153088
    s_nop 0
    buffer_load_dwordx4 v4, s[24:27], s48 offen lds
    s_add_u32 s48, s48, 10240
    s_add_u32 m0, s49, 154112
    s_nop 0
    buffer_load_dwordx4 v4, s[24:27], s48 offen lds
    s_add_u32 s48, s48, 10240
    s_add_u32 m0, s49, 155136
    s_nop 0
    buffer_load_dwordx4 v4, s[24:27], s48 offen lds
    s_add_u32 s48, s48, 10240
    s_add_u32 m0, s49, 156160
    s_nop 0
    buffer_load_dwordx4 v4, s[24:27], s48 offen lds
    v_mov_b32 v4, 0
    v_mov_b32 v5, s98
    s_cmp_eq_u32 s6, 3
    s_cbranch_scc1 h_nf_52
    s_lshl_b32 s42, s2, 2
    s_add_u32 s42, s42, 3802112
    s_mov_b64 exec, 1
    buffer_store_dword v5, v4, s[36:39], s42 offen sc1
    s_mov_b64 exec, -1
    s_waitcnt vmcnt(18)
    s_barrier
    s_waitcnt vmcnt(1)
    s_barrier
    s_branch h_done_54
h_nf_52:
    s_waitcnt vmcnt(17)
    s_barrier
    s_lshl_b32 s42, s2, 2
    s_add_u32 s42, s42, 3801088
    s_mov_b64 exec, 1
    buffer_store_dword v5, v4, s[36:39], s42 offen sc1
    s_mov_b64 exec, -1
    s_waitcnt vmcnt(1)
    s_barrier
    s_branch h_done_54
h_kvw_36:
    s_and_b32 s7, s4, 1
    s_cmp_eq_u32 s7, 1
    s_cbranch_scc1 h_isv_55
    s_mov_b32 s44, s10
    s_mov_b32 s45, s11
    s_mov_b32 s46, 25600
    s_mov_b32 s47, 0x20000
    s_branch h_kv_56
h_isv_55:
    s_mov_b32 s44, s12
    s_mov_b32 s45, s13
    s_mov_b32 s46, 25600
    s_mov_b32 s47, 0x20000
h_kv_56:
    s_barrier
    s_lshr_b32 s42, s2, 3
    s_and_b32 s42, s42, 31
    s_mul_i32 s42, s42, 43
    s_lshr_b32 s42, s42, 7
    s_lshl_b32 s40, s6, 10
    s_add_u32 s43, s42, 0
    s_sub_u32 s41, s43, 12
    s_cmp_ge_u32 s43, 12
    s_cselect_b32 s43, s41, s43
    s_lshl_b32 s43, s43, 11
    s_add_u32 s41, s43, s40
    s_add_u32 m0, s41, 84480
    s_nop 0
    buffer_load_dwordx4 v3, s[44:47], s41 offen lds
    s_add_u32 s43, s42, 1
    s_sub_u32 s41, s43, 12
    s_cmp_ge_u32 s43, 12
    s_cselect_b32 s43, s41, s43
    s_lshl_b32 s43, s43, 11
    s_add_u32 s41, s43, s40
    s_add_u32 m0, s41, 84480
    s_nop 0
    buffer_load_dwordx4 v3, s[44:47], s41 offen lds
    s_add_u32 s43, s42, 2
    s_sub_u32 s41, s43, 12
    s_cmp_ge_u32 s43, 12
    s_cselect_b32 s43, s41, s43
    s_lshl_b32 s43, s43, 11
    s_add_u32 s41, s43, s40
    s_add_u32 m0, s41, 84480
    s_nop 0
    buffer_load_dwordx4 v3, s[44:47], s41 offen lds
    s_add_u32 s43, s42, 3
    s_sub_u32 s41, s43, 12
    s_cmp_ge_u32 s43, 12
    s_cselect_b32 s43, s41, s43
    s_lshl_b32 s43, s43, 11
    s_add_u32 s41, s43, s40
    s_add_u32 m0, s41, 84480
    s_nop 0
    buffer_load_dwordx4 v3, s[44:47], s41 offen lds
    s_add_u32 s43, s42, 4
    s_sub_u32 s41, s43, 12
    s_cmp_ge_u32 s43, 12
    s_cselect_b32 s43, s41, s43
    s_lshl_b32 s43, s43, 11
    s_add_u32 s41, s43, s40
    s_add_u32 m0, s41, 84480
    s_nop 0
    buffer_load_dwordx4 v3, s[44:47], s41 offen lds
    s_add_u32 s43, s42, 5
    s_sub_u32 s41, s43, 12
    s_cmp_ge_u32 s43, 12
    s_cselect_b32 s43, s41, s43
    s_lshl_b32 s43, s43, 11
    s_add_u32 s41, s43, s40
    s_add_u32 m0, s41, 84480
    s_nop 0
    buffer_load_dwordx4 v3, s[44:47], s41 offen lds
    s_add_u32 s43, s42, 6
    s_sub_u32 s41, s43, 12
    s_cmp_ge_u32 s43, 12
    s_cselect_b32 s43, s41, s43
    s_lshl_b32 s43, s43, 11
    s_add_u32 s41, s43, s40
    s_add_u32 m0, s41, 84480
    s_nop 0
    buffer_load_dwordx4 v3, s[44:47], s41 offen lds
    s_add_u32 s43, s42, 7
    s_sub_u32 s41, s43, 12
    s_cmp_ge_u32 s43, 12
    s_cselect_b32 s43, s41, s43
    s_lshl_b32 s43, s43, 11
    s_add_u32 s41, s43, s40
    s_add_u32 m0, s41, 84480
    s_nop 0
    buffer_load_dwordx4 v3, s[44:47], s41 offen lds
    s_add_u32 s43, s42, 8
    s_sub_u32 s41, s43, 12
    s_cmp_ge_u32 s43, 12
    s_cselect_b32 s43, s41, s43
    s_lshl_b32 s43, s43, 11
    s_add_u32 s41, s43, s40
    s_add_u32 m0, s41, 84480
    s_nop 0
    buffer_load_dwordx4 v3, s[44:47], s41 offen lds
    s_add_u32 s43, s42, 9
    s_sub_u32 s41, s43, 12
    s_cmp_ge_u32 s43, 12
    s_cselect_b32 s43, s41, s43
    s_lshl_b32 s43, s43, 11
    s_add_u32 s41, s43, s40
    s_add_u32 m0, s41, 84480
    s_nop 0
    buffer_load_dwordx4 v3, s[44:47], s41 offen lds
    s_add_u32 s43, s42, 10
    s_sub_u32 s41, s43, 12
    s_cmp_ge_u32 s43, 12
    s_cselect_b32 s43, s41, s43
    s_lshl_b32 s43, s43, 11
    s_add_u32 s41, s43, s40
    s_add_u32 m0, s41, 84480
    s_nop 0
    buffer_load_dwordx4 v3, s[44:47], s41 offen lds
    s_add_u32 s43, s42, 11
    s_sub_u32 s41, s43, 12
    s_cmp_ge_u32 s43, 12
    s_cselect_b32 s43, s41, s43
    s_lshl_b32 s43, s43, 11
    s_add_u32 s41, s43, s40
    s_add_u32 m0, s41, 84480
    s_nop 0
    buffer_load_dwordx4 v3, s[44:47], s41 offen lds
    s_cmp_lg_u32 s6, 0
    s_cbranch_scc1 h_no24_57
    s_mov_b32 m0, 109056
    s_movk_i32 s41, 24576
    buffer_load_dwordx4 v3, s[44:47], s41 offen lds
h_no24_57:
    s_sub_u32 s83, s2, 220
    s_cmp_ge_u32 s2, 220
    s_cselect_b32 s83, s83, s2
    s_cmp_ge_u32 s83, 180
    s_cbranch_scc1 h_j2o_58
    s_mul_hi_u32 s80, s83, 429496730
    s_mul_i32 s81, s80, 10
    s_sub_u32 s81, s83, s81
    s_mul_i32 s92, s80, 122880
    s_lshl_b32 s82, s81, 7
    s_add_u32 s92, s92, s82
    s_mul_i32 s93, s81, 221184
    s_mul_i32 s82, s80, 6144
    s_add_u32 s93, s93, s82
    s_add_u32 s93, s93, 9437184
    s_mov_b32 s94, 110592
    s_mov_b32 s95, 4
    s_movk_i32 s99, 1024
    s_branch h_j2g_59
h_j2o_58:
    s_sub_u32 s83, s83, 180
    s_mul_hi_u32 s80, s83, 429496730
    s_mul_i32 s81, s80, 10
    s_sub_u32 s81, s83, s81
    s_mul_i32 s80, s80, 5
    s_add_u32 s80, s80, 20
    s_min_u32 s80, s80, 34
    s_mul_i32 s92, s80, 20480
    s_lshl_b32 s82, s81, 7
    s_add_u32 s92, s92, s82
    s_mul_i32 s93, s81, 81920
    s_lshl_b32 s82, s80, 10
    s_add_u32 s93, s93, s82
    s_add_u32 s93, s93, 12582912
    s_mov_b32 s94, 40960
    s_mov_b32 s95, 8
    s_movk_i32 s99, 512
h_j2g_59:
    s_lshr_b32 s48, s4, 1
    v_lshrrev_b32 v4, 4, v0
    v_and_b32 v5, 15, v0
    s_and_b32 s49, s48, 1
    s_lshl_b32 s50, s49, 4
    v_add_u32 v6, s50, v5
    v_mul_u32_u24 v1, 528, v4
    v_lshl_add_u32 v1, v6, 4, v1
    s_lshr_b32 s51, s48, 1
    s_mul_i32 s51, s51, 42240
    v_add_u32 v1, s51, v1
    v_lshrrev_b32 v2, 2, v5
    v_lshl_add_u32 v2, v4, 3, v2
    v_mul_u32_u24 v2, 40, v2
    v_and_b32 v7, 3, v5
    v_lshl_add_u32 v2, v7, 3, v2
    s_lshl_b32 s51, s6, 5
    s_add_u32 s51, s51, 84480
    v_add_u32 v2, s51, v2
    s_lshl_b32 s52, s5, 1
    s_lshr_b32 s53, s48, 1
    s_add_u32 s52, s52, s53
    s_lshl_b32 s52, s52, 12
    s_add_u32 s52, s52, 3145728
    s_lshl_b32 s53, s5, 2
    s_add_u32 s53, s53, s48
    s_waitcnt vmcnt(0)
    s_barrier
    ds_read_b128 v[4:7], v1 offset:0
    ds_read_b64_tr_b16 v[84:85], v2 offset:0
    ds_read_b64_tr_b16 v[86:87], v2 offset:160
    ds_read_b128 v[8:11], v1 offset:2112
    ds_read_b64_tr_b16 v[88:89], v2 offset:1280
    ds_read_b64_tr_b16 v[90:91], v2 offset:1440
    ds_read_b128 v[12:15], v1 offset:4224
    ds_read_b64_tr_b16 v[92:93], v2 offset:2560
    ds_read_b64_tr_b16 v[94:95], v2 offset:2720
    ds_read_b128 v[16:19], v1 offset:6336
    ds_read_b64_tr_b16 v[96:97], v2 offset:3840
    ds_read_b64_tr_b16 v[98:99], v2 offset:4000
    s_waitcnt lgkmcnt(3)
    ds_read_b128 v[20:23], v1 offset:8448
    ds_read_b64_tr_b16 v[100:101], v2 offset:5120
    ds_read_b64_tr_b16 v[102:103], v2 offset:5280
    ds_read_b128 v[24:27], v1 offset:10560
    ds_read_b64_tr_b16 v[104:105], v2 offset:6400
    ds_read_b64_tr_b16 v[106:107], v2 offset:6560
    ds_read_b128 v[28:31], v1 offset:12672
    ds_read_b64_tr_b16 v[108:109], v2 offset:7680
    ds_read_b64_tr_b16 v[110:111], v2 offset:7840
    ds_read_b128 v[32:35], v1 offset:14784
    ds_read_b64_tr_b16 v[112:113], v2 offset:8960
    ds_read_b64_tr_b16 v[114:115], v2 offset:9120
    s_waitcnt lgkmcnt(3)
    ds_read_b128 v[36:39], v1 offset:16896
    ds_read_b64_tr_b16 v[116:117], v2 offset:10240
    ds_read_b64_tr_b16 v[118:119], v2 offset:10400
    ds_read_b128 v[40:43], v1 offset:19008
    ds_read_b64_tr_b16 v[120:121], v2 offset:11520
    ds_read_b64_tr_b16 v[122:123], v2 offset:11680
    ds_read_b128 v[44:47], v1 offset:21120
    ds_read_b64_tr_b16 v[124:125], v2 offset:12800
    ds_read_b64_tr_b16 v[126:127], v2 offset:12960
    ds_read_b128 v[48:51], v1 offset:23232
    ds_read_b64_tr_b16 v[128:129], v2 offset:14080
    ds_read_b64_tr_b16 v[130:131], v2 offset:14240
    s_waitcnt lgkmcnt(3)
    ds_read_b128 v[52:55], v1 offset:25344
    ds_read_b64_tr_b16 v[132:133], v2 offset:15360
    ds_read_b64_tr_b16 v[134:135], v2 offset:15520
    ds_read_b128 v[56:59], v1 offset:27456
    ds_read_b64_tr_b16 v[136:137], v2 offset:16640
    ds_read_b64_tr_b16 v[138:139], v2 offset:16800
    ds_read_b128 v[60:63], v1 offset:29568
    ds_read_b64_tr_b16 v[140:141], v2 offset:17920
    ds_read_b64_tr_b16 v[142:143], v2 offset:18080
    ds_read_b128 v[64:67], v1 offset:31680
    ds_read_b64_tr_b16 v[144:145], v2 offset:19200
    ds_read_b64_tr_b16 v[146:147], v2 offset:19360
    s_waitcnt lgkmcnt(3)
    ds_read_b128 v[68:71], v1 offset:33792
    ds_read_b64_tr_b16 v[148:149], v2 offset:20480
    ds_read_b64_tr_b16 v[150:151], v2 offset:20640
    ds_read_b128 v[72:75], v1 offset:35904
    ds_read_b64_tr_b16 v[152:153], v2 offset:21760
    ds_read_b64_tr_b16 v[154:155], v2 offset:21920
    ds_read_b128 v[76:79], v1 offset:38016
    ds_read_b64_tr_b16 v[156:157], v2 offset:23040
    ds_read_b64_tr_b16 v[158:159], v2 offset:23200
    ds_read_b128 v[80:83], v1 offset:40128
    ds_read_b64_tr_b16 v[160:161], v2 offset:24320
    ds_read_b64_tr_b16 v[162:163], v2 offset:24480
    s_waitcnt lgkmcnt(3)
    s_waitcnt lgkmcnt(0)
    s_barrier
    v_mov_b32 v1, 163824
    ds_read_b32 v2, v1
    s_cmp_eq_u32 s7, 1
    s_cbranch_scc1 h_vm_60
    v_mfma_f32_16x16x32_bf16 v[164:167], v[84:87], v[4:7], 0
    v_mfma_f32_16x16x32_bf16 v[164:167], v[88:91], v[8:11], v[164:167]
    v_mfma_f32_16x16x32_bf16 v[164:167], v[92:95], v[12:15], v[164:167]
    v_mfma_f32_16x16x32_bf16 v[164:167], v[96:99], v[16:19], v[164:167]
    v_mfma_f32_16x16x32_bf16 v[164:167], v[100:103], v[20:23], v[164:167]
    v_mfma_f32_16x16x32_bf16 v[164:167], v[104:107], v[24:27], v[164:167]
    v_mfma_f32_16x16x32_bf16 v[164:167], v[108:111], v[28:31], v[164:167]
    v_mfma_f32_16x16x32_bf16 v[164:167], v[112:115], v[32:35], v[164:167]
    v_mfma_f32_16x16x32_bf16 v[164:167], v[116:119], v[36:39], v[164:167]
    v_mfma_f32_16x16x32_bf16 v[164:167], v[120:123], v[40:43], v[164:167]
    v_mfma_f32_16x16x32_bf16 v[164:167], v[124:127], v[44:47], v[164:167]
    v_mfma_f32_16x16x32_bf16 v[164:167], v[128:131], v[48:51], v[164:167]
    v_mfma_f32_16x16x32_bf16 v[164:167], v[132:135], v[52:55], v[164:167]
    v_mfma_f32_16x16x32_bf16 v[164:167], v[136:139], v[56:59], v[164:167]
    v_mfma_f32_16x16x32_bf16 v[164:167], v[140:143], v[60:63], v[164:167]
    v_mfma_f32_16x16x32_bf16 v[164:167], v[144:147], v[64:67], v[164:167]
    v_mfma_f32_16x16x32_bf16 v[164:167], v[148:151], v[68:71], v[164:167]
    v_mfma_f32_16x16x32_bf16 v[164:167], v[152:155], v[72:75], v[164:167]
    v_mfma_f32_16x16x32_bf16 v[164:167], v[156:159], v[76:79], v[164:167]
    v_mfma_f32_16x16x32_bf16 v[164:167], v[160:163], v[80:83], v[164:167]
    s_branch h_md_61
h_vm_60:
    v_mfma_f32_16x16x32_bf16 v[164:167], v[4:7], v[84:87], 0
    v_mfma_f32_16x16x32_bf16 v[164:167], v[8:11], v[88:91], v[164:167]
    v_mfma_f32_16x16x32_bf16 v[164:167], v[12:15], v[92:95], v[164:167]
    v_mfma_f32_16x16x32_bf16 v[164:167], v[16:19], v[96:99], v[164:167]
    v_mfma_f32_16x16x32_bf16 v[164:167], v[20:23], v[100:103], v[164:167]
    v_mfma_f32_16x16x32_bf16 v[164:167], v[24:27], v[104:107], v[164:167]
    v_mfma_f32_16x16x32_bf16 v[164:167], v[28:31], v[108:111], v[164:167]
    v_mfma_f32_16x16x32_bf16 v[164:167], v[32:35], v[112:115], v[164:167]
    v_mfma_f32_16x16x32_bf16 v[164:167], v[36:39], v[116:119], v[164:167]
    v_mfma_f32_16x16x32_bf16 v[164:167], v[40:43], v[120:123], v[164:167]
    v_mfma_f32_16x16x32_bf16 v[164:167], v[44:47], v[124:127], v[164:167]
    v_mfma_f32_16x16x32_bf16 v[164:167], v[48:51], v[128:131], v[164:167]
    v_mfma_f32_16x16x32_bf16 v[164:167], v[52:55], v[132:135], v[164:167]
    v_mfma_f32_16x16x32_bf16 v[164:167], v[56:59], v[136:139], v[164:167]
    v_mfma_f32_16x16x32_bf16 v[164:167], v[60:63], v[140:143], v[164:167]
    v_mfma_f32_16x16x32_bf16 v[164:167], v[64:67], v[144:147], v[164:167]
    v_mfma_f32_16x16x32_bf16 v[164:167], v[68:71], v[148:151], v[164:167]
    v_mfma_f32_16x16x32_bf16 v[164:167], v[72:75], v[152:155], v[164:167]
    v_mfma_f32_16x16x32_bf16 v[164:167], v[76:79], v[156:159], v[164:167]
    v_mfma_f32_16x16x32_bf16 v[164:167], v[80:83], v[160:163], v[164:167]
h_md_61:
    s_waitcnt lgkmcnt(0)
    v_readfirstlane_b32 s98, v2
    v_lshrrev_b32 v88, 4, v0
    v_and_b32 v89, 15, v0
    v_add_u32 v90, s50, v89
    v_and_b32 v93, 1, v88
    v_lshrrev_b32 v94, 1, v88
    s_nop 7
    v_mul_f32 v164, 0x3f317218, v164
    v_mul_f32 v165, 0x3f317218, v165
    v_mul_f32 v166, 0x3f317218, v166
    v_mul_f32 v167, 0x3f317218, v167
    v_cvt_pk_bf16_f32 v96, v164, v165
    v_cvt_pk_bf16_f32 v97, v166, v167
    s_lshl_b32 s54, s7, 1
    s_add_u32 s54, s54, s6
    s_cmp_eq_u32 s54, 0
    s_cbranch_scc1 h_ep_62
    s_cmp_eq_u32 s54, 1
    s_cbranch_scc1 h_ep_63
    s_cmp_eq_u32 s54, 2
    s_cbranch_scc1 h_ep_64
    s_branch h_ep_65
h_ep_62:
    v_lshl_add_u32 v95, v93, 5, v90
    v_lshlrev_b32 v95, 4, v95
    v_lshl_add_u32 v95, v94, 3, v95
    buffer_store_dwordx2 v[96:97], v95, s[36:39], s52 offen sc1
    v_mul_f32 v98, v164, v164
    v_fmac_f32 v98, v165, v165
    v_fmac_f32 v98, v166, v166
    v_fmac_f32 v98, v167, v167
    v_mov_b32 v99, v98
    s_nop 1
    v_permlane32_swap_b32 v98, v99
    s_nop 1
    v_add_f32 v98, v98, v99
    v_mov_b32 v99, v98
    s_nop 1
    v_permlane16_swap_b32 v98, v99
    s_nop 1
    v_add_f32 v98, v98, v99
    s_nop 1
    v_max_f32_dpp v98, v98, v98 row_ror:8 row_mask:0xf bank_mask:0xf
    s_nop 1
    v_max_f32_dpp v98, v98, v98 row_ror:4 row_mask:0xf bank_mask:0xf
    s_nop 1
    v_max_f32_dpp v98, v98, v98 row_ror:2 row_mask:0xf bank_mask:0xf
    s_nop 1
    v_max_f32_dpp v98, v98, v98 row_ror:1 row_mask:0xf bank_mask:0xf
    s_lshl_b32 s55, s53, 3
    s_add_u32 s55, s55, 3670016
    v_mov_b32 v99, 0
    s_mov_b64 exec, 1
    buffer_store_dword v98, v99, s[36:39], s55 offen sc1
    s_mov_b64 exec, -1
    s_branch h_ep_66
h_ep_63:
    v_cmp_eq_u32 vcc, 1, v88
    v_mov_b32 v98, 0x3f803f80
    v_mov_b32 v99, 0x00003f80
    v_cndmask_b32 v96, v96, v98, vcc
    v_cndmask_b32 v97, v97, v99, vcc
    v_lshl_add_u32 v95, v88, 5, v90
    v_lshlrev_b32 v95, 3, v95
    v_add_u32 v95, 1024, v95
    v_cmp_gt_u32 vcc, 2, v88
    s_and_saveexec_b64 s[54:55], vcc
    buffer_store_dwordx2 v[96:97], v95, s[36:39], s52 offen sc1
    s_mov_b64 exec, s[54:55]
    v_mul_f32 v98, v164, v164
    v_fmac_f32 v98, v165, v165
    v_fmac_f32 v98, v166, v166
    v_fmac_f32 v98, v167, v167
    v_cmp_eq_u32 vcc, 0, v88
    s_nop 1
    v_cndmask_b32 v98, 0, v98, vcc
    v_mov_b32 v99, v98
    s_nop 1
    v_permlane32_swap_b32 v98, v99
    s_nop 1
    v_add_f32 v98, v98, v99
    v_mov_b32 v99, v98
    s_nop 1
    v_permlane16_swap_b32 v98, v99
    s_nop 1
    v_add_f32 v98, v98, v99
    s_nop 1
    v_max_f32_dpp v98, v98, v98 row_ror:8 row_mask:0xf bank_mask:0xf
    s_nop 1
    v_max_f32_dpp v98, v98, v98 row_ror:4 row_mask:0xf bank_mask:0xf
    s_nop 1
    v_max_f32_dpp v98, v98, v98 row_ror:2 row_mask:0xf bank_mask:0xf
    s_nop 1
    v_max_f32_dpp v98, v98, v98 row_ror:1 row_mask:0xf bank_mask:0xf
    s_lshl_b32 s55, s53, 3
    s_add_u32 s55, s55, 3670020
    v_mov_b32 v99, 0
    s_mov_b64 exec, 1
    buffer_store_dword v98, v99, s[36:39], s55 offen sc1
    s_mov_b64 exec, -1
    s_branch h_ep_66
h_ep_65:
    v_cmp_gt_u32 vcc, 4, v89
    s_nop 1
    v_cndmask_b32 v96, 0, v96, vcc
    v_cndmask_b32 v97, 0, v97, vcc
    v_cmp_eq_u32 vcc, 4, v89
    v_mov_b32 v98, 0x3f803f80
    s_nop 0
    v_cndmask_b32 v96, v96, v98, vcc
    v_cndmask_b32 v97, v97, v98, vcc
    v_add_u32 v89, 16, v89
h_ep_64:
    v_lshl_add_u32 v95, v93, 5, v89
    v_lshlrev_b32 v95, 4, v95
    v_lshl_add_u32 v95, v94, 3, v95
    s_lshl_b32 s55, s49, 10
    s_add_u32 s55, s55, s52
    s_add_u32 s55, s55, 2048
    buffer_store_dwordx2 v[96:97], v95, s[36:39], s55 offen sc1
h_ep_66:
    s_barrier
    s_waitcnt vmcnt(0)
    s_barrier
    s_barrier
h_done_54:
    s_setprio 0
    s_lshl_b32 s40, s6, 12
    s_add_u32 s41, s40, 84480
    s_add_u32 s44, s20, 6291456
    s_addc_u32 s45, s21, 0
    s_mov_b32 s46, 2211840
    s_mov_b32 s47, 0x20000
    s_add_u32 s48, s20, 9437184
    s_addc_u32 s49, s21, 0
    s_mov_b32 s50, 2211840
    s_mov_b32 s51, 0x20000
    s_lshr_b32 s8, s4, 1
    s_and_b32 s9, s4, 1
    s_lshl_b32 s7, s4, 2
    s_add_u32 s7, s7, s6
    s_mul_i32 s12, s8, 5
    s_mul_i32 s13, s9, 3
    s_add_u32 s12, s12, s13
    s_lshl_b32 s14, s5, 8
    s_add_u32 s14, s14, 3735552
    s_lshl_b32 s13, s7, 2
    s_add_u32 s16, s14, s13
    s_mul_i32 s17, s5, 221184
    s_add_u32 s17, s17, 16777216
    v_lshrrev_b32 v164, 5, v0
    v_mul_u32_u24 v164, 528, v164
    v_and_b32 v165, 31, v0
    v_lshl_add_u32 v164, v165, 4, v164
    v_add_u32 v165, 42240, v164
    s_cmp_eq_u32 s9, 1
    s_cbranch_scc1 parallel_sum__grouped_kv_mqa__dense_activation_silu__prompt_kernel_ffn_odd
    s_mul_i32 s18, s7, 40960
    s_lshl_b32 s13, s7, 11
    s_add_u32 s10, s17, s13
    s_lshr_b32 s13, s6, 1
    s_add_u32 s13, s13, s4
    s_add_u32 s13, s13, 48
    s_and_b32 s15, s6, 1
    s_mul_i32 s15, s15, 110592
    s_lshl_b32 s11, s13, 11
    s_add_u32 s11, s11, s17
    s_add_u32 s11, s11, s15
    s_lshl_b32 s15, s6, 11
    s_add_u32 s15, s15, 24117248
    s_cmp_eq_u32 s4, 6
    s_cselect_b32 s11, s15, s11
    s_and_b32 s15, s6, 1
    s_mul_i32 s15, s15, 42240
    v_add_u32 v166, s15, v164
    s_mul_i32 s19, s13, 40960
    v_lshrrev_b32 v144, 5, v0
    v_mul_lo_u32 v144, v144, s95
    v_and_b32 v145, 15, v0
    v_lshrrev_b32 v146, 2, v145
    v_add_u32 v144, v144, v146
    v_lshlrev_b32 v144, 7, v144
    v_bfe_u32 v146, v0, 4, 1
    v_lshl_add_u32 v144, v146, 5, v144
    v_and_b32 v146, 3, v145
    v_lshl_add_u32 v144, v146, 3, v144
    s_lshr_b32 s13, s6, 1
    s_lshl_b32 s15, s13, 6
    s_mul_i32 s13, s13, s94
    s_add_u32 s13, s13, s93
    s_and_b32 s43, s6, 1
    s_mul_i32 s43, s43, 3
    s_lshl_b32 s42, s43, 11
    s_add_u32 s15, s15, s42
    s_add_u32 s15, s15, 151040
    s_lshl_b32 s43, s43, 10
    s_add_u32 s13, s13, s43
    v_add_u32 v144, s15, v144
    v_add_u32 v145, s99, v144
    ds_read_b64_tr_b16 v[132:133], v144 offset:0
    ds_read_b64_tr_b16 v[134:135], v145 offset:0
    ds_read_b64_tr_b16 v[136:137], v144 offset:2048
    ds_read_b64_tr_b16 v[138:139], v145 offset:2048
    ds_read_b64_tr_b16 v[140:141], v144 offset:4096
    ds_read_b64_tr_b16 v[142:143], v145 offset:4096
    s_waitcnt lgkmcnt(0)
    buffer_store_dwordx4 v[132:135], v3, s[36:39], s13 offen offset:0 sc1
    buffer_store_dwordx4 v[136:139], v3, s[36:39], s13 offen offset:1024 sc1
    buffer_store_dwordx4 v[140:143], v3, s[36:39], s13 offen offset:2048 sc1
    s_barrier
    s_barrier
    s_add_u32 m0, s41, 0
    s_add_u32 s15, s40, 0
    buffer_load_dwordx4 v3, s[28:31], s15 offen offset:0 sc1 lds
    buffer_load_dwordx4 v3, s[28:31], s15 offen offset:1024 sc1 lds
    buffer_load_dwordx4 v3, s[28:31], s15 offen offset:2048 sc1 lds
    buffer_load_dwordx4 v3, s[28:31], s15 offen offset:3072 sc1 lds
    s_add_u32 m0, s41, 16384
    s_add_u32 s15, s40, 16384
    buffer_load_dwordx4 v3, s[28:31], s15 offen offset:0 sc1 lds
    buffer_load_dwordx4 v3, s[28:31], s15 offen offset:1024 sc1 lds
    buffer_load_dwordx4 v3, s[28:31], s15 offen offset:2048 sc1 lds
    buffer_load_dwordx4 v3, s[28:31], s15 offen offset:3072 sc1 lds
    buffer_load_dwordx4 v[68:71], v3, s[44:47], s18 offen offset:0 sc1
    buffer_load_dwordx4 v[72:75], v3, s[44:47], s18 offen offset:1024 sc1
    buffer_load_dwordx4 v[76:79], v3, s[44:47], s18 offen offset:2048 sc1
    buffer_load_dwordx4 v[80:83], v3, s[44:47], s18 offen offset:3072 sc1
    s_add_u32 s18, s18, 4096
    buffer_load_dwordx4 v[84:87], v3, s[44:47], s18 offen offset:0 sc1
    buffer_load_dwordx4 v[88:91], v3, s[44:47], s18 offen offset:1024 sc1
    buffer_load_dwordx4 v[92:95], v3, s[44:47], s18 offen offset:2048 sc1
    buffer_load_dwordx4 v[96:99], v3, s[44:47], s18 offen offset:3072 sc1
    ds_read_b128 v[100:103], v164 offset:0
    ds_read_b128 v[104:107], v165 offset:0
    ds_read_b128 v[108:111], v164 offset:1056
    ds_read_b128 v[112:115], v165 offset:1056
    s_waitcnt vmcnt(7) lgkmcnt(2)
    v_mfma_f32_32x32x16_bf16 v[4:19], v[68:71], v[100:103], 0
    v_mfma_f32_32x32x16_bf16 v[20:35], v[68:71], v[104:107], 0
    ds_read_b128 v[116:119], v164 offset:2112
    ds_read_b128 v[120:123], v165 offset:2112
    s_add_u32 s18, s18, 4096
    buffer_load_dwordx4 v[68:71], v3, s[44:47], s18 offen offset:0 sc1
    s_waitcnt vmcnt(7) lgkmcnt(2)
    v_mfma_f32_32x32x16_bf16 v[4:19], v[72:75], v[108:111], v[4:19]
    v_mfma_f32_32x32x16_bf16 v[20:35], v[72:75], v[112:115], v[20:35]
    ds_read_b128 v[100:103], v164 offset:3168
    ds_read_b128 v[104:107], v165 offset:3168
    buffer_load_dwordx4 v[72:75], v3, s[44:47], s18 offen offset:1024 sc1
    s_waitcnt vmcnt(7) lgkmcnt(2)
    v_mfma_f32_32x32x16_bf16 v[4:19], v[76:79], v[116:119], v[4:19]
    v_mfma_f32_32x32x16_bf16 v[20:35], v[76:79], v[120:123], v[20:35]
    ds_read_b128 v[108:111], v164 offset:4224
    ds_read_b128 v[112:115], v165 offset:4224
    buffer_load_dwordx4 v[76:79], v3, s[44:47], s18 offen offset:2048 sc1
    s_waitcnt vmcnt(7) lgkmcnt(2)
    v_mfma_f32_32x32x16_bf16 v[4:19], v[80:83], v[100:103], v[4:19]
    v_mfma_f32_32x32x16_bf16 v[20:35], v[80:83], v[104:107], v[20:35]
    ds_read_b128 v[116:119], v164 offset:5280
    ds_read_b128 v[120:123], v165 offset:5280
    buffer_load_dwordx4 v[80:83], v3, s[44:47], s18 offen offset:3072 sc1
    s_barrier
    s_add_u32 m0, s41, 32768
    s_add_u32 s15, s40, 32768
    buffer_load_dwordx4 v3, s[28:31], s15 offen offset:0 sc1 lds
    buffer_load_dwordx4 v3, s[28:31], s15 offen offset:1024 sc1 lds
    buffer_load_dwordx4 v3, s[28:31], s15 offen offset:2048 sc1 lds
    buffer_load_dwordx4 v3, s[28:31], s15 offen offset:3072 sc1 lds
    s_add_u32 m0, s41, 49152
    s_add_u32 s15, s40, 49152
    buffer_load_dwordx4 v3, s[28:31], s15 offen offset:0 sc1 lds
    buffer_load_dwordx4 v3, s[28:31], s15 offen offset:1024 sc1 lds
    buffer_load_dwordx4 v3, s[28:31], s15 offen offset:2048 sc1 lds
    buffer_load_dwordx4 v3, s[28:31], s15 offen offset:3072 sc1 lds
    s_cmp_lg_u32 s6, 3
    s_cbranch_scc1 g2f_67
    s_lshl_b32 s13, s2, 2
    s_add_u32 s13, s13, 3804160
    v_mov_b32 v162, 0
    v_mov_b32 v163, s98
    s_mov_b64 exec, 1
    buffer_store_dword v163, v162, s[36:39], s13 offen sc1
    s_mov_b64 exec, -1
g2f_67:
    s_waitcnt vmcnt(15) lgkmcnt(2)
    v_mfma_f32_32x32x16_bf16 v[4:19], v[84:87], v[108:111], v[4:19]
    v_mfma_f32_32x32x16_bf16 v[20:35], v[84:87], v[112:115], v[20:35]
    ds_read_b128 v[100:103], v164 offset:6336
    ds_read_b128 v[104:107], v165 offset:6336
    s_add_u32 s18, s18, 4096
    buffer_load_dwordx4 v[84:87], v3, s[44:47], s18 offen offset:0 sc1
    s_waitcnt vmcnt(15) lgkmcnt(2)
    v_mfma_f32_32x32x16_bf16 v[4:19], v[88:91], v[116:119], v[4:19]
    v_mfma_f32_32x32x16_bf16 v[20:35], v[88:91], v[120:123], v[20:35]
    ds_read_b128 v[108:111], v164 offset:7392
    ds_read_b128 v[112:115], v165 offset:7392
    buffer_load_dwordx4 v[88:91], v3, s[44:47], s18 offen offset:1024 sc1
    s_waitcnt vmcnt(15) lgkmcnt(2)
    v_mfma_f32_32x32x16_bf16 v[4:19], v[92:95], v[100:103], v[4:19]
    v_mfma_f32_32x32x16_bf16 v[20:35], v[92:95], v[104:107], v[20:35]
    ds_read_b128 v[116:119], v164 offset:8448
    ds_read_b128 v[120:123], v165 offset:8448
    buffer_load_dwordx4 v[92:95], v3, s[44:47], s18 offen offset:2048 sc1
    s_waitcnt vmcnt(15) lgkmcnt(2)
    v_mfma_f32_32x32x16_bf16 v[4:19], v[96:99], v[108:111], v[4:19]
    v_mfma_f32_32x32x16_bf16 v[20:35], v[96:99], v[112:115], v[20:35]
    ds_read_b128 v[100:103], v164 offset:9504
    ds_read_b128 v[104:107], v165 offset:9504
    buffer_load_dwordx4 v[96:99], v3, s[44:47], s18 offen offset:3072 sc1
    s_waitcnt vmcnt(15) lgkmcnt(2)
    v_mfma_f32_32x32x16_bf16 v[4:19], v[68:71], v[116:119], v[4:19]
    v_mfma_f32_32x32x16_bf16 v[20:35], v[68:71], v[120:123], v[20:35]
    ds_read_b128 v[108:111], v164 offset:10560
    ds_read_b128 v[112:115], v165 offset:10560
    s_add_u32 s18, s18, 4096
    buffer_load_dwordx4 v[68:71], v3, s[44:47], s18 offen offset:0 sc1
    s_waitcnt vmcnt(15) lgkmcnt(2)
    v_mfma_f32_32x32x16_bf16 v[4:19], v[72:75], v[100:103], v[4:19]
    v_mfma_f32_32x32x16_bf16 v[20:35], v[72:75], v[104:107], v[20:35]
    ds_read_b128 v[116:119], v164 offset:11616
    ds_read_b128 v[120:123], v165 offset:11616
    buffer_load_dwordx4 v[72:75], v3, s[44:47], s18 offen offset:1024 sc1
    s_waitcnt vmcnt(15) lgkmcnt(2)
    v_mfma_f32_32x32x16_bf16 v[4:19], v[76:79], v[108:111], v[4:19]
    v_mfma_f32_32x32x16_bf16 v[20:35], v[76:79], v[112:115], v[20:35]
    ds_read_b128 v[100:103], v164 offset:12672
    ds_read_b128 v[104:107], v165 offset:12672
    buffer_load_dwordx4 v[76:79], v3, s[44:47], s18 offen offset:2048 sc1
    s_waitcnt vmcnt(15) lgkmcnt(2)
    v_mfma_f32_32x32x16_bf16 v[4:19], v[80:83], v[116:119], v[4:19]
    v_mfma_f32_32x32x16_bf16 v[20:35], v[80:83], v[120:123], v[20:35]
    ds_read_b128 v[108:111], v164 offset:13728
    ds_read_b128 v[112:115], v165 offset:13728
    buffer_load_dwordx4 v[80:83], v3, s[44:47], s18 offen offset:3072 sc1
    s_waitcnt vmcnt(12)
    s_barrier
    s_add_u32 m0, s41, 0
    s_add_u32 s15, s40, 65536
    buffer_load_dwordx4 v3, s[28:31], s15 offen offset:0 sc1 lds
    buffer_load_dwordx4 v3, s[28:31], s15 offen offset:1024 sc1 lds
    buffer_load_dwordx4 v3, s[28:31], s15 offen offset:2048 sc1 lds
    buffer_load_dwordx4 v3, s[28:31], s15 offen offset:3072 sc1 lds
    s_waitcnt vmcnt(11) lgkmcnt(2)
    v_mfma_f32_32x32x16_bf16 v[4:19], v[84:87], v[100:103], v[4:19]
    v_mfma_f32_32x32x16_bf16 v[20:35], v[84:87], v[104:107], v[20:35]
    ds_read_b128 v[116:119], v164 offset:14784
    ds_read_b128 v[120:123], v165 offset:14784
    s_add_u32 s18, s18, 4096
    buffer_load_dwordx4 v[84:87], v3, s[44:47], s18 offen offset:0 sc1
    s_waitcnt vmcnt(11) lgkmcnt(2)
    v_mfma_f32_32x32x16_bf16 v[4:19], v[88:91], v[108:111], v[4:19]
    v_mfma_f32_32x32x16_bf16 v[20:35], v[88:91], v[112:115], v[20:35]
    ds_read_b128 v[100:103], v164 offset:15840
    ds_read_b128 v[104:107], v165 offset:15840
    buffer_load_dwordx4 v[88:91], v3, s[44:47], s18 offen offset:1024 sc1
    s_waitcnt vmcnt(11) lgkmcnt(2)
    v_mfma_f32_32x32x16_bf16 v[4:19], v[92:95], v[116:119], v[4:19]
    v_mfma_f32_32x32x16_bf16 v[20:35], v[92:95], v[120:123], v[20:35]
    ds_read_b128 v[108:111], v164 offset:16896
    ds_read_b128 v[112:115], v165 offset:16896
    buffer_load_dwordx4 v[92:95], v3, s[44:47], s18 offen offset:2048 sc1
    s_waitcnt vmcnt(11) lgkmcnt(2)
    v_mfma_f32_32x32x16_bf16 v[4:19], v[96:99], v[100:103], v[4:19]
    v_mfma_f32_32x32x16_bf16 v[20:35], v[96:99], v[104:107], v[20:35]
    ds_read_b128 v[116:119], v164 offset:17952
    ds_read_b128 v[120:123], v165 offset:17952
    buffer_load_dwordx4 v[96:99], v3, s[44:47], s18 offen offset:3072 sc1
    s_waitcnt vmcnt(11) lgkmcnt(2)
    v_mfma_f32_32x32x16_bf16 v[4:19], v[68:71], v[108:111], v[4:19]
    v_mfma_f32_32x32x16_bf16 v[20:35], v[68:71], v[112:115], v[20:35]
    ds_read_b128 v[100:103], v164 offset:19008
    ds_read_b128 v[104:107], v165 offset:19008
    s_add_u32 s18, s18, 4096
    buffer_load_dwordx4 v[68:71], v3, s[44:47], s18 offen offset:0 sc1
    s_waitcnt vmcnt(11) lgkmcnt(2)
    v_mfma_f32_32x32x16_bf16 v[4:19], v[72:75], v[116:119], v[4:19]
    v_mfma_f32_32x32x16_bf16 v[20:35], v[72:75], v[120:123], v[20:35]
    ds_read_b128 v[108:111], v164 offset:20064
    ds_read_b128 v[112:115], v165 offset:20064
    buffer_load_dwordx4 v[72:75], v3, s[44:47], s18 offen offset:1024 sc1
    s_waitcnt vmcnt(11) lgkmcnt(2)
    v_mfma_f32_32x32x16_bf16 v[4:19], v[76:79], v[100:103], v[4:19]
    v_mfma_f32_32x32x16_bf16 v[20:35], v[76:79], v[104:107], v[20:35]
    ds_read_b128 v[116:119], v164 offset:21120
    ds_read_b128 v[120:123], v165 offset:21120
    buffer_load_dwordx4 v[76:79], v3, s[44:47], s18 offen offset:2048 sc1
    s_waitcnt vmcnt(11) lgkmcnt(2)
    v_mfma_f32_32x32x16_bf16 v[4:19], v[80:83], v[108:111], v[4:19]
    v_mfma_f32_32x32x16_bf16 v[20:35], v[80:83], v[112:115], v[20:35]
    ds_read_b128 v[100:103], v164 offset:22176
    ds_read_b128 v[104:107], v165 offset:22176
    buffer_load_dwordx4 v[80:83], v3, s[44:47], s18 offen offset:3072 sc1
    s_barrier
    s_add_u32 m0, s41, 16384
    s_add_u32 s15, s40, 81920
    buffer_load_dwordx4 v3, s[28:31], s15 offen offset:0 sc1 lds
    buffer_load_dwordx4 v3, s[28:31], s15 offen offset:1024 sc1 lds
    buffer_load_dwordx4 v3, s[28:31], s15 offen offset:2048 sc1 lds
    buffer_load_dwordx4 v3, s[28:31], s15 offen offset:3072 sc1 lds
    s_waitcnt vmcnt(11) lgkmcnt(2)
    v_mfma_f32_32x32x16_bf16 v[4:19], v[84:87], v[116:119], v[4:19]
    v_mfma_f32_32x32x16_bf16 v[20:35], v[84:87], v[120:123], v[20:35]
    ds_read_b128 v[108:111], v164 offset:23232
    ds_read_b128 v[112:115], v165 offset:23232
    s_add_u32 s18, s18, 4096
    buffer_load_dwordx4 v[84:87], v3, s[44:47], s18 offen offset:0 sc1
    s_waitcnt vmcnt(11) lgkmcnt(2)
    v_mfma_f32_32x32x16_bf16 v[4:19], v[88:91], v[100:103], v[4:19]
    v_mfma_f32_32x32x16_bf16 v[20:35], v[88:91], v[104:107], v[20:35]
    ds_read_b128 v[116:119], v164 offset:24288
    ds_read_b128 v[120:123], v165 offset:24288
    buffer_load_dwordx4 v[88:91], v3, s[44:47], s18 offen offset:1024 sc1
    s_waitcnt vmcnt(11) lgkmcnt(2)
    v_mfma_f32_32x32x16_bf16 v[4:19], v[92:95], v[108:111], v[4:19]
    v_mfma_f32_32x32x16_bf16 v[20:35], v[92:95], v[112:115], v[20:35]
    ds_read_b128 v[100:103], v164 offset:25344
    ds_read_b128 v[104:107], v165 offset:25344
    buffer_load_dwordx4 v[92:95], v3, s[44:47], s18 offen offset:2048 sc1
    s_waitcnt vmcnt(11) lgkmcnt(2)
    v_mfma_f32_32x32x16_bf16 v[4:19], v[96:99], v[116:119], v[4:19]
    v_mfma_f32_32x32x16_bf16 v[20:35], v[96:99], v[120:123], v[20:35]
    ds_read_b128 v[108:111], v164 offset:26400
    ds_read_b128 v[112:115], v165 offset:26400
    buffer_load_dwordx4 v[96:99], v3, s[44:47], s18 offen offset:3072 sc1
    s_waitcnt vmcnt(11) lgkmcnt(2)
    v_mfma_f32_32x32x16_bf16 v[4:19], v[68:71], v[100:103], v[4:19]
    v_mfma_f32_32x32x16_bf16 v[20:35], v[68:71], v[104:107], v[20:35]
    ds_read_b128 v[116:119], v164 offset:27456
    ds_read_b128 v[120:123], v165 offset:27456
    s_add_u32 s18, s18, 4096
    buffer_load_dwordx4 v[68:71], v3, s[44:47], s18 offen offset:0 sc1
    s_waitcnt vmcnt(11) lgkmcnt(2)
    v_mfma_f32_32x32x16_bf16 v[4:19], v[72:75], v[108:111], v[4:19]
    v_mfma_f32_32x32x16_bf16 v[20:35], v[72:75], v[112:115], v[20:35]
    ds_read_b128 v[100:103], v164 offset:28512
    ds_read_b128 v[104:107], v165 offset:28512
    buffer_load_dwordx4 v[72:75], v3, s[44:47], s18 offen offset:1024 sc1
    s_waitcnt vmcnt(11) lgkmcnt(2)
    v_mfma_f32_32x32x16_bf16 v[4:19], v[76:79], v[116:119], v[4:19]
    v_mfma_f32_32x32x16_bf16 v[20:35], v[76:79], v[120:123], v[20:35]
    ds_read_b128 v[108:111], v164 offset:29568
    ds_read_b128 v[112:115], v165 offset:29568
    buffer_load_dwordx4 v[76:79], v3, s[44:47], s18 offen offset:2048 sc1
    s_waitcnt vmcnt(11) lgkmcnt(2)
    v_mfma_f32_32x32x16_bf16 v[4:19], v[80:83], v[100:103], v[4:19]
    v_mfma_f32_32x32x16_bf16 v[20:35], v[80:83], v[104:107], v[20:35]
    ds_read_b128 v[116:119], v164 offset:30624
    ds_read_b128 v[120:123], v165 offset:30624
    buffer_load_dwordx4 v[80:83], v3, s[44:47], s18 offen offset:3072 sc1
    s_waitcnt vmcnt(7) lgkmcnt(2)
    v_mfma_f32_32x32x16_bf16 v[4:19], v[84:87], v[108:111], v[4:19]
    v_mfma_f32_32x32x16_bf16 v[20:35], v[84:87], v[112:115], v[20:35]
    ds_read_b128 v[100:103], v164 offset:31680
    ds_read_b128 v[104:107], v165 offset:31680
    s_add_u32 s18, s18, 4096
    buffer_load_dwordx4 v[84:87], v3, s[44:47], s18 offen offset:0 sc1
    s_waitcnt vmcnt(7) lgkmcnt(2)
    v_mfma_f32_32x32x16_bf16 v[4:19], v[88:91], v[116:119], v[4:19]
    v_mfma_f32_32x32x16_bf16 v[20:35], v[88:91], v[120:123], v[20:35]
    ds_read_b128 v[108:111], v164 offset:32736
    ds_read_b128 v[112:115], v165 offset:32736
    buffer_load_dwordx4 v[88:91], v3, s[44:47], s18 offen offset:1024 sc1
    s_barrier
    s_add_u32 m0, s41, 32768
    s_add_u32 s15, s40, 98304
    buffer_load_dwordx4 v3, s[28:31], s15 offen offset:0 sc1 lds
    buffer_load_dwordx4 v3, s[28:31], s15 offen offset:1024 sc1 lds
    buffer_load_dwordx4 v3, s[28:31], s15 offen offset:2048 sc1 lds
    buffer_load_dwordx4 v3, s[28:31], s15 offen offset:3072 sc1 lds
    s_waitcnt vmcnt(11) lgkmcnt(2)
    v_mfma_f32_32x32x16_bf16 v[4:19], v[92:95], v[100:103], v[4:19]
    v_mfma_f32_32x32x16_bf16 v[20:35], v[92:95], v[104:107], v[20:35]
    ds_read_b128 v[116:119], v164 offset:33792
    ds_read_b128 v[120:123], v165 offset:33792
    buffer_load_dwordx4 v[92:95], v3, s[44:47], s18 offen offset:2048 sc1
    s_waitcnt vmcnt(11) lgkmcnt(2)
    v_mfma_f32_32x32x16_bf16 v[4:19], v[96:99], v[108:111], v[4:19]
    v_mfma_f32_32x32x16_bf16 v[20:35], v[96:99], v[112:115], v[20:35]
    ds_read_b128 v[100:103], v164 offset:34848
    ds_read_b128 v[104:107], v165 offset:34848
    buffer_load_dwordx4 v[96:99], v3, s[44:47], s18 offen offset:3072 sc1
    s_waitcnt vmcnt(11) lgkmcnt(2)
    v_mfma_f32_32x32x16_bf16 v[4:19], v[68:71], v[116:119], v[4:19]
    v_mfma_f32_32x32x16_bf16 v[20:35], v[68:71], v[120:123], v[20:35]
    ds_read_b128 v[108:111], v164 offset:35904
    ds_read_b128 v[112:115], v165 offset:35904
    s_mov_b32 s18, s19
    buffer_load_dwordx4 v[68:71], v3, s[44:47], s18 offen offset:0 sc1
    s_waitcnt vmcnt(11) lgkmcnt(2)
    v_mfma_f32_32x32x16_bf16 v[4:19], v[72:75], v[100:103], v[4:19]
    v_mfma_f32_32x32x16_bf16 v[20:35], v[72:75], v[104:107], v[20:35]
    ds_read_b128 v[116:119], v164 offset:36960
    ds_read_b128 v[120:123], v165 offset:36960
    buffer_load_dwordx4 v[72:75], v3, s[44:47], s18 offen offset:1024 sc1
    s_waitcnt vmcnt(11) lgkmcnt(2)
    v_mfma_f32_32x32x16_bf16 v[4:19], v[76:79], v[108:111], v[4:19]
    v_mfma_f32_32x32x16_bf16 v[20:35], v[76:79], v[112:115], v[20:35]
    ds_read_b128 v[100:103], v164 offset:38016
    ds_read_b128 v[104:107], v165 offset:38016
    buffer_load_dwordx4 v[76:79], v3, s[44:47], s18 offen offset:2048 sc1
    s_waitcnt vmcnt(11) lgkmcnt(2)
    v_mfma_f32_32x32x16_bf16 v[4:19], v[80:83], v[116:119], v[4:19]
    v_mfma_f32_32x32x16_bf16 v[20:35], v[80:83], v[120:123], v[20:35]
    ds_read_b128 v[108:111], v164 offset:39072
    ds_read_b128 v[112:115], v165 offset:39072
    buffer_load_dwordx4 v[80:83], v3, s[44:47], s18 offen offset:3072 sc1
    s_waitcnt vmcnt(11) lgkmcnt(2)
    v_mfma_f32_32x32x16_bf16 v[4:19], v[84:87], v[100:103], v[4:19]
    v_mfma_f32_32x32x16_bf16 v[20:35], v[84:87], v[104:107], v[20:35]
    ds_read_b128 v[116:119], v164 offset:40128
    ds_read_b128 v[120:123], v165 offset:40128
    s_add_u32 s18, s18, 4096
    buffer_load_dwordx4 v[84:87], v3, s[44:47], s18 offen offset:0 sc1
    s_waitcnt vmcnt(11) lgkmcnt(2)
    v_mfma_f32_32x32x16_bf16 v[4:19], v[88:91], v[108:111], v[4:19]
    v_mfma_f32_32x32x16_bf16 v[20:35], v[88:91], v[112:115], v[20:35]
    ds_read_b128 v[100:103], v164 offset:41184
    ds_read_b128 v[104:107], v165 offset:41184
    buffer_load_dwordx4 v[88:91], v3, s[44:47], s18 offen offset:1024 sc1
    s_waitcnt vmcnt(7) lgkmcnt(2)
    v_mfma_f32_32x32x16_bf16 v[4:19], v[92:95], v[116:119], v[4:19]
    v_mfma_f32_32x32x16_bf16 v[20:35], v[92:95], v[120:123], v[20:35]
    ds_read_b128 v[108:111], v166 offset:0
    buffer_load_dwordx4 v[92:95], v3, s[44:47], s18 offen offset:2048 sc1
    s_waitcnt vmcnt(7) lgkmcnt(1)
    v_mfma_f32_32x32x16_bf16 v[4:19], v[96:99], v[100:103], v[4:19]
    v_mfma_f32_32x32x16_bf16 v[20:35], v[96:99], v[104:107], v[20:35]
    ds_read_b128 v[116:119], v166 offset:1056
    buffer_load_dwordx4 v[96:99], v3, s[44:47], s18 offen offset:3072 sc1
    s_barrier
    s_add_u32 m0, s41, 49152
    s_add_u32 s15, s40, 114688
    buffer_load_dwordx4 v3, s[28:31], s15 offen offset:0 sc1 lds
    buffer_load_dwordx4 v3, s[28:31], s15 offen offset:1024 sc1 lds
    buffer_load_dwordx4 v3, s[28:31], s15 offen offset:2048 sc1 lds
    buffer_load_dwordx4 v3, s[28:31], s15 offen offset:3072 sc1 lds
    s_waitcnt vmcnt(11) lgkmcnt(1)
    v_mfma_f32_32x32x16_bf16 v[36:51], v[68:71], v[108:111], 0
    ds_read_b128 v[100:103], v166 offset:2112
    s_add_u32 s18, s18, 4096
    buffer_load_dwordx4 v[68:71], v3, s[44:47], s18 offen offset:0 sc1
    s_waitcnt vmcnt(11) lgkmcnt(1)
    v_mfma_f32_32x32x16_bf16 v[36:51], v[72:75], v[116:119], v[36:51]
    ds_read_b128 v[108:111], v166 offset:3168
    buffer_load_dwordx4 v[72:75], v3, s[44:47], s18 offen offset:1024 sc1
    s_waitcnt vmcnt(11) lgkmcnt(1)
    v_mfma_f32_32x32x16_bf16 v[36:51], v[76:79], v[100:103], v[36:51]
    ds_read_b128 v[116:119], v166 offset:4224
    buffer_load_dwordx4 v[76:79], v3, s[44:47], s18 offen offset:2048 sc1
    s_waitcnt vmcnt(11) lgkmcnt(1)
    v_mfma_f32_32x32x16_bf16 v[36:51], v[80:83], v[108:111], v[36:51]
    ds_read_b128 v[100:103], v166 offset:5280
    buffer_load_dwordx4 v[80:83], v3, s[44:47], s18 offen offset:3072 sc1
    s_waitcnt vmcnt(11) lgkmcnt(1)
    v_mfma_f32_32x32x16_bf16 v[36:51], v[84:87], v[116:119], v[36:51]
    ds_read_b128 v[108:111], v166 offset:6336
    s_add_u32 s18, s18, 4096
    buffer_load_dwordx4 v[84:87], v3, s[44:47], s18 offen offset:0 sc1
    s_waitcnt vmcnt(11) lgkmcnt(1)
    v_mfma_f32_32x32x16_bf16 v[36:51], v[88:91], v[100:103], v[36:51]
    ds_read_b128 v[116:119], v166 offset:7392
    buffer_load_dwordx4 v[88:91], v3, s[44:47], s18 offen offset:1024 sc1
    s_setprio 2
    v_exp_f32 v124, -v4
    v_exp_f32 v125, -v5
    v_exp_f32 v126, -v6
    v_exp_f32 v127, -v7
    v_exp_f32 v128, -v8
    v_exp_f32 v129, -v9
    v_exp_f32 v130, -v10
    v_exp_f32 v131, -v11
    s_setprio 0
    s_waitcnt vmcnt(11) lgkmcnt(1)
    v_mfma_f32_32x32x16_bf16 v[36:51], v[92:95], v[108:111], v[36:51]
    ds_read_b128 v[100:103], v166 offset:8448
    buffer_load_dwordx4 v[92:95], v3, s[44:47], s18 offen offset:2048 sc1
    s_setprio 2
    v_add_f32 v124, 1.0, v124
    v_add_f32 v125, 1.0, v125
    v_add_f32 v126, 1.0, v126
    v_add_f32 v127, 1.0, v127
    v_add_f32 v128, 1.0, v128
    v_add_f32 v129, 1.0, v129
    v_add_f32 v130, 1.0, v130
    s_setprio 0
    s_waitcnt vmcnt(11) lgkmcnt(1)
    v_mfma_f32_32x32x16_bf16 v[36:51], v[96:99], v[116:119], v[36:51]
    ds_read_b128 v[108:111], v166 offset:9504
    buffer_load_dwordx4 v[96:99], v3, s[44:47], s18 offen offset:3072 sc1
    s_setprio 2
    v_add_f32 v131, 1.0, v131
    v_rcp_f32 v124, v124
    v_rcp_f32 v125, v125
    v_rcp_f32 v126, v126
    v_rcp_f32 v127, v127
    v_rcp_f32 v128, v128
    v_rcp_f32 v129, v129
    s_setprio 0
    s_waitcnt vmcnt(7) lgkmcnt(1)
    v_mfma_f32_32x32x16_bf16 v[36:51], v[68:71], v[100:103], v[36:51]
    ds_read_b128 v[116:119], v166 offset:10560
    s_add_u32 s18, s18, 4096
    buffer_load_dwordx4 v[68:71], v3, s[44:47], s18 offen offset:0 sc1
    s_setprio 2
    v_rcp_f32 v130, v130
    v_rcp_f32 v131, v131
    v_mul_f32 v4, v4, v124
    v_mul_f32 v5, v5, v125
    v_mul_f32 v6, v6, v126
    v_mul_f32 v7, v7, v127
    v_mul_f32 v8, v8, v128
    s_setprio 0
    s_waitcnt vmcnt(7) lgkmcnt(1)
    v_mfma_f32_32x32x16_bf16 v[36:51], v[72:75], v[108:111], v[36:51]
    ds_read_b128 v[100:103], v166 offset:11616
    buffer_load_dwordx4 v[72:75], v3, s[44:47], s18 offen offset:1024 sc1
    s_setprio 2
    v_mul_f32 v9, v9, v129
    v_mul_f32 v10, v10, v130
    v_mul_f32 v11, v11, v131
    v_cvt_pk_bf16_f32 v4, v4, v5
    v_cvt_pk_bf16_f32 v5, v6, v7
    v_cvt_pk_bf16_f32 v6, v8, v9
    v_cvt_pk_bf16_f32 v7, v10, v11
    s_setprio 0
    s_waitcnt vmcnt(7) lgkmcnt(1)
    v_mfma_f32_32x32x16_bf16 v[36:51], v[76:79], v[116:119], v[36:51]
    ds_read_b128 v[108:111], v166 offset:12672
    buffer_load_dwordx4 v[76:79], v3, s[44:47], s18 offen offset:2048 sc1
    s_setprio 2
    s_add_u32 s15, s10, 0
    buffer_store_dwordx4 v[4:7], v3, s[36:39], s15 offen sc1
    v_exp_f32 v124, -v12
    v_exp_f32 v125, -v13
    v_exp_f32 v126, -v14
    v_exp_f32 v127, -v15
    v_exp_f32 v128, -v16
    v_exp_f32 v129, -v17
    s_setprio 0
    s_waitcnt vmcnt(8) lgkmcnt(1)
    v_mfma_f32_32x32x16_bf16 v[36:51], v[80:83], v[100:103], v[36:51]
    ds_read_b128 v[116:119], v166 offset:13728
    buffer_load_dwordx4 v[80:83], v3, s[44:47], s18 offen offset:3072 sc1
    s_setprio 2
    v_exp_f32 v130, -v18
    v_exp_f32 v131, -v19
    v_add_f32 v124, 1.0, v124
    v_add_f32 v125, 1.0, v125
    v_add_f32 v126, 1.0, v126
    v_add_f32 v127, 1.0, v127
    v_add_f32 v128, 1.0, v128
    s_setprio 0
    s_waitcnt vmcnt(8) lgkmcnt(1)
    v_mfma_f32_32x32x16_bf16 v[36:51], v[84:87], v[108:111], v[36:51]
    ds_read_b128 v[100:103], v166 offset:14784
    s_add_u32 s18, s18, 4096
    buffer_load_dwordx4 v[84:87], v3, s[44:47], s18 offen offset:0 sc1
    s_setprio 2
    v_add_f32 v129, 1.0, v129
    v_add_f32 v130, 1.0, v130
    v_add_f32 v131, 1.0, v131
    v_rcp_f32 v124, v124
    v_rcp_f32 v125, v125
    v_rcp_f32 v126, v126
    v_rcp_f32 v127, v127
    s_setprio 0
    s_waitcnt vmcnt(8) lgkmcnt(1)
    v_mfma_f32_32x32x16_bf16 v[36:51], v[88:91], v[116:119], v[36:51]
    ds_read_b128 v[108:111], v166 offset:15840
    buffer_load_dwordx4 v[88:91], v3, s[44:47], s18 offen offset:1024 sc1
    s_setprio 2
    v_rcp_f32 v128, v128
    v_rcp_f32 v129, v129
    v_rcp_f32 v130, v130
    v_rcp_f32 v131, v131
    v_mul_f32 v12, v12, v124
    v_mul_f32 v13, v13, v125
    v_mul_f32 v14, v14, v126
    s_setprio 0
    s_barrier
    s_add_u32 m0, s41, 0
    s_add_u32 s15, s40, 131072
    buffer_load_dwordx4 v3, s[28:31], s15 offen offset:0 sc1 lds
    buffer_load_dwordx4 v3, s[28:31], s15 offen offset:1024 sc1 lds
    buffer_load_dwordx4 v3, s[28:31], s15 offen offset:2048 sc1 lds
    buffer_load_dwordx4 v3, s[28:31], s15 offen offset:3072 sc1 lds
    s_waitcnt vmcnt(12) lgkmcnt(1)
    v_mfma_f32_32x32x16_bf16 v[36:51], v[92:95], v[100:103], v[36:51]
    ds_read_b128 v[116:119], v166 offset:16896
    buffer_load_dwordx4 v[92:95], v3, s[44:47], s18 offen offset:2048 sc1
    s_setprio 2
    v_mul_f32 v15, v15, v127
    v_mul_f32 v16, v16, v128
    v_mul_f32 v17, v17, v129
    v_mul_f32 v18, v18, v130
    v_mul_f32 v19, v19, v131
    v_cvt_pk_bf16_f32 v12, v12, v13
    v_cvt_pk_bf16_f32 v13, v14, v15
    s_setprio 0
    s_waitcnt vmcnt(12) lgkmcnt(1)
    v_mfma_f32_32x32x16_bf16 v[36:51], v[96:99], v[108:111], v[36:51]
    ds_read_b128 v[100:103], v166 offset:17952
    buffer_load_dwordx4 v[96:99], v3, s[44:47], s18 offen offset:3072 sc1
    s_setprio 2
    v_cvt_pk_bf16_f32 v14, v16, v17
    v_cvt_pk_bf16_f32 v15, v18, v19
    s_add_u32 s15, s10, 1024
    buffer_store_dwordx4 v[12:15], v3, s[36:39], s15 offen sc1
    v_exp_f32 v124, -v20
    v_exp_f32 v125, -v21
    v_exp_f32 v126, -v22
    v_exp_f32 v127, -v23
    s_setprio 0
    s_waitcnt vmcnt(13) lgkmcnt(1)
    v_mfma_f32_32x32x16_bf16 v[36:51], v[68:71], v[116:119], v[36:51]
    ds_read_b128 v[108:111], v166 offset:19008
    s_add_u32 s18, s18, 4096
    buffer_load_dwordx4 v[68:71], v3, s[44:47], s18 offen offset:0 sc1
    s_setprio 2
    v_exp_f32 v128, -v24
    v_exp_f32 v129, -v25
    v_exp_f32 v130, -v26
    v_exp_f32 v131, -v27
    v_add_f32 v124, 1.0, v124
    v_add_f32 v125, 1.0, v125
    v_add_f32 v126, 1.0, v126
    s_setprio 0
    s_waitcnt vmcnt(13) lgkmcnt(1)
    v_mfma_f32_32x32x16_bf16 v[36:51], v[72:75], v[100:103], v[36:51]
    ds_read_b128 v[116:119], v166 offset:20064
    buffer_load_dwordx4 v[72:75], v3, s[44:47], s18 offen offset:1024 sc1
    s_setprio 2
    v_add_f32 v127, 1.0, v127
    v_add_f32 v128, 1.0, v128
    v_add_f32 v129, 1.0, v129
    v_add_f32 v130, 1.0, v130
    v_add_f32 v131, 1.0, v131
    v_rcp_f32 v124, v124
    v_rcp_f32 v125, v125
    s_setprio 0
    s_waitcnt vmcnt(13) lgkmcnt(1)
    v_mfma_f32_32x32x16_bf16 v[36:51], v[76:79], v[108:111], v[36:51]
    ds_read_b128 v[100:103], v166 offset:21120
    buffer_load_dwordx4 v[76:79], v3, s[44:47], s18 offen offset:2048 sc1
    s_setprio 2
    v_rcp_f32 v126, v126
    v_rcp_f32 v127, v127
    v_rcp_f32 v128, v128
    v_rcp_f32 v129, v129
    v_rcp_f32 v130, v130
    v_rcp_f32 v131, v131
    v_mul_f32 v20, v20, v124
    s_setprio 0
    s_waitcnt vmcnt(12) lgkmcnt(1)
    v_mfma_f32_32x32x16_bf16 v[36:51], v[80:83], v[116:119], v[36:51]
    ds_read_b128 v[108:111], v166 offset:22176
    buffer_load_dwordx4 v[80:83], v3, s[44:47], s18 offen offset:3072 sc1
    s_setprio 2
    v_mul_f32 v21, v21, v125
    v_mul_f32 v22, v22, v126
    v_mul_f32 v23, v23, v127
    v_mul_f32 v24, v24, v128
    v_mul_f32 v25, v25, v129
    v_mul_f32 v26, v26, v130
    v_mul_f32 v27, v27, v131
    s_setprio 0
    s_waitcnt vmcnt(12) lgkmcnt(1)
    v_mfma_f32_32x32x16_bf16 v[36:51], v[84:87], v[100:103], v[36:51]
    ds_read_b128 v[116:119], v166 offset:23232
    s_add_u32 s18, s18, 4096
    buffer_load_dwordx4 v[84:87], v3, s[44:47], s18 offen offset:0 sc1
    s_setprio 2
    v_cvt_pk_bf16_f32 v20, v20, v21
    v_cvt_pk_bf16_f32 v21, v22, v23
    v_cvt_pk_bf16_f32 v22, v24, v25
    v_cvt_pk_bf16_f32 v23, v26, v27
    s_add_u32 s15, s10, 110592
    buffer_store_dwordx4 v[20:23], v3, s[36:39], s15 offen sc1
    v_exp_f32 v124, -v28
    v_exp_f32 v125, -v29
    s_setprio 0
    s_waitcnt vmcnt(13) lgkmcnt(1)
    v_mfma_f32_32x32x16_bf16 v[36:51], v[88:91], v[108:111], v[36:51]
    ds_read_b128 v[100:103], v166 offset:24288
    buffer_load_dwordx4 v[88:91], v3, s[44:47], s18 offen offset:1024 sc1
    s_setprio 2
    v_exp_f32 v126, -v30
    v_exp_f32 v127, -v31
    v_exp_f32 v128, -v32
    v_exp_f32 v129, -v33
    v_exp_f32 v130, -v34
    v_exp_f32 v131, -v35
    v_add_f32 v124, 1.0, v124
    s_setprio 0
    s_waitcnt vmcnt(9) lgkmcnt(1)
    v_mfma_f32_32x32x16_bf16 v[36:51], v[92:95], v[116:119], v[36:51]
    ds_read_b128 v[108:111], v166 offset:25344
    buffer_load_dwordx4 v[92:95], v3, s[44:47], s18 offen offset:2048 sc1
    s_setprio 2
    v_add_f32 v125, 1.0, v125
    v_add_f32 v126, 1.0, v126
    v_add_f32 v127, 1.0, v127
    v_add_f32 v128, 1.0, v128
    v_add_f32 v129, 1.0, v129
    v_add_f32 v130, 1.0, v130
    v_add_f32 v131, 1.0, v131
    s_setprio 0
    s_waitcnt vmcnt(9) lgkmcnt(1)
    v_mfma_f32_32x32x16_bf16 v[36:51], v[96:99], v[100:103], v[36:51]
    ds_read_b128 v[116:119], v166 offset:26400
    buffer_load_dwordx4 v[96:99], v3, s[44:47], s18 offen offset:3072 sc1
    s_setprio 2
    v_rcp_f32 v124, v124
    v_rcp_f32 v125, v125
    v_rcp_f32 v126, v126
    v_rcp_f32 v127, v127
    v_rcp_f32 v128, v128
    v_rcp_f32 v129, v129
    v_rcp_f32 v130, v130
    s_setprio 0
    s_waitcnt vmcnt(8) lgkmcnt(1)
    v_mfma_f32_32x32x16_bf16 v[36:51], v[68:71], v[108:111], v[36:51]
    ds_read_b128 v[100:103], v166 offset:27456
    s_add_u32 s18, s18, 4096
    buffer_load_dwordx4 v[68:71], v3, s[44:47], s18 offen offset:0 sc1
    s_setprio 2
    v_rcp_f32 v131, v131
    v_mul_f32 v28, v28, v124
    v_mul_f32 v29, v29, v125
    v_mul_f32 v30, v30, v126
    v_mul_f32 v31, v31, v127
    v_mul_f32 v32, v32, v128
    v_mul_f32 v33, v33, v129
    s_setprio 0
    s_waitcnt vmcnt(8) lgkmcnt(1)
    v_mfma_f32_32x32x16_bf16 v[36:51], v[72:75], v[116:119], v[36:51]
    ds_read_b128 v[108:111], v166 offset:28512
    buffer_load_dwordx4 v[72:75], v3, s[44:47], s18 offen offset:1024 sc1
    s_setprio 2
    v_mul_f32 v34, v34, v130
    v_mul_f32 v35, v35, v131
    v_cvt_pk_bf16_f32 v28, v28, v29
    v_cvt_pk_bf16_f32 v29, v30, v31
    v_cvt_pk_bf16_f32 v30, v32, v33
    v_cvt_pk_bf16_f32 v31, v34, v35
    s_add_u32 s15, s10, 111616
    buffer_store_dwordx4 v[28:31], v3, s[36:39], s15 offen sc1
    s_setprio 0
    s_waitcnt vmcnt(9) lgkmcnt(1)
    v_mfma_f32_32x32x16_bf16 v[36:51], v[76:79], v[100:103], v[36:51]
    ds_read_b128 v[116:119], v166 offset:29568
    buffer_load_dwordx4 v[76:79], v3, s[44:47], s18 offen offset:2048 sc1
    s_barrier
    s_add_u32 m0, s41, 16384
    s_add_u32 s15, s40, 147456
    buffer_load_dwordx4 v3, s[28:31], s15 offen offset:0 sc1 lds
    buffer_load_dwordx4 v3, s[28:31], s15 offen offset:1024 sc1 lds
    buffer_load_dwordx4 v3, s[28:31], s15 offen offset:2048 sc1 lds
    buffer_load_dwordx4 v3, s[28:31], s15 offen offset:3072 sc1 lds
    s_waitcnt vmcnt(13) lgkmcnt(1)
    v_mfma_f32_32x32x16_bf16 v[36:51], v[80:83], v[108:111], v[36:51]
    ds_read_b128 v[100:103], v166 offset:30624
    buffer_load_dwordx4 v[80:83], v3, s[44:47], s18 offen offset:3072 sc1
    s_waitcnt vmcnt(13) lgkmcnt(1)
    v_mfma_f32_32x32x16_bf16 v[36:51], v[84:87], v[116:119], v[36:51]
    ds_read_b128 v[108:111], v166 offset:31680
    s_add_u32 s18, s18, 4096
    buffer_load_dwordx4 v[84:87], v3, s[44:47], s18 offen offset:0 sc1
    s_waitcnt vmcnt(12) lgkmcnt(1)
    v_mfma_f32_32x32x16_bf16 v[36:51], v[88:91], v[100:103], v[36:51]
    ds_read_b128 v[116:119], v166 offset:32736
    buffer_load_dwordx4 v[88:91], v3, s[44:47], s18 offen offset:1024 sc1
    s_waitcnt vmcnt(8)
    v_mov_b32 v162, 0
    v_mov_b32 v163, s98
    s_mov_b64 exec, 1
    buffer_store_dword v163, v162, s[36:39], s16 offen offset:0 sc1
    s_mov_b64 exec, -1
    s_waitcnt lgkmcnt(1)
    v_mfma_f32_32x32x16_bf16 v[36:51], v[92:95], v[108:111], v[36:51]
    ds_read_b128 v[100:103], v166 offset:33792
    buffer_load_dwordx4 v[92:95], v3, s[44:47], s18 offen offset:2048 sc1
    s_waitcnt lgkmcnt(1)
    v_mfma_f32_32x32x16_bf16 v[36:51], v[96:99], v[116:119], v[36:51]
    ds_read_b128 v[108:111], v166 offset:34848
    buffer_load_dwordx4 v[96:99], v3, s[44:47], s18 offen offset:3072 sc1
    s_waitcnt lgkmcnt(1)
    v_mfma_f32_32x32x16_bf16 v[36:51], v[68:71], v[100:103], v[36:51]
    ds_read_b128 v[116:119], v166 offset:35904
    s_waitcnt lgkmcnt(1)
    v_mfma_f32_32x32x16_bf16 v[36:51], v[72:75], v[108:111], v[36:51]
    ds_read_b128 v[100:103], v166 offset:36960
    s_waitcnt vmcnt(10) lgkmcnt(1)
    v_mfma_f32_32x32x16_bf16 v[36:51], v[76:79], v[116:119], v[36:51]
    ds_read_b128 v[108:111], v166 offset:38016
    s_waitcnt vmcnt(5) lgkmcnt(1)
    v_mfma_f32_32x32x16_bf16 v[36:51], v[80:83], v[100:103], v[36:51]
    ds_read_b128 v[116:119], v166 offset:39072
    s_waitcnt vmcnt(4) lgkmcnt(1)
    v_mfma_f32_32x32x16_bf16 v[36:51], v[84:87], v[108:111], v[36:51]
    ds_read_b128 v[100:103], v166 offset:40128
    s_waitcnt vmcnt(3) lgkmcnt(1)
    v_mfma_f32_32x32x16_bf16 v[36:51], v[88:91], v[116:119], v[36:51]
    ds_read_b128 v[108:111], v166 offset:41184
    s_waitcnt vmcnt(1) lgkmcnt(1)
    v_mfma_f32_32x32x16_bf16 v[36:51], v[92:95], v[100:103], v[36:51]
    s_waitcnt vmcnt(0) lgkmcnt(0)
    v_mfma_f32_32x32x16_bf16 v[36:51], v[96:99], v[108:111], v[36:51]
    s_barrier
    s_add_u32 m0, s41, 32768
    s_add_u32 s15, s40, 163840
    buffer_load_dwordx4 v3, s[28:31], s15 offen offset:0 sc1 lds
    buffer_load_dwordx4 v3, s[28:31], s15 offen offset:1024 sc1 lds
    buffer_load_dwordx4 v3, s[28:31], s15 offen offset:2048 sc1 lds
    buffer_load_dwordx4 v3, s[28:31], s15 offen offset:3072 sc1 lds
    s_lshl_b32 s13, s6, 14
    s_mul_i32 s8, s12, 110592
    s_mul_i32 s15, s6, 11264
    s_add_u32 s15, s15, 65536
    s_add_u32 s9, s8, s15
    s_add_u32 s8, s8, s13
    s_add_u32 s19, s17, s15
    s_add_u32 s18, s17, s13
    v_and_b32 v160, 31, v0
    v_lshlrev_b32 v160, 2, v160
    buffer_load_dword v161, v160, s[36:39], s14 offen offset:0 sc1
    s_mov_b32 s13, 3804160
    buffer_load_dwordx4 v[132:135], v3, s[36:39], s13 offen sc1
    s_nop 7
    s_setprio 2
    v_exp_f32 v68, -v36
    v_exp_f32 v69, -v37
    v_exp_f32 v70, -v38
    v_exp_f32 v71, -v39
    v_exp_f32 v72, -v40
    v_exp_f32 v73, -v41
    v_exp_f32 v74, -v42
    v_exp_f32 v75, -v43
    v_add_f32 v68, 1.0, v68
    v_add_f32 v69, 1.0, v69
    v_add_f32 v70, 1.0, v70
    v_add_f32 v71, 1.0, v71
    v_add_f32 v72, 1.0, v72
    v_add_f32 v73, 1.0, v73
    v_add_f32 v74, 1.0, v74
    v_add_f32 v75, 1.0, v75
    v_rcp_f32 v68, v68
    v_rcp_f32 v69, v69
    v_rcp_f32 v70, v70
    v_rcp_f32 v71, v71
    v_rcp_f32 v72, v72
    v_rcp_f32 v73, v73
    v_rcp_f32 v74, v74
    v_rcp_f32 v75, v75
    v_mul_f32 v36, v36, v68
    v_mul_f32 v37, v37, v69
    v_mul_f32 v38, v38, v70
    v_mul_f32 v39, v39, v71
    v_mul_f32 v40, v40, v72
    v_mul_f32 v41, v41, v73
    v_mul_f32 v42, v42, v74
    v_mul_f32 v43, v43, v75
    v_cvt_pk_bf16_f32 v36, v36, v37
    v_cvt_pk_bf16_f32 v37, v38, v39
    v_cvt_pk_bf16_f32 v38, v40, v41
    v_cvt_pk_bf16_f32 v39, v42, v43
    s_add_u32 s15, s11, 0
    buffer_store_dwordx4 v[36:39], v3, s[36:39], s15 offen sc1
    v_exp_f32 v68, -v44
    v_exp_f32 v69, -v45
    v_exp_f32 v70, -v46
    v_exp_f32 v71, -v47
    v_exp_f32 v72, -v48
    v_exp_f32 v73, -v49
    v_exp_f32 v74, -v50
    v_exp_f32 v75, -v51
    v_add_f32 v68, 1.0, v68
    v_add_f32 v69, 1.0, v69
    v_add_f32 v70, 1.0, v70
    v_add_f32 v71, 1.0, v71
    v_add_f32 v72, 1.0, v72
    v_add_f32 v73, 1.0, v73
    v_add_f32 v74, 1.0, v74
    v_add_f32 v75, 1.0, v75
    v_rcp_f32 v68, v68
    v_rcp_f32 v69, v69
    v_rcp_f32 v70, v70
    v_rcp_f32 v71, v71
    v_rcp_f32 v72, v72
    v_rcp_f32 v73, v73
    v_rcp_f32 v74, v74
    v_rcp_f32 v75, v75
    v_mul_f32 v44, v44, v68
    v_mul_f32 v45, v45, v69
    v_mul_f32 v46, v46, v70
    v_mul_f32 v47, v47, v71
    v_mul_f32 v48, v48, v72
    v_mul_f32 v49, v49, v73
    v_mul_f32 v50, v50, v74
    v_mul_f32 v51, v51, v75
    v_cvt_pk_bf16_f32 v44, v44, v45
    v_cvt_pk_bf16_f32 v45, v46, v47
    v_cvt_pk_bf16_f32 v46, v48, v49
    v_cvt_pk_bf16_f32 v47, v50, v51
    s_add_u32 s15, s11, 1024
    buffer_store_dwordx4 v[44:47], v3, s[36:39], s15 offen sc1
    s_waitcnt vmcnt(3)
    v_cmp_ne_u32 vcc, s98, v161
    s_mov_b32 s13, 0x4000
    s_nop 3
    s_cbranch_vccz polld_69
poll_68:
    buffer_load_dword v161, v160, s[36:39], s14 offen offset:0 sc1
    s_waitcnt vmcnt(0)
    v_cmp_ne_u32 vcc, s98, v161
    s_sub_u32 s13, s13, 1
    s_nop 3
    s_cbranch_vccz polld_69
    s_cmp_eq_u32 s13, 0
    s_cbranch_scc1 polld_69
    s_sleep 2
    s_branch poll_68
polld_69:
    s_waitcnt vmcnt(2)
    s_mov_b32 s43, 0x4000
    s_mov_b32 s13, 3804160
g2p_70:
    v_xor_b32 v132, s98, v132
    v_xor_b32 v133, s98, v133
    v_xor_b32 v134, s98, v134
    v_xor_b32 v135, s98, v135
    v_or_b32 v132, v132, v133
    v_or_b32 v134, v134, v135
    v_or_b32 v132, v132, v134
    v_cmp_ne_u32 vcc, 0, v132
    s_sub_u32 s43, s43, 1
    s_nop 3
    s_cbranch_vccz g2d_71
    s_cmp_eq_u32 s43, 0
    s_cbranch_scc1 g2d_71
    s_sleep 2
    buffer_load_dwordx4 v[132:135], v3, s[36:39], s13 offen sc1
    s_waitcnt vmcnt(0)
    s_branch g2p_70
g2d_71:
    s_add_u32 s15, s8, 0
    buffer_load_dwordx4 v[100:103], v3, s[48:51], s15 offen offset:0 sc1
    s_add_u32 s15, s8, 110592
    buffer_load_dwordx4 v[104:107], v3, s[48:51], s15 offen offset:0 sc1
    s_add_u32 s15, s8, 221184
    buffer_load_dwordx4 v[108:111], v3, s[48:51], s15 offen offset:0 sc1
    s_add_u32 s15, s18, 0
    buffer_load_dwordx4 v[112:115], v3, s[36:39], s15 offen offset:0 sc1
    s_add_u32 s15, s18, 110592
    buffer_load_dwordx4 v[116:119], v3, s[36:39], s15 offen offset:0 sc1
    s_add_u32 s15, s8, 0
    buffer_load_dwordx4 v[120:123], v3, s[48:51], s15 offen offset:1024 sc1
    s_add_u32 s15, s8, 110592
    buffer_load_dwordx4 v[124:127], v3, s[48:51], s15 offen offset:1024 sc1
    s_add_u32 s15, s8, 221184
    buffer_load_dwordx4 v[128:131], v3, s[48:51], s15 offen offset:1024 sc1
    s_add_u32 s15, s18, 0
    buffer_load_dwordx4 v[132:135], v3, s[36:39], s15 offen offset:1024 sc1
    s_add_u32 s15, s18, 110592
    buffer_load_dwordx4 v[136:139], v3, s[36:39], s15 offen offset:1024 sc1
    s_add_u32 s15, s8, 0
    buffer_load_dwordx4 v[140:143], v3, s[48:51], s15 offen offset:2048 sc1
    s_add_u32 s15, s8, 110592
    buffer_load_dwordx4 v[144:147], v3, s[48:51], s15 offen offset:2048 sc1
    s_add_u32 s15, s8, 221184
    buffer_load_dwordx4 v[148:151], v3, s[48:51], s15 offen offset:2048 sc1
    s_add_u32 s15, s18, 0
    buffer_load_dwordx4 v[152:155], v3, s[36:39], s15 offen offset:2048 sc1
    s_add_u32 s15, s18, 110592
    buffer_load_dwordx4 v[156:159], v3, s[36:39], s15 offen offset:2048 sc1
    s_setprio 0
    s_barrier
    s_add_u32 m0, s41, 49152
    s_add_u32 s15, s40, 180224
    buffer_load_dwordx4 v3, s[28:31], s15 offen offset:0 sc1 lds
    buffer_load_dwordx4 v3, s[28:31], s15 offen offset:1024 sc1 lds
    buffer_load_dwordx4 v3, s[28:31], s15 offen offset:2048 sc1 lds
    buffer_load_dwordx4 v3, s[28:31], s15 offen offset:3072 sc1 lds
    s_waitcnt vmcnt(14)
    v_mfma_f32_32x32x16_bf16 v[4:19], v[100:103], v[112:115], 0
    v_mfma_f32_32x32x16_bf16 v[20:35], v[100:103], v[116:119], 0
    s_add_u32 s15, s8, 0
    buffer_load_dwordx4 v[100:103], v3, s[48:51], s15 offen offset:3072 sc1
    v_mfma_f32_32x32x16_bf16 v[52:67], v[104:107], v[116:119], 0
    v_mfma_f32_32x32x16_bf16 v[36:51], v[104:107], v[112:115], 0
    s_add_u32 s15, s8, 110592
    buffer_load_dwordx4 v[104:107], v3, s[48:51], s15 offen offset:3072 sc1
    v_mfma_f32_32x32x16_bf16 v[68:83], v[108:111], v[112:115], 0
    v_mfma_f32_32x32x16_bf16 v[84:99], v[108:111], v[116:119], 0
    s_add_u32 s15, s8, 221184
    buffer_load_dwordx4 v[108:111], v3, s[48:51], s15 offen offset:3072 sc1
    s_add_u32 s15, s18, 0
    buffer_load_dwordx4 v[112:115], v3, s[36:39], s15 offen offset:3072 sc1
    s_add_u32 s15, s18, 110592
    buffer_load_dwordx4 v[116:119], v3, s[36:39], s15 offen offset:3072 sc1
    s_waitcnt vmcnt(14)
    v_mfma_f32_32x32x16_bf16 v[4:19], v[120:123], v[132:135], v[4:19]
    v_mfma_f32_32x32x16_bf16 v[20:35], v[120:123], v[136:139], v[20:35]
    s_add_u32 s15, s8, 4096
    buffer_load_dwordx4 v[120:123], v3, s[48:51], s15 offen offset:0 sc1
    v_mfma_f32_32x32x16_bf16 v[52:67], v[124:127], v[136:139], v[52:67]
    v_mfma_f32_32x32x16_bf16 v[36:51], v[124:127], v[132:135], v[36:51]
    s_add_u32 s15, s8, 114688
    buffer_load_dwordx4 v[124:127], v3, s[48:51], s15 offen offset:0 sc1
    v_mfma_f32_32x32x16_bf16 v[68:83], v[128:131], v[132:135], v[68:83]
    v_mfma_f32_32x32x16_bf16 v[84:99], v[128:131], v[136:139], v[84:99]
    s_add_u32 s15, s8, 225280
    buffer_load_dwordx4 v[128:131], v3, s[48:51], s15 offen offset:0 sc1
    s_add_u32 s15, s18, 4096
    buffer_load_dwordx4 v[132:135], v3, s[36:39], s15 offen offset:0 sc1
    s_add_u32 s15, s18, 114688
    buffer_load_dwordx4 v[136:139], v3, s[36:39], s15 offen offset:0 sc1
    v_mov_b32 v162, 0
    v_mov_b32 v163, s98
    s_mov_b64 exec, 1
    buffer_store_dword v163, v162, s[36:39], s16 offen offset:128 sc1
    s_mov_b64 exec, -1
    s_waitcnt vmcnt(15)
    v_mfma_f32_32x32x16_bf16 v[4:19], v[140:143], v[152:155], v[4:19]
    v_mfma_f32_32x32x16_bf16 v[20:35], v[140:143], v[156:159], v[20:35]
    s_add_u32 s15, s8, 4096
    buffer_load_dwordx4 v[140:143], v3, s[48:51], s15 offen offset:1024 sc1
    v_mfma_f32_32x32x16_bf16 v[52:67], v[144:147], v[156:159], v[52:67]
    v_mfma_f32_32x32x16_bf16 v[36:51], v[144:147], v[152:155], v[36:51]
    s_add_u32 s15, s8, 114688
    buffer_load_dwordx4 v[144:147], v3, s[48:51], s15 offen offset:1024 sc1
    v_mfma_f32_32x32x16_bf16 v[68:83], v[148:151], v[152:155], v[68:83]
    v_mfma_f32_32x32x16_bf16 v[84:99], v[148:151], v[156:159], v[84:99]
    s_add_u32 s15, s8, 225280
    buffer_load_dwordx4 v[148:151], v3, s[48:51], s15 offen offset:1024 sc1
    s_add_u32 s15, s18, 4096
    buffer_load_dwordx4 v[152:155], v3, s[36:39], s15 offen offset:1024 sc1
    s_add_u32 s15, s18, 114688
    buffer_load_dwordx4 v[156:159], v3, s[36:39], s15 offen offset:1024 sc1
    s_barrier
    s_add_u32 m0, s41, 0
    s_add_u32 s15, s40, 196608
    buffer_load_dwordx4 v3, s[28:31], s15 offen offset:0 sc1 lds
    buffer_load_dwordx4 v3, s[28:31], s15 offen offset:1024 sc1 lds
    buffer_load_dwordx4 v3, s[28:31], s15 offen offset:2048 sc1 lds
    buffer_load_dwordx4 v3, s[28:31], s15 offen offset:3072 sc1 lds
    s_waitcnt vmcnt(15)
    v_mfma_f32_32x32x16_bf16 v[4:19], v[100:103], v[112:115], v[4:19]
    v_mfma_f32_32x32x16_bf16 v[20:35], v[100:103], v[116:119], v[20:35]
    s_add_u32 s15, s8, 4096
    buffer_load_dwordx4 v[100:103], v3, s[48:51], s15 offen offset:2048 sc1
    v_mfma_f32_32x32x16_bf16 v[52:67], v[104:107], v[116:119], v[52:67]
    v_mfma_f32_32x32x16_bf16 v[36:51], v[104:107], v[112:115], v[36:51]
    s_add_u32 s15, s8, 114688
    buffer_load_dwordx4 v[104:107], v3, s[48:51], s15 offen offset:2048 sc1
    v_mfma_f32_32x32x16_bf16 v[68:83], v[108:111], v[112:115], v[68:83]
    v_mfma_f32_32x32x16_bf16 v[84:99], v[108:111], v[116:119], v[84:99]
    s_add_u32 s15, s8, 225280
    buffer_load_dwordx4 v[108:111], v3, s[48:51], s15 offen offset:2048 sc1
    s_add_u32 s15, s18, 4096
    buffer_load_dwordx4 v[112:115], v3, s[36:39], s15 offen offset:2048 sc1
    s_add_u32 s15, s18, 114688
    buffer_load_dwordx4 v[116:119], v3, s[36:39], s15 offen offset:2048 sc1
    s_waitcnt vmcnt(15)
    v_mfma_f32_32x32x16_bf16 v[4:19], v[120:123], v[132:135], v[4:19]
    v_mfma_f32_32x32x16_bf16 v[20:35], v[120:123], v[136:139], v[20:35]
    s_add_u32 s15, s8, 4096
    buffer_load_dwordx4 v[120:123], v3, s[48:51], s15 offen offset:3072 sc1
    v_mfma_f32_32x32x16_bf16 v[52:67], v[124:127], v[136:139], v[52:67]
    v_mfma_f32_32x32x16_bf16 v[36:51], v[124:127], v[132:135], v[36:51]
    s_add_u32 s15, s8, 114688
    buffer_load_dwordx4 v[124:127], v3, s[48:51], s15 offen offset:3072 sc1
    v_mfma_f32_32x32x16_bf16 v[68:83], v[128:131], v[132:135], v[68:83]
    v_mfma_f32_32x32x16_bf16 v[84:99], v[128:131], v[136:139], v[84:99]
    s_add_u32 s15, s8, 225280
    buffer_load_dwordx4 v[128:131], v3, s[48:51], s15 offen offset:3072 sc1
    s_add_u32 s15, s18, 4096
    buffer_load_dwordx4 v[132:135], v3, s[36:39], s15 offen offset:3072 sc1
    s_add_u32 s15, s18, 114688
    buffer_load_dwordx4 v[136:139], v3, s[36:39], s15 offen offset:3072 sc1
    s_waitcnt vmcnt(14)
    v_mfma_f32_32x32x16_bf16 v[4:19], v[140:143], v[152:155], v[4:19]
    v_mfma_f32_32x32x16_bf16 v[20:35], v[140:143], v[156:159], v[20:35]
    s_add_u32 s15, s8, 8192
    buffer_load_dwordx4 v[140:143], v3, s[48:51], s15 offen offset:0 sc1
    v_mfma_f32_32x32x16_bf16 v[52:67], v[144:147], v[156:159], v[52:67]
    v_mfma_f32_32x32x16_bf16 v[36:51], v[144:147], v[152:155], v[36:51]
    s_add_u32 s15, s8, 118784
    buffer_load_dwordx4 v[144:147], v3, s[48:51], s15 offen offset:0 sc1
    v_mfma_f32_32x32x16_bf16 v[68:83], v[148:151], v[152:155], v[68:83]
    v_mfma_f32_32x32x16_bf16 v[84:99], v[148:151], v[156:159], v[84:99]
    s_add_u32 s15, s8, 229376
    buffer_load_dwordx4 v[148:151], v3, s[48:51], s15 offen offset:0 sc1
    s_add_u32 s15, s18, 8192
    buffer_load_dwordx4 v[152:155], v3, s[36:39], s15 offen offset:0 sc1
    s_add_u32 s15, s18, 118784
    buffer_load_dwordx4 v[156:159], v3, s[36:39], s15 offen offset:0 sc1
    s_barrier
    s_add_u32 m0, s41, 16384
    s_add_u32 s15, s40, 212992
    buffer_load_dwordx4 v3, s[28:31], s15 offen offset:0 sc1 lds
    buffer_load_dwordx4 v3, s[28:31], s15 offen offset:1024 sc1 lds
    buffer_load_dwordx4 v3, s[28:31], s15 offen offset:2048 sc1 lds
    buffer_load_dwordx4 v3, s[28:31], s15 offen offset:3072 sc1 lds
    s_waitcnt vmcnt(14)
    v_mfma_f32_32x32x16_bf16 v[4:19], v[100:103], v[112:115], v[4:19]
    v_mfma_f32_32x32x16_bf16 v[20:35], v[100:103], v[116:119], v[20:35]
    s_add_u32 s15, s8, 8192
    buffer_load_dwordx4 v[100:103], v3, s[48:51], s15 offen offset:1024 sc1
    v_mfma_f32_32x32x16_bf16 v[52:67], v[104:107], v[116:119], v[52:67]
    v_mfma_f32_32x32x16_bf16 v[36:51], v[104:107], v[112:115], v[36:51]
    s_add_u32 s15, s8, 118784
    buffer_load_dwordx4 v[104:107], v3, s[48:51], s15 offen offset:1024 sc1
    v_mfma_f32_32x32x16_bf16 v[68:83], v[108:111], v[112:115], v[68:83]
    v_mfma_f32_32x32x16_bf16 v[84:99], v[108:111], v[116:119], v[84:99]
    s_add_u32 s15, s8, 229376
    buffer_load_dwordx4 v[108:111], v3, s[48:51], s15 offen offset:1024 sc1
    s_add_u32 s15, s18, 8192
    buffer_load_dwordx4 v[112:115], v3, s[36:39], s15 offen offset:1024 sc1
    s_add_u32 s15, s18, 118784
    buffer_load_dwordx4 v[116:119], v3, s[36:39], s15 offen offset:1024 sc1
    s_waitcnt vmcnt(14)
    v_mfma_f32_32x32x16_bf16 v[4:19], v[120:123], v[132:135], v[4:19]
    v_mfma_f32_32x32x16_bf16 v[20:35], v[120:123], v[136:139], v[20:35]
    s_add_u32 s15, s8, 8192
    buffer_load_dwordx4 v[120:123], v3, s[48:51], s15 offen offset:2048 sc1
    v_mfma_f32_32x32x16_bf16 v[52:67], v[124:127], v[136:139], v[52:67]
    v_mfma_f32_32x32x16_bf16 v[36:51], v[124:127], v[132:135], v[36:51]
    s_add_u32 s15, s8, 118784
    buffer_load_dwordx4 v[124:127], v3, s[48:51], s15 offen offset:2048 sc1
    v_mfma_f32_32x32x16_bf16 v[68:83], v[128:131], v[132:135], v[68:83]
    v_mfma_f32_32x32x16_bf16 v[84:99], v[128:131], v[136:139], v[84:99]
    s_add_u32 s15, s8, 229376
    buffer_load_dwordx4 v[128:131], v3, s[48:51], s15 offen offset:2048 sc1
    s_add_u32 s15, s18, 8192
    buffer_load_dwordx4 v[132:135], v3, s[36:39], s15 offen offset:2048 sc1
    s_add_u32 s15, s18, 118784
    buffer_load_dwordx4 v[136:139], v3, s[36:39], s15 offen offset:2048 sc1
    s_waitcnt vmcnt(14)
    v_mfma_f32_32x32x16_bf16 v[4:19], v[140:143], v[152:155], v[4:19]
    v_mfma_f32_32x32x16_bf16 v[20:35], v[140:143], v[156:159], v[20:35]
    s_add_u32 s15, s8, 8192
    buffer_load_dwordx4 v[140:143], v3, s[48:51], s15 offen offset:3072 sc1
    v_mfma_f32_32x32x16_bf16 v[52:67], v[144:147], v[156:159], v[52:67]
    v_mfma_f32_32x32x16_bf16 v[36:51], v[144:147], v[152:155], v[36:51]
    s_add_u32 s15, s8, 118784
    buffer_load_dwordx4 v[144:147], v3, s[48:51], s15 offen offset:3072 sc1
    v_mfma_f32_32x32x16_bf16 v[68:83], v[148:151], v[152:155], v[68:83]
    v_mfma_f32_32x32x16_bf16 v[84:99], v[148:151], v[156:159], v[84:99]
    s_add_u32 s15, s8, 229376
    buffer_load_dwordx4 v[148:151], v3, s[48:51], s15 offen offset:3072 sc1
    s_add_u32 s15, s18, 8192
    buffer_load_dwordx4 v[152:155], v3, s[36:39], s15 offen offset:3072 sc1
    s_add_u32 s15, s18, 118784
    buffer_load_dwordx4 v[156:159], v3, s[36:39], s15 offen offset:3072 sc1
    s_barrier
    s_add_u32 m0, s41, 32768
    s_add_u32 s15, s40, 229376
    buffer_load_dwordx4 v3, s[28:31], s15 offen offset:0 sc1 lds
    buffer_load_dwordx4 v3, s[28:31], s15 offen offset:1024 sc1 lds
    buffer_load_dwordx4 v3, s[28:31], s15 offen offset:2048 sc1 lds
    buffer_load_dwordx4 v3, s[28:31], s15 offen offset:3072 sc1 lds
    s_waitcnt vmcnt(14)
    v_mfma_f32_32x32x16_bf16 v[4:19], v[100:103], v[112:115], v[4:19]
    v_mfma_f32_32x32x16_bf16 v[20:35], v[100:103], v[116:119], v[20:35]
    s_add_u32 s15, s8, 12288
    buffer_load_dwordx4 v[100:103], v3, s[48:51], s15 offen offset:0 sc1
    v_mfma_f32_32x32x16_bf16 v[52:67], v[104:107], v[116:119], v[52:67]
    v_mfma_f32_32x32x16_bf16 v[36:51], v[104:107], v[112:115], v[36:51]
    s_add_u32 s15, s8, 122880
    buffer_load_dwordx4 v[104:107], v3, s[48:51], s15 offen offset:0 sc1
    v_mfma_f32_32x32x16_bf16 v[68:83], v[108:111], v[112:115], v[68:83]
    v_mfma_f32_32x32x16_bf16 v[84:99], v[108:111], v[116:119], v[84:99]
    s_add_u32 s15, s8, 233472
    buffer_load_dwordx4 v[108:111], v3, s[48:51], s15 offen offset:0 sc1
    s_add_u32 s15, s18, 12288
    buffer_load_dwordx4 v[112:115], v3, s[36:39], s15 offen offset:0 sc1
    s_add_u32 s15, s18, 122880
    buffer_load_dwordx4 v[116:119], v3, s[36:39], s15 offen offset:0 sc1
    s_waitcnt vmcnt(14)
    v_mfma_f32_32x32x16_bf16 v[4:19], v[120:123], v[132:135], v[4:19]
    v_mfma_f32_32x32x16_bf16 v[20:35], v[120:123], v[136:139], v[20:35]
    s_add_u32 s15, s8, 12288
    buffer_load_dwordx4 v[120:123], v3, s[48:51], s15 offen offset:1024 sc1
    v_mfma_f32_32x32x16_bf16 v[52:67], v[124:127], v[136:139], v[52:67]
    v_mfma_f32_32x32x16_bf16 v[36:51], v[124:127], v[132:135], v[36:51]
    s_add_u32 s15, s8, 122880
    buffer_load_dwordx4 v[124:127], v3, s[48:51], s15 offen offset:1024 sc1
    v_mfma_f32_32x32x16_bf16 v[68:83], v[128:131], v[132:135], v[68:83]
    v_mfma_f32_32x32x16_bf16 v[84:99], v[128:131], v[136:139], v[84:99]
    s_add_u32 s15, s8, 233472
    buffer_load_dwordx4 v[128:131], v3, s[48:51], s15 offen offset:1024 sc1
    s_add_u32 s15, s18, 12288
    buffer_load_dwordx4 v[132:135], v3, s[36:39], s15 offen offset:1024 sc1
    s_add_u32 s15, s18, 122880
    buffer_load_dwordx4 v[136:139], v3, s[36:39], s15 offen offset:1024 sc1
    s_waitcnt vmcnt(14)
    v_mfma_f32_32x32x16_bf16 v[4:19], v[140:143], v[152:155], v[4:19]
    v_mfma_f32_32x32x16_bf16 v[20:35], v[140:143], v[156:159], v[20:35]
    s_add_u32 s15, s8, 12288
    buffer_load_dwordx4 v[140:143], v3, s[48:51], s15 offen offset:2048 sc1
    v_mfma_f32_32x32x16_bf16 v[52:67], v[144:147], v[156:159], v[52:67]
    v_mfma_f32_32x32x16_bf16 v[36:51], v[144:147], v[152:155], v[36:51]
    s_add_u32 s15, s8, 122880
    buffer_load_dwordx4 v[144:147], v3, s[48:51], s15 offen offset:2048 sc1
    v_mfma_f32_32x32x16_bf16 v[68:83], v[148:151], v[152:155], v[68:83]
    v_mfma_f32_32x32x16_bf16 v[84:99], v[148:151], v[156:159], v[84:99]
    s_add_u32 s15, s8, 233472
    buffer_load_dwordx4 v[148:151], v3, s[48:51], s15 offen offset:2048 sc1
    s_add_u32 s15, s18, 12288
    buffer_load_dwordx4 v[152:155], v3, s[36:39], s15 offen offset:2048 sc1
    s_add_u32 s15, s18, 122880
    buffer_load_dwordx4 v[156:159], v3, s[36:39], s15 offen offset:2048 sc1
    v_and_b32 v160, 31, v0
    v_lshlrev_b32 v160, 2, v160
    buffer_load_dword v161, v160, s[36:39], s14 offen offset:128 sc1
    s_barrier
    s_add_u32 m0, s41, 49152
    s_add_u32 s15, s40, 245760
    buffer_load_dwordx4 v3, s[28:31], s15 offen offset:0 sc1 lds
    buffer_load_dwordx4 v3, s[28:31], s15 offen offset:1024 sc1 lds
    buffer_load_dwordx4 v3, s[28:31], s15 offen offset:2048 sc1 lds
    buffer_load_dwordx4 v3, s[28:31], s15 offen offset:3072 sc1 lds
    s_waitcnt vmcnt(15)
    v_mfma_f32_32x32x16_bf16 v[4:19], v[100:103], v[112:115], v[4:19]
    v_mfma_f32_32x32x16_bf16 v[20:35], v[100:103], v[116:119], v[20:35]
    s_add_u32 s15, s8, 12288
    buffer_load_dwordx4 v[100:103], v3, s[48:51], s15 offen offset:3072 sc1
    v_mfma_f32_32x32x16_bf16 v[52:67], v[104:107], v[116:119], v[52:67]
    v_mfma_f32_32x32x16_bf16 v[36:51], v[104:107], v[112:115], v[36:51]
    s_add_u32 s15, s8, 122880
    buffer_load_dwordx4 v[104:107], v3, s[48:51], s15 offen offset:3072 sc1
    v_mfma_f32_32x32x16_bf16 v[68:83], v[108:111], v[112:115], v[68:83]
    v_mfma_f32_32x32x16_bf16 v[84:99], v[108:111], v[116:119], v[84:99]
    s_add_u32 s15, s8, 233472
    buffer_load_dwordx4 v[108:111], v3, s[48:51], s15 offen offset:3072 sc1
    s_add_u32 s15, s18, 12288
    buffer_load_dwordx4 v[112:115], v3, s[36:39], s15 offen offset:3072 sc1
    s_add_u32 s15, s18, 122880
    buffer_load_dwordx4 v[116:119], v3, s[36:39], s15 offen offset:3072 sc1
    s_waitcnt vmcnt(15)
    s_waitcnt vmcnt(9)
    v_cmp_ne_u32 vcc, s98, v161
    s_mov_b32 s13, 0x4000
    s_nop 3
    s_cbranch_vccz polld_73
poll_72:
    buffer_load_dword v161, v160, s[36:39], s14 offen offset:128 sc1
    s_waitcnt vmcnt(0)
    v_cmp_ne_u32 vcc, s98, v161
    s_sub_u32 s13, s13, 1
    s_nop 3
    s_cbranch_vccz polld_73
    s_cmp_eq_u32 s13, 0
    s_cbranch_scc1 polld_73
    s_sleep 2
    s_branch poll_72
polld_73:
    v_mfma_f32_32x32x16_bf16 v[4:19], v[120:123], v[132:135], v[4:19]
    v_mfma_f32_32x32x16_bf16 v[20:35], v[120:123], v[136:139], v[20:35]
    s_add_u32 s15, s9, 0
    buffer_load_dwordx4 v[120:123], v3, s[48:51], s15 offen offset:0 sc1
    v_mfma_f32_32x32x16_bf16 v[52:67], v[124:127], v[136:139], v[52:67]
    v_mfma_f32_32x32x16_bf16 v[36:51], v[124:127], v[132:135], v[36:51]
    s_add_u32 s15, s9, 110592
    buffer_load_dwordx4 v[124:127], v3, s[48:51], s15 offen offset:0 sc1
    v_mfma_f32_32x32x16_bf16 v[68:83], v[128:131], v[132:135], v[68:83]
    v_mfma_f32_32x32x16_bf16 v[84:99], v[128:131], v[136:139], v[84:99]
    s_add_u32 s15, s9, 221184
    buffer_load_dwordx4 v[128:131], v3, s[48:51], s15 offen offset:0 sc1
    s_add_u32 s15, s19, 0
    buffer_load_dwordx4 v[132:135], v3, s[36:39], s15 offen offset:0 sc1
    s_add_u32 s15, s19, 110592
    buffer_load_dwordx4 v[136:139], v3, s[36:39], s15 offen offset:0 sc1
    v_mfma_f32_32x32x16_bf16 v[4:19], v[140:143], v[152:155], v[4:19]
    v_mfma_f32_32x32x16_bf16 v[20:35], v[140:143], v[156:159], v[20:35]
    s_add_u32 s15, s9, 0
    buffer_load_dwordx4 v[140:143], v3, s[48:51], s15 offen offset:1024 sc1
    v_mfma_f32_32x32x16_bf16 v[52:67], v[144:147], v[156:159], v[52:67]
    v_mfma_f32_32x32x16_bf16 v[36:51], v[144:147], v[152:155], v[36:51]
    s_add_u32 s15, s9, 110592
    buffer_load_dwordx4 v[144:147], v3, s[48:51], s15 offen offset:1024 sc1
    v_mfma_f32_32x32x16_bf16 v[68:83], v[148:151], v[152:155], v[68:83]
    v_mfma_f32_32x32x16_bf16 v[84:99], v[148:151], v[156:159], v[84:99]
    s_add_u32 s15, s9, 221184
    buffer_load_dwordx4 v[148:151], v3, s[48:51], s15 offen offset:1024 sc1
    s_add_u32 s15, s19, 0
    buffer_load_dwordx4 v[152:155], v3, s[36:39], s15 offen offset:1024 sc1
    s_add_u32 s15, s19, 110592
    buffer_load_dwordx4 v[156:159], v3, s[36:39], s15 offen offset:1024 sc1
    s_barrier
    s_waitcnt vmcnt(10)
    v_mfma_f32_32x32x16_bf16 v[4:19], v[100:103], v[112:115], v[4:19]
    v_mfma_f32_32x32x16_bf16 v[20:35], v[100:103], v[116:119], v[20:35]
    s_add_u32 s15, s9, 0
    buffer_load_dwordx4 v[100:103], v3, s[48:51], s15 offen offset:2048 sc1
    v_mfma_f32_32x32x16_bf16 v[52:67], v[104:107], v[116:119], v[52:67]
    v_mfma_f32_32x32x16_bf16 v[36:51], v[104:107], v[112:115], v[36:51]
    s_add_u32 s15, s9, 110592
    buffer_load_dwordx4 v[104:107], v3, s[48:51], s15 offen offset:2048 sc1
    v_mfma_f32_32x32x16_bf16 v[68:83], v[108:111], v[112:115], v[68:83]
    v_mfma_f32_32x32x16_bf16 v[84:99], v[108:111], v[116:119], v[84:99]
    s_add_u32 s15, s9, 221184
    buffer_load_dwordx4 v[108:111], v3, s[48:51], s15 offen offset:2048 sc1
    s_add_u32 s15, s19, 0
    buffer_load_dwordx4 v[112:115], v3, s[36:39], s15 offen offset:2048 sc1
    s_add_u32 s15, s19, 110592
    buffer_load_dwordx4 v[116:119], v3, s[36:39], s15 offen offset:2048 sc1
    s_waitcnt vmcnt(10)
    v_mfma_f32_32x32x16_bf16 v[4:19], v[120:123], v[132:135], v[4:19]
    v_mfma_f32_32x32x16_bf16 v[20:35], v[120:123], v[136:139], v[20:35]
    s_add_u32 s15, s9, 0
    buffer_load_dwordx4 v[120:123], v3, s[48:51], s15 offen offset:3072 sc1
    v_mfma_f32_32x32x16_bf16 v[52:67], v[124:127], v[136:139], v[52:67]
    v_mfma_f32_32x32x16_bf16 v[36:51], v[124:127], v[132:135], v[36:51]
    s_add_u32 s15, s9, 110592
    buffer_load_dwordx4 v[124:127], v3, s[48:51], s15 offen offset:3072 sc1
    v_mfma_f32_32x32x16_bf16 v[68:83], v[128:131], v[132:135], v[68:83]
    v_mfma_f32_32x32x16_bf16 v[84:99], v[128:131], v[136:139], v[84:99]
    s_add_u32 s15, s9, 221184
    buffer_load_dwordx4 v[128:131], v3, s[48:51], s15 offen offset:3072 sc1
    s_add_u32 s15, s19, 0
    buffer_load_dwordx4 v[132:135], v3, s[36:39], s15 offen offset:3072 sc1
    s_add_u32 s15, s19, 110592
    buffer_load_dwordx4 v[136:139], v3, s[36:39], s15 offen offset:3072 sc1
    s_waitcnt vmcnt(10)
    v_mfma_f32_32x32x16_bf16 v[4:19], v[140:143], v[152:155], v[4:19]
    v_mfma_f32_32x32x16_bf16 v[20:35], v[140:143], v[156:159], v[20:35]
    s_add_u32 s15, s9, 4096
    buffer_load_dwordx4 v[140:143], v3, s[48:51], s15 offen offset:0 sc1
    v_mfma_f32_32x32x16_bf16 v[52:67], v[144:147], v[156:159], v[52:67]
    v_mfma_f32_32x32x16_bf16 v[36:51], v[144:147], v[152:155], v[36:51]
    s_add_u32 s15, s9, 114688
    buffer_load_dwordx4 v[144:147], v3, s[48:51], s15 offen offset:0 sc1
    v_mfma_f32_32x32x16_bf16 v[68:83], v[148:151], v[152:155], v[68:83]
    v_mfma_f32_32x32x16_bf16 v[84:99], v[148:151], v[156:159], v[84:99]
    s_add_u32 s15, s9, 225280
    buffer_load_dwordx4 v[148:151], v3, s[48:51], s15 offen offset:0 sc1
    s_add_u32 s15, s19, 4096
    buffer_load_dwordx4 v[152:155], v3, s[36:39], s15 offen offset:0 sc1
    s_add_u32 s15, s19, 114688
    buffer_load_dwordx4 v[156:159], v3, s[36:39], s15 offen offset:0 sc1
    s_barrier
    s_waitcnt vmcnt(10)
    v_mfma_f32_32x32x16_bf16 v[4:19], v[100:103], v[112:115], v[4:19]
    v_mfma_f32_32x32x16_bf16 v[20:35], v[100:103], v[116:119], v[20:35]
    s_add_u32 s15, s9, 4096
    buffer_load_dwordx4 v[100:103], v3, s[48:51], s15 offen offset:1024 sc1
    v_mfma_f32_32x32x16_bf16 v[52:67], v[104:107], v[116:119], v[52:67]
    v_mfma_f32_32x32x16_bf16 v[36:51], v[104:107], v[112:115], v[36:51]
    s_add_u32 s15, s9, 114688
    buffer_load_dwordx4 v[104:107], v3, s[48:51], s15 offen offset:1024 sc1
    v_mfma_f32_32x32x16_bf16 v[68:83], v[108:111], v[112:115], v[68:83]
    v_mfma_f32_32x32x16_bf16 v[84:99], v[108:111], v[116:119], v[84:99]
    s_add_u32 s15, s9, 225280
    buffer_load_dwordx4 v[108:111], v3, s[48:51], s15 offen offset:1024 sc1
    s_add_u32 s15, s19, 4096
    buffer_load_dwordx4 v[112:115], v3, s[36:39], s15 offen offset:1024 sc1
    s_add_u32 s15, s19, 114688
    buffer_load_dwordx4 v[116:119], v3, s[36:39], s15 offen offset:1024 sc1
    s_waitcnt vmcnt(10)
    v_mfma_f32_32x32x16_bf16 v[4:19], v[120:123], v[132:135], v[4:19]
    v_mfma_f32_32x32x16_bf16 v[20:35], v[120:123], v[136:139], v[20:35]
    s_add_u32 s15, s9, 4096
    buffer_load_dwordx4 v[120:123], v3, s[48:51], s15 offen offset:2048 sc1
    v_mfma_f32_32x32x16_bf16 v[52:67], v[124:127], v[136:139], v[52:67]
    v_mfma_f32_32x32x16_bf16 v[36:51], v[124:127], v[132:135], v[36:51]
    s_add_u32 s15, s9, 114688
    buffer_load_dwordx4 v[124:127], v3, s[48:51], s15 offen offset:2048 sc1
    v_mfma_f32_32x32x16_bf16 v[68:83], v[128:131], v[132:135], v[68:83]
    v_mfma_f32_32x32x16_bf16 v[84:99], v[128:131], v[136:139], v[84:99]
    s_add_u32 s15, s9, 225280
    buffer_load_dwordx4 v[128:131], v3, s[48:51], s15 offen offset:2048 sc1
    s_add_u32 s15, s19, 4096
    buffer_load_dwordx4 v[132:135], v3, s[36:39], s15 offen offset:2048 sc1
    s_add_u32 s15, s19, 114688
    buffer_load_dwordx4 v[136:139], v3, s[36:39], s15 offen offset:2048 sc1
    s_waitcnt vmcnt(10)
    v_mfma_f32_32x32x16_bf16 v[4:19], v[140:143], v[152:155], v[4:19]
    v_mfma_f32_32x32x16_bf16 v[20:35], v[140:143], v[156:159], v[20:35]
    s_add_u32 s15, s9, 4096
    buffer_load_dwordx4 v[140:143], v3, s[48:51], s15 offen offset:3072 sc1
    v_mfma_f32_32x32x16_bf16 v[52:67], v[144:147], v[156:159], v[52:67]
    v_mfma_f32_32x32x16_bf16 v[36:51], v[144:147], v[152:155], v[36:51]
    s_add_u32 s15, s9, 114688
    buffer_load_dwordx4 v[144:147], v3, s[48:51], s15 offen offset:3072 sc1
    v_mfma_f32_32x32x16_bf16 v[68:83], v[148:151], v[152:155], v[68:83]
    v_mfma_f32_32x32x16_bf16 v[84:99], v[148:151], v[156:159], v[84:99]
    s_add_u32 s15, s9, 225280
    buffer_load_dwordx4 v[148:151], v3, s[48:51], s15 offen offset:3072 sc1
    s_add_u32 s15, s19, 4096
    buffer_load_dwordx4 v[152:155], v3, s[36:39], s15 offen offset:3072 sc1
    s_add_u32 s15, s19, 114688
    buffer_load_dwordx4 v[156:159], v3, s[36:39], s15 offen offset:3072 sc1
    s_barrier
    s_waitcnt vmcnt(10)
    v_mfma_f32_32x32x16_bf16 v[4:19], v[100:103], v[112:115], v[4:19]
    v_mfma_f32_32x32x16_bf16 v[20:35], v[100:103], v[116:119], v[20:35]
    s_add_u32 s15, s9, 8192
    buffer_load_dwordx4 v[100:103], v3, s[48:51], s15 offen offset:0 sc1
    v_mfma_f32_32x32x16_bf16 v[52:67], v[104:107], v[116:119], v[52:67]
    v_mfma_f32_32x32x16_bf16 v[36:51], v[104:107], v[112:115], v[36:51]
    s_add_u32 s15, s9, 118784
    buffer_load_dwordx4 v[104:107], v3, s[48:51], s15 offen offset:0 sc1
    v_mfma_f32_32x32x16_bf16 v[68:83], v[108:111], v[112:115], v[68:83]
    v_mfma_f32_32x32x16_bf16 v[84:99], v[108:111], v[116:119], v[84:99]
    s_add_u32 s15, s9, 229376
    buffer_load_dwordx4 v[108:111], v3, s[48:51], s15 offen offset:0 sc1
    s_add_u32 s15, s19, 8192
    buffer_load_dwordx4 v[112:115], v3, s[36:39], s15 offen offset:0 sc1
    s_add_u32 s15, s19, 118784
    buffer_load_dwordx4 v[116:119], v3, s[36:39], s15 offen offset:0 sc1
    s_waitcnt vmcnt(10)
    v_mfma_f32_32x32x16_bf16 v[4:19], v[120:123], v[132:135], v[4:19]
    v_mfma_f32_32x32x16_bf16 v[20:35], v[120:123], v[136:139], v[20:35]
    s_add_u32 s15, s9, 8192
    buffer_load_dwordx4 v[120:123], v3, s[48:51], s15 offen offset:1024 sc1
    v_mfma_f32_32x32x16_bf16 v[52:67], v[124:127], v[136:139], v[52:67]
    v_mfma_f32_32x32x16_bf16 v[36:51], v[124:127], v[132:135], v[36:51]
    s_add_u32 s15, s9, 118784
    buffer_load_dwordx4 v[124:127], v3, s[48:51], s15 offen offset:1024 sc1
    v_mfma_f32_32x32x16_bf16 v[68:83], v[128:131], v[132:135], v[68:83]
    v_mfma_f32_32x32x16_bf16 v[84:99], v[128:131], v[136:139], v[84:99]
    s_add_u32 s15, s9, 229376
    buffer_load_dwordx4 v[128:131], v3, s[48:51], s15 offen offset:1024 sc1
    s_add_u32 s15, s19, 8192
    buffer_load_dwordx4 v[132:135], v3, s[36:39], s15 offen offset:1024 sc1
    s_add_u32 s15, s19, 118784
    buffer_load_dwordx4 v[136:139], v3, s[36:39], s15 offen offset:1024 sc1
    s_waitcnt vmcnt(10)
    v_mfma_f32_32x32x16_bf16 v[4:19], v[140:143], v[152:155], v[4:19]
    v_mfma_f32_32x32x16_bf16 v[20:35], v[140:143], v[156:159], v[20:35]
    s_add_u32 s15, s9, 8192
    buffer_load_dwordx4 v[140:143], v3, s[48:51], s15 offen offset:2048 sc1
    v_mfma_f32_32x32x16_bf16 v[52:67], v[144:147], v[156:159], v[52:67]
    v_mfma_f32_32x32x16_bf16 v[36:51], v[144:147], v[152:155], v[36:51]
    s_add_u32 s15, s9, 118784
    buffer_load_dwordx4 v[144:147], v3, s[48:51], s15 offen offset:2048 sc1
    v_mfma_f32_32x32x16_bf16 v[68:83], v[148:151], v[152:155], v[68:83]
    v_mfma_f32_32x32x16_bf16 v[84:99], v[148:151], v[156:159], v[84:99]
    s_add_u32 s15, s9, 229376
    buffer_load_dwordx4 v[148:151], v3, s[48:51], s15 offen offset:2048 sc1
    s_add_u32 s15, s19, 8192
    buffer_load_dwordx4 v[152:155], v3, s[36:39], s15 offen offset:2048 sc1
    s_add_u32 s15, s19, 118784
    buffer_load_dwordx4 v[156:159], v3, s[36:39], s15 offen offset:2048 sc1
    s_waitcnt vmcnt(10)
    v_mfma_f32_32x32x16_bf16 v[4:19], v[100:103], v[112:115], v[4:19]
    v_mfma_f32_32x32x16_bf16 v[20:35], v[100:103], v[116:119], v[20:35]
    v_mfma_f32_32x32x16_bf16 v[52:67], v[104:107], v[116:119], v[52:67]
    v_mfma_f32_32x32x16_bf16 v[36:51], v[104:107], v[112:115], v[36:51]
    v_mfma_f32_32x32x16_bf16 v[68:83], v[108:111], v[112:115], v[68:83]
    v_mfma_f32_32x32x16_bf16 v[84:99], v[108:111], v[116:119], v[84:99]
    s_waitcnt vmcnt(5)
    v_mfma_f32_32x32x16_bf16 v[4:19], v[120:123], v[132:135], v[4:19]
    v_mfma_f32_32x32x16_bf16 v[20:35], v[120:123], v[136:139], v[20:35]
    v_mfma_f32_32x32x16_bf16 v[52:67], v[124:127], v[136:139], v[52:67]
    v_mfma_f32_32x32x16_bf16 v[36:51], v[124:127], v[132:135], v[36:51]
    v_mfma_f32_32x32x16_bf16 v[68:83], v[128:131], v[132:135], v[68:83]
    v_mfma_f32_32x32x16_bf16 v[84:99], v[128:131], v[136:139], v[84:99]
    s_waitcnt vmcnt(0)
    v_mfma_f32_32x32x16_bf16 v[4:19], v[140:143], v[152:155], v[4:19]
    v_mfma_f32_32x32x16_bf16 v[20:35], v[140:143], v[156:159], v[20:35]
    v_mfma_f32_32x32x16_bf16 v[52:67], v[144:147], v[156:159], v[52:67]
    v_mfma_f32_32x32x16_bf16 v[36:51], v[144:147], v[152:155], v[36:51]
    v_mfma_f32_32x32x16_bf16 v[68:83], v[148:151], v[152:155], v[68:83]
    v_mfma_f32_32x32x16_bf16 v[84:99], v[148:151], v[156:159], v[84:99]
    s_add_u32 s52, s20, 12582912
    s_addc_u32 s53, s21, 0
    s_mov_b32 s54, 819200
    s_mov_b32 s55, 0x20000
    s_add_u32 s56, s20, 13631488
    s_addc_u32 s57, s21, 0
    s_mov_b32 s58, 2621440
    s_mov_b32 s59, 0x20000
    s_mul_i32 s80, s3, 43
    s_lshr_b32 s80, s80, 7
    s_mul_i32 s81, s80, 3
    s_sub_u32 s81, s3, s81
    s_lshr_b32 s82, s4, 1
    s_mul_i32 s82, s82, 5
    s_and_b32 s83, s4, 1
    s_mul_i32 s84, s83, 3
    s_add_u32 s82, s82, s84
    s_add_u32 s82, s82, s81
    s_mul_i32 s84, s82, 40960
    s_mul_i32 s82, s80, 10240
    s_add_u32 s84, s84, s82
    s_lshl_b32 s86, s80, 0
    s_mul_i32 s86, s80, 10240
    s_cmp_eq_u32 s81, 2
    s_cselect_b32 s85, s83, 0
    s_xor_b32 s85, s85, 1
    s_add_u32 s80, s3, 0
    s_mul_i32 s81, s80, 52429
    s_lshr_b32 s81, s81, 18
    s_mul_i32 s82, s81, 5
    s_sub_u32 s82, s80, s82
    s_mul_i32 s81, s81, 10240
    s_lshl_b32 s82, s82, 10
    s_add_u32 s92, s81, s82
    s_add_u32 s80, s3, 12
    s_mul_i32 s81, s80, 52429
    s_lshr_b32 s81, s81, 18
    s_mul_i32 s82, s81, 5
    s_sub_u32 s82, s80, s82
    s_mul_i32 s81, s81, 10240
    s_lshl_b32 s82, s82, 10
    s_add_u32 s93, s81, s82
    s_add_u32 s80, s3, 24
    s_mul_i32 s81, s80, 52429
    s_lshr_b32 s81, s81, 18
    s_mul_i32 s82, s81, 5
    s_sub_u32 s82, s80, s82
    s_mul_i32 s81, s81, 10240
    s_lshl_b32 s82, s82, 10
    s_add_u32 s94, s81, s82
    s_add_u32 s80, s3, 36
    s_mul_i32 s81, s80, 52429
    s_lshr_b32 s81, s81, 18
    s_mul_i32 s82, s81, 5
    s_sub_u32 s82, s80, s82
    s_mul_i32 s81, s81, 10240
    s_lshl_b32 s82, s82, 10
    s_add_u32 s95, s81, s82
    s_mul_i32 s97, s5, 81920
    s_mov_b32 s44, s22
    s_mov_b32 s45, s23
    s_mov_b32 s46, 2621440
    s_mov_b32 s47, 0x20000
    v_and_b32 v166, 31, v0
    s_lshl_b32 s13, s5, 6
    v_add_u32 v166, s13, v166
    v_mul_u32_u24 v166, 1280, v166
    v_lshrrev_b32 v161, 5, v0
    v_lshl_add_u32 v166, v161, 3, v166
    s_lshl_b32 s13, s12, 6
    s_lshl_b32 s15, s6, 4
    s_add_u32 s13, s13, s15
    v_add_u32 v166, s13, v166
    s_mov_b32 s15, 0
    buffer_load_dwordx2 v[124:125], v166, s[44:47], s15 offen
    s_mov_b32 s15, 40960
    buffer_load_dwordx2 v[126:127], v166, s[44:47], s15 offen
    s_mov_b32 s15, 64
    buffer_load_dwordx2 v[128:129], v166, s[44:47], s15 offen
    s_mov_b32 s15, 41024
    buffer_load_dwordx2 v[130:131], v166, s[44:47], s15 offen
    s_mov_b32 s15, 128
    buffer_load_dwordx2 v[132:133], v166, s[44:47], s15 offen
    s_mov_b32 s15, 41088
    buffer_load_dwordx2 v[134:135], v166, s[44:47], s15 offen
    s_mul_i32 s13, s6, 18432
    v_add_u32 v164, s13, v3
    s_cmp_lg_u32 s6, 0
    s_cbranch_scc1 rw_75
    s_nop 15
    ds_write_b128 v164, v[8:11] offset:0
    ds_write_b128 v164, v[12:15] offset:1024
    ds_write_b128 v164, v[16:19] offset:2048
    ds_write_b128 v164, v[24:27] offset:3072
    ds_write_b128 v164, v[28:31] offset:4096
    ds_write_b128 v164, v[32:35] offset:5120
    ds_write_b128 v164, v[40:43] offset:6144
    ds_write_b128 v164, v[44:47] offset:7168
    ds_write_b128 v164, v[48:51] offset:8192
    ds_write_b128 v164, v[56:59] offset:9216
    ds_write_b128 v164, v[60:63] offset:10240
    ds_write_b128 v164, v[64:67] offset:11264
    ds_write_b128 v164, v[72:75] offset:12288
    ds_write_b128 v164, v[76:79] offset:13312
    ds_write_b128 v164, v[80:83] offset:14336
    ds_write_b128 v164, v[88:91] offset:15360
    ds_write_b128 v164, v[92:95] offset:16384
    ds_write_b128 v164, v[96:99] offset:17408
    v_mov_b32 v100, v4
    v_mov_b32 v101, v5
    v_mov_b32 v102, v6
    v_mov_b32 v103, v7
    v_mov_b32 v104, v20
    v_mov_b32 v105, v21
    v_mov_b32 v106, v22
    v_mov_b32 v107, v23
    v_mov_b32 v108, v36
    v_mov_b32 v109, v37
    v_mov_b32 v110, v38
    v_mov_b32 v111, v39
    v_mov_b32 v112, v52
    v_mov_b32 v113, v53
    v_mov_b32 v114, v54
    v_mov_b32 v115, v55
    v_mov_b32 v116, v68
    v_mov_b32 v117, v69
    v_mov_b32 v118, v70
    v_mov_b32 v119, v71
    v_mov_b32 v120, v84
    v_mov_b32 v121, v85
    v_mov_b32 v122, v86
    v_mov_b32 v123, v87
    s_branch rw_done_74
rw_75:
    s_cmp_lg_u32 s6, 1
    s_cbranch_scc1 rw_76
    s_nop 15
    ds_write_b128 v164, v[4:7] offset:2048
    ds_write_b128 v164, v[12:15] offset:0
    ds_write_b128 v164, v[16:19] offset:1024
    ds_write_b128 v164, v[20:23] offset:5120
    ds_write_b128 v164, v[28:31] offset:3072
    ds_write_b128 v164, v[32:35] offset:4096
    ds_write_b128 v164, v[36:39] offset:8192
    ds_write_b128 v164, v[44:47] offset:6144
    ds_write_b128 v164, v[48:51] offset:7168
    ds_write_b128 v164, v[52:55] offset:11264
    ds_write_b128 v164, v[60:63] offset:9216
    ds_write_b128 v164, v[64:67] offset:10240
    ds_write_b128 v164, v[68:71] offset:14336
    ds_write_b128 v164, v[76:79] offset:12288
    ds_write_b128 v164, v[80:83] offset:13312
    ds_write_b128 v164, v[84:87] offset:17408
    ds_write_b128 v164, v[92:95] offset:15360
    ds_write_b128 v164, v[96:99] offset:16384
    v_mov_b32 v100, v8
    v_mov_b32 v101, v9
    v_mov_b32 v102, v10
    v_mov_b32 v103, v11
    v_mov_b32 v104, v24
    v_mov_b32 v105, v25
    v_mov_b32 v106, v26
    v_mov_b32 v107, v27
    v_mov_b32 v108, v40
    v_mov_b32 v109, v41
    v_mov_b32 v110, v42
    v_mov_b32 v111, v43
    v_mov_b32 v112, v56
    v_mov_b32 v113, v57
    v_mov_b32 v114, v58
    v_mov_b32 v115, v59
    v_mov_b32 v116, v72
    v_mov_b32 v117, v73
    v_mov_b32 v118, v74
    v_mov_b32 v119, v75
    v_mov_b32 v120, v88
    v_mov_b32 v121, v89
    v_mov_b32 v122, v90
    v_mov_b32 v123, v91
    s_branch rw_done_74
rw_76:
    s_cmp_lg_u32 s6, 2
    s_cbranch_scc1 rw_77
    s_nop 15
    ds_write_b128 v164, v[4:7] offset:1024
    ds_write_b128 v164, v[8:11] offset:2048
    ds_write_b128 v164, v[16:19] offset:0
    ds_write_b128 v164, v[20:23] offset:4096
    ds_write_b128 v164, v[24:27] offset:5120
    ds_write_b128 v164, v[32:35] offset:3072
    ds_write_b128 v164, v[36:39] offset:7168
    ds_write_b128 v164, v[40:43] offset:8192
    ds_write_b128 v164, v[48:51] offset:6144
    ds_write_b128 v164, v[52:55] offset:10240
    ds_write_b128 v164, v[56:59] offset:11264
    ds_write_b128 v164, v[64:67] offset:9216
    ds_write_b128 v164, v[68:71] offset:13312
    ds_write_b128 v164, v[72:75] offset:14336
    ds_write_b128 v164, v[80:83] offset:12288
    ds_write_b128 v164, v[84:87] offset:16384
    ds_write_b128 v164, v[88:91] offset:17408
    ds_write_b128 v164, v[96:99] offset:15360
    v_mov_b32 v100, v12
    v_mov_b32 v101, v13
    v_mov_b32 v102, v14
    v_mov_b32 v103, v15
    v_mov_b32 v104, v28
    v_mov_b32 v105, v29
    v_mov_b32 v106, v30
    v_mov_b32 v107, v31
    v_mov_b32 v108, v44
    v_mov_b32 v109, v45
    v_mov_b32 v110, v46
    v_mov_b32 v111, v47
    v_mov_b32 v112, v60
    v_mov_b32 v113, v61
    v_mov_b32 v114, v62
    v_mov_b32 v115, v63
    v_mov_b32 v116, v76
    v_mov_b32 v117, v77
    v_mov_b32 v118, v78
    v_mov_b32 v119, v79
    v_mov_b32 v120, v92
    v_mov_b32 v121, v93
    v_mov_b32 v122, v94
    v_mov_b32 v123, v95
    s_branch rw_done_74
rw_77:
    s_nop 15
    ds_write_b128 v164, v[4:7] offset:0
    ds_write_b128 v164, v[8:11] offset:1024
    ds_write_b128 v164, v[12:15] offset:2048
    ds_write_b128 v164, v[20:23] offset:3072
    ds_write_b128 v164, v[24:27] offset:4096
    ds_write_b128 v164, v[28:31] offset:5120
    ds_write_b128 v164, v[36:39] offset:6144
    ds_write_b128 v164, v[40:43] offset:7168
    ds_write_b128 v164, v[44:47] offset:8192
    ds_write_b128 v164, v[52:55] offset:9216
    ds_write_b128 v164, v[56:59] offset:10240
    ds_write_b128 v164, v[60:63] offset:11264
    ds_write_b128 v164, v[68:71] offset:12288
    ds_write_b128 v164, v[72:75] offset:13312
    ds_write_b128 v164, v[76:79] offset:14336
    ds_write_b128 v164, v[84:87] offset:15360
    ds_write_b128 v164, v[88:91] offset:16384
    ds_write_b128 v164, v[92:95] offset:17408
    v_mov_b32 v100, v16
    v_mov_b32 v101, v17
    v_mov_b32 v102, v18
    v_mov_b32 v103, v19
    v_mov_b32 v104, v32
    v_mov_b32 v105, v33
    v_mov_b32 v106, v34
    v_mov_b32 v107, v35
    v_mov_b32 v108, v48
    v_mov_b32 v109, v49
    v_mov_b32 v110, v50
    v_mov_b32 v111, v51
    v_mov_b32 v112, v64
    v_mov_b32 v113, v65
    v_mov_b32 v114, v66
    v_mov_b32 v115, v67
    v_mov_b32 v116, v80
    v_mov_b32 v117, v81
    v_mov_b32 v118, v82
    v_mov_b32 v119, v83
    v_mov_b32 v120, v96
    v_mov_b32 v121, v97
    v_mov_b32 v122, v98
    v_mov_b32 v123, v99
rw_done_74:
    s_waitcnt lgkmcnt(0)
    s_barrier
    s_add_u32 s80, s92, 0
    s_add_u32 m0, s80, 73728
    s_add_u32 s80, s80, s97
    buffer_load_dwordx4 v3, s[56:59], s80 offen sc1 lds
    s_add_u32 s80, s93, 0
    s_add_u32 m0, s80, 73728
    s_add_u32 s80, s80, s97
    buffer_load_dwordx4 v3, s[56:59], s80 offen sc1 lds
    s_add_u32 s80, s94, 0
    s_add_u32 m0, s80, 73728
    s_add_u32 s80, s80, s97
    buffer_load_dwordx4 v3, s[56:59], s80 offen sc1 lds
    s_cmp_ge_u32 s3, 4
    s_cbranch_scc1 t_no4_79
    s_add_u32 s80, s95, 0
    s_add_u32 m0, s80, 73728
    s_add_u32 s80, s80, s97
    buffer_load_dwordx4 v3, s[56:59], s80 offen sc1 lds
t_no4_79:
    s_add_u32 s80, s92, 5120
    s_add_u32 m0, s80, 73728
    s_add_u32 s80, s80, s97
    buffer_load_dwordx4 v3, s[56:59], s80 offen sc1 lds
    s_add_u32 s80, s93, 5120
    s_add_u32 m0, s80, 73728
    s_add_u32 s80, s80, s97
    buffer_load_dwordx4 v3, s[56:59], s80 offen sc1 lds
    s_add_u32 s80, s94, 5120
    s_add_u32 m0, s80, 73728
    s_add_u32 s80, s80, s97
    buffer_load_dwordx4 v3, s[56:59], s80 offen sc1 lds
    s_cmp_ge_u32 s3, 4
    s_cbranch_scc1 t_no4_80
    s_add_u32 s80, s95, 5120
    s_add_u32 m0, s80, 73728
    s_add_u32 s80, s80, s97
    buffer_load_dwordx4 v3, s[56:59], s80 offen sc1 lds
t_no4_80:
    s_add_u32 s13, s6, 1
    s_and_b32 s13, s13, 3
    s_mul_i32 s13, s13, 18432
    v_add_u32 v165, s13, v3
    ds_read_b128 v[4:7], v165 offset:2048
    ds_read_b128 v[8:11], v165 offset:5120
    ds_read_b128 v[12:15], v165 offset:8192
    ds_read_b128 v[16:19], v165 offset:11264
    ds_read_b128 v[20:23], v165 offset:14336
    ds_read_b128 v[24:27], v165 offset:17408
    s_add_u32 s13, s6, 2
    s_and_b32 s13, s13, 3
    s_mul_i32 s13, s13, 18432
    v_add_u32 v165, s13, v3
    ds_read_b128 v[28:31], v165 offset:1024
    ds_read_b128 v[32:35], v165 offset:4096
    ds_read_b128 v[36:39], v165 offset:7168
    ds_read_b128 v[40:43], v165 offset:10240
    ds_read_b128 v[44:47], v165 offset:13312
    ds_read_b128 v[48:51], v165 offset:16384
    s_add_u32 s13, s6, 3
    s_and_b32 s13, s13, 3
    s_mul_i32 s13, s13, 18432
    v_add_u32 v165, s13, v3
    ds_read_b128 v[52:55], v165 offset:0
    ds_read_b128 v[56:59], v165 offset:3072
    ds_read_b128 v[60:63], v165 offset:6144
    ds_read_b128 v[64:67], v165 offset:9216
    ds_read_b128 v[68:71], v165 offset:12288
    ds_read_b128 v[72:75], v165 offset:15360
    s_mov_b32 s8, 0x3f317218
    s_waitcnt vmcnt(6) lgkmcnt(0)
    v_add_f32 v100, v100, v4
    v_add_f32 v101, v101, v5
    v_add_f32 v102, v102, v6
    v_add_f32 v103, v103, v7
    v_add_f32 v100, v100, v28
    v_add_f32 v101, v101, v29
    v_add_f32 v102, v102, v30
    v_add_f32 v103, v103, v31
    v_add_f32 v100, v100, v52
    v_add_f32 v101, v101, v53
    v_add_f32 v102, v102, v54
    v_add_f32 v103, v103, v55
    v_lshlrev_b32 v76, 16, v124
    v_and_b32 v77, 0xffff0000, v124
    v_lshlrev_b32 v78, 16, v125
    v_and_b32 v79, 0xffff0000, v125
    v_fma_f32 v100, v100, s8, v76
    v_fma_f32 v101, v101, s8, v77
    v_fma_f32 v102, v102, s8, v78
    v_fma_f32 v103, v103, s8, v79
    v_add_f32 v104, v104, v8
    v_add_f32 v105, v105, v9
    v_add_f32 v106, v106, v10
    v_add_f32 v107, v107, v11
    v_add_f32 v104, v104, v32
    v_add_f32 v105, v105, v33
    v_add_f32 v106, v106, v34
    v_add_f32 v107, v107, v35
    v_add_f32 v104, v104, v56
    v_add_f32 v105, v105, v57
    v_add_f32 v106, v106, v58
    v_add_f32 v107, v107, v59
    v_lshlrev_b32 v76, 16, v126
    v_and_b32 v77, 0xffff0000, v126
    v_lshlrev_b32 v78, 16, v127
    v_and_b32 v79, 0xffff0000, v127
    v_fma_f32 v104, v104, s8, v76
    v_fma_f32 v105, v105, s8, v77
    v_fma_f32 v106, v106, s8, v78
    v_fma_f32 v107, v107, s8, v79
    v_add_f32 v108, v108, v12
    v_add_f32 v109, v109, v13
    v_add_f32 v110, v110, v14
    v_add_f32 v111, v111, v15
    v_add_f32 v108, v108, v36
    v_add_f32 v109, v109, v37
    v_add_f32 v110, v110, v38
    v_add_f32 v111, v111, v39
    v_add_f32 v108, v108, v60
    v_add_f32 v109, v109, v61
    v_add_f32 v110, v110, v62
    v_add_f32 v111, v111, v63
    v_lshlrev_b32 v76, 16, v128
    v_and_b32 v77, 0xffff0000, v128
    v_lshlrev_b32 v78, 16, v129
    v_and_b32 v79, 0xffff0000, v129
    v_fma_f32 v108, v108, s8, v76
    v_fma_f32 v109, v109, s8, v77
    v_fma_f32 v110, v110, s8, v78
    v_fma_f32 v111, v111, s8, v79
    v_add_f32 v112, v112, v16
    v_add_f32 v113, v113, v17
    v_add_f32 v114, v114, v18
    v_add_f32 v115, v115, v19
    v_add_f32 v112, v112, v40
    v_add_f32 v113, v113, v41
    v_add_f32 v114, v114, v42
    v_add_f32 v115, v115, v43
    v_add_f32 v112, v112, v64
    v_add_f32 v113, v113, v65
    v_add_f32 v114, v114, v66
    v_add_f32 v115, v115, v67
    v_lshlrev_b32 v76, 16, v130
    v_and_b32 v77, 0xffff0000, v130
    v_lshlrev_b32 v78, 16, v131
    v_and_b32 v79, 0xffff0000, v131
    v_fma_f32 v112, v112, s8, v76
    v_fma_f32 v113, v113, s8, v77
    v_fma_f32 v114, v114, s8, v78
    v_fma_f32 v115, v115, s8, v79
    v_add_f32 v116, v116, v20
    v_add_f32 v117, v117, v21
    v_add_f32 v118, v118, v22
    v_add_f32 v119, v119, v23
    v_add_f32 v116, v116, v44
    v_add_f32 v117, v117, v45
    v_add_f32 v118, v118, v46
    v_add_f32 v119, v119, v47
    v_add_f32 v116, v116, v68
    v_add_f32 v117, v117, v69
    v_add_f32 v118, v118, v70
    v_add_f32 v119, v119, v71
    v_lshlrev_b32 v76, 16, v132
    v_and_b32 v77, 0xffff0000, v132
    v_lshlrev_b32 v78, 16, v133
    v_and_b32 v79, 0xffff0000, v133
    v_fma_f32 v116, v116, s8, v76
    v_fma_f32 v117, v117, s8, v77
    v_fma_f32 v118, v118, s8, v78
    v_fma_f32 v119, v119, s8, v79
    v_add_f32 v120, v120, v24
    v_add_f32 v121, v121, v25
    v_add_f32 v122, v122, v26
    v_add_f32 v123, v123, v27
    v_add_f32 v120, v120, v48
    v_add_f32 v121, v121, v49
    v_add_f32 v122, v122, v50
    v_add_f32 v123, v123, v51
    v_add_f32 v120, v120, v72
    v_add_f32 v121, v121, v73
    v_add_f32 v122, v122, v74
    v_add_f32 v123, v123, v75
    v_lshlrev_b32 v76, 16, v134
    v_and_b32 v77, 0xffff0000, v134
    v_lshlrev_b32 v78, 16, v135
    v_and_b32 v79, 0xffff0000, v135
    v_fma_f32 v120, v120, s8, v76
    v_fma_f32 v121, v121, s8, v77
    v_fma_f32 v122, v122, s8, v78
    v_fma_f32 v123, v123, s8, v79
    s_add_u32 s80, s84, 0
    buffer_load_dwordx4 v[4:7], v3, s[52:55], s80 offen offset:0 sc1
    s_add_u32 s80, s84, 0
    buffer_load_dwordx4 v[8:11], v3, s[52:55], s80 offen offset:1024 sc1
    s_add_u32 s80, s84, 0
    buffer_load_dwordx4 v[12:15], v3, s[52:55], s80 offen offset:2048 sc1
    s_add_u32 s80, s84, 0
    buffer_load_dwordx4 v[16:19], v3, s[52:55], s80 offen offset:3072 sc1
    s_add_u32 s80, s84, 4096
    buffer_load_dwordx4 v[20:23], v3, s[52:55], s80 offen offset:0 sc1
    s_add_u32 s80, s84, 4096
    buffer_load_dwordx4 v[24:27], v3, s[52:55], s80 offen offset:1024 sc1
    s_add_u32 s80, s84, 4096
    buffer_load_dwordx4 v[28:31], v3, s[52:55], s80 offen offset:2048 sc1
    s_add_u32 s80, s84, 4096
    buffer_load_dwordx4 v[32:35], v3, s[52:55], s80 offen offset:3072 sc1
    s_add_u32 s80, s84, 8192
    buffer_load_dwordx4 v[36:39], v3, s[52:55], s80 offen offset:0 sc1
    s_add_u32 s80, s84, 8192
    buffer_load_dwordx4 v[40:43], v3, s[52:55], s80 offen offset:1024 sc1
    s_waitcnt vmcnt(13)
    s_add_u32 s80, s86, 73728
    v_add_u32 v1, s80, v3
    v_add_u32 v2, 40960, v1
    s_barrier
    s_cmp_eq_u32 s85, 0
    s_cbranch_scc1 t_skip_81
    s_waitcnt vmcnt(5)
    ds_read_b128 v[124:127], v1 offset:0
    ds_read_b128 v[128:131], v2 offset:0
    ds_read_b128 v[132:135], v1 offset:1024
    ds_read_b128 v[136:139], v2 offset:1024
    ds_read_b128 v[140:143], v1 offset:2048
    ds_read_b128 v[144:147], v2 offset:2048
    ds_read_b128 v[148:151], v1 offset:3072
    ds_read_b128 v[152:155], v2 offset:3072
    s_waitcnt lgkmcnt(6)
    v_mfma_f32_32x32x16_bf16 v[44:59], v[4:7], v[124:127], 0
    v_mfma_f32_32x32x16_bf16 v[60:75], v[4:7], v[128:131], 0
    ds_read_b128 v[124:127], v1 offset:4096
    ds_read_b128 v[128:131], v2 offset:4096
    s_waitcnt lgkmcnt(6)
    v_mfma_f32_32x32x16_bf16 v[44:59], v[8:11], v[132:135], v[44:59]
    v_mfma_f32_32x32x16_bf16 v[60:75], v[8:11], v[136:139], v[60:75]
    s_waitcnt lgkmcnt(4)
    v_mfma_f32_32x32x16_bf16 v[44:59], v[12:15], v[140:143], v[44:59]
    v_mfma_f32_32x32x16_bf16 v[60:75], v[12:15], v[144:147], v[60:75]
    s_waitcnt lgkmcnt(2)
    v_mfma_f32_32x32x16_bf16 v[44:59], v[16:19], v[148:151], v[44:59]
    v_mfma_f32_32x32x16_bf16 v[60:75], v[16:19], v[152:155], v[60:75]
    s_waitcnt lgkmcnt(0)
    v_mfma_f32_32x32x16_bf16 v[44:59], v[20:23], v[124:127], v[44:59]
    v_mfma_f32_32x32x16_bf16 v[60:75], v[20:23], v[128:131], v[60:75]
    s_waitcnt vmcnt(0)
    s_barrier
    ds_read_b128 v[132:135], v1 offset:5120
    ds_read_b128 v[136:139], v2 offset:5120
    ds_read_b128 v[140:143], v1 offset:6144
    ds_read_b128 v[144:147], v2 offset:6144
    ds_read_b128 v[148:151], v1 offset:7168
    ds_read_b128 v[152:155], v2 offset:7168
    ds_read_b128 v[124:127], v1 offset:8192
    ds_read_b128 v[128:131], v2 offset:8192
    s_waitcnt lgkmcnt(6)
    v_mfma_f32_32x32x16_bf16 v[44:59], v[24:27], v[132:135], v[44:59]
    v_mfma_f32_32x32x16_bf16 v[60:75], v[24:27], v[136:139], v[60:75]
    ds_read_b128 v[132:135], v1 offset:9216
    ds_read_b128 v[136:139], v2 offset:9216
    s_waitcnt lgkmcnt(6)
    v_mfma_f32_32x32x16_bf16 v[44:59], v[28:31], v[140:143], v[44:59]
    v_mfma_f32_32x32x16_bf16 v[60:75], v[28:31], v[144:147], v[60:75]
    s_waitcnt lgkmcnt(4)
    v_mfma_f32_32x32x16_bf16 v[44:59], v[32:35], v[148:151], v[44:59]
    v_mfma_f32_32x32x16_bf16 v[60:75], v[32:35], v[152:155], v[60:75]
    s_waitcnt lgkmcnt(2)
    v_mfma_f32_32x32x16_bf16 v[44:59], v[36:39], v[124:127], v[44:59]
    v_mfma_f32_32x32x16_bf16 v[60:75], v[36:39], v[128:131], v[60:75]
    s_waitcnt lgkmcnt(0)
    v_mfma_f32_32x32x16_bf16 v[44:59], v[40:43], v[132:135], v[44:59]
    v_mfma_f32_32x32x16_bf16 v[60:75], v[40:43], v[136:139], v[60:75]
    s_barrier
    s_lshl_b32 s80, s3, 13
    v_add_u32 v1, s80, v3
    s_nop 7
    ds_write_b128 v1, v[44:47] offset:0
    ds_write_b128 v1, v[48:51] offset:1024
    ds_write_b128 v1, v[52:55] offset:2048
    ds_write_b128 v1, v[56:59] offset:3072
    ds_write_b128 v1, v[60:63] offset:4096
    ds_write_b128 v1, v[64:67] offset:5120
    ds_write_b128 v1, v[68:71] offset:6144
    ds_write_b128 v1, v[72:75] offset:7168
    s_waitcnt lgkmcnt(0)
    s_branch t_done_82
t_skip_81:
    s_waitcnt vmcnt(0)
    s_barrier
    s_barrier
t_done_82:
    s_barrier
    s_mov_b32 s44, s88
    s_mov_b32 s45, s89
    s_mov_b32 s46, 2621440
    s_mov_b32 s47, 0x20000
    s_lshl_b32 s13, s6, 10
    v_add_u32 v1, s13, v3
    v_add_u32 v2, 49152, v1
    ds_read_b128 v[4:7], v1 offset:0
    ds_read_b128 v[8:11], v1 offset:24576
    ds_read_b128 v[12:15], v2 offset:0
    ds_read_b128 v[16:19], v2 offset:24576
    ds_read_b128 v[20:23], v1 offset:4096
    ds_read_b128 v[24:27], v1 offset:28672
    ds_read_b128 v[28:31], v2 offset:4096
    ds_read_b128 v[32:35], v2 offset:28672
    s_waitcnt lgkmcnt(0)
    ds_read_b128 v[36:39], v1 offset:8192
    ds_read_b128 v[40:43], v1 offset:32768
    ds_read_b128 v[44:47], v2 offset:8192
    ds_read_b128 v[48:51], v2 offset:32768
    ds_read_b128 v[52:55], v1 offset:12288
    ds_read_b128 v[56:59], v1 offset:36864
    ds_read_b128 v[60:63], v2 offset:12288
    ds_read_b128 v[64:67], v2 offset:36864
    s_waitcnt lgkmcnt(0)
    ds_read_b128 v[68:71], v1 offset:16384
    ds_read_b128 v[72:75], v1 offset:40960
    ds_read_b128 v[76:79], v2 offset:16384
    ds_read_b128 v[80:83], v2 offset:40960
    ds_read_b128 v[84:87], v1 offset:20480
    ds_read_b128 v[88:91], v1 offset:45056
    ds_read_b128 v[92:95], v2 offset:20480
    ds_read_b128 v[96:99], v2 offset:45056
    s_waitcnt lgkmcnt(0)
    v_add_f32 v100, v100, v4
    v_add_f32 v101, v101, v5
    v_add_f32 v102, v102, v6
    v_add_f32 v103, v103, v7
    v_add_f32 v100, v100, v8
    v_add_f32 v101, v101, v9
    v_add_f32 v102, v102, v10
    v_add_f32 v103, v103, v11
    v_add_f32 v100, v100, v12
    v_add_f32 v101, v101, v13
    v_add_f32 v102, v102, v14
    v_add_f32 v103, v103, v15
    v_add_f32 v100, v100, v16
    v_add_f32 v101, v101, v17
    v_add_f32 v102, v102, v18
    v_add_f32 v103, v103, v19
    v_cvt_pk_bf16_f32 v100, v100, v101
    v_cvt_pk_bf16_f32 v101, v102, v103
    s_mov_b32 s15, 0
    buffer_store_dwordx2 v[100:101], v166, s[44:47], s15 offen
    v_add_f32 v104, v104, v20
    v_add_f32 v105, v105, v21
    v_add_f32 v106, v106, v22
    v_add_f32 v107, v107, v23
    v_add_f32 v104, v104, v24
    v_add_f32 v105, v105, v25
    v_add_f32 v106, v106, v26
    v_add_f32 v107, v107, v27
    v_add_f32 v104, v104, v28
    v_add_f32 v105, v105, v29
    v_add_f32 v106, v106, v30
    v_add_f32 v107, v107, v31
    v_add_f32 v104, v104, v32
    v_add_f32 v105, v105, v33
    v_add_f32 v106, v106, v34
    v_add_f32 v107, v107, v35
    v_cvt_pk_bf16_f32 v104, v104, v105
    v_cvt_pk_bf16_f32 v105, v106, v107
    s_mov_b32 s15, 40960
    buffer_store_dwordx2 v[104:105], v166, s[44:47], s15 offen
    v_add_f32 v108, v108, v36
    v_add_f32 v109, v109, v37
    v_add_f32 v110, v110, v38
    v_add_f32 v111, v111, v39
    v_add_f32 v108, v108, v40
    v_add_f32 v109, v109, v41
    v_add_f32 v110, v110, v42
    v_add_f32 v111, v111, v43
    v_add_f32 v108, v108, v44
    v_add_f32 v109, v109, v45
    v_add_f32 v110, v110, v46
    v_add_f32 v111, v111, v47
    v_add_f32 v108, v108, v48
    v_add_f32 v109, v109, v49
    v_add_f32 v110, v110, v50
    v_add_f32 v111, v111, v51
    v_cvt_pk_bf16_f32 v108, v108, v109
    v_cvt_pk_bf16_f32 v109, v110, v111
    s_mov_b32 s15, 64
    buffer_store_dwordx2 v[108:109], v166, s[44:47], s15 offen
    v_add_f32 v112, v112, v52
    v_add_f32 v113, v113, v53
    v_add_f32 v114, v114, v54
    v_add_f32 v115, v115, v55
    v_add_f32 v112, v112, v56
    v_add_f32 v113, v113, v57
    v_add_f32 v114, v114, v58
    v_add_f32 v115, v115, v59
    v_add_f32 v112, v112, v60
    v_add_f32 v113, v113, v61
    v_add_f32 v114, v114, v62
    v_add_f32 v115, v115, v63
    v_add_f32 v112, v112, v64
    v_add_f32 v113, v113, v65
    v_add_f32 v114, v114, v66
    v_add_f32 v115, v115, v67
    v_cvt_pk_bf16_f32 v112, v112, v113
    v_cvt_pk_bf16_f32 v113, v114, v115
    s_mov_b32 s15, 41024
    buffer_store_dwordx2 v[112:113], v166, s[44:47], s15 offen
    v_add_f32 v116, v116, v68
    v_add_f32 v117, v117, v69
    v_add_f32 v118, v118, v70
    v_add_f32 v119, v119, v71
    v_add_f32 v116, v116, v72
    v_add_f32 v117, v117, v73
    v_add_f32 v118, v118, v74
    v_add_f32 v119, v119, v75
    v_add_f32 v116, v116, v76
    v_add_f32 v117, v117, v77
    v_add_f32 v118, v118, v78
    v_add_f32 v119, v119, v79
    v_add_f32 v116, v116, v80
    v_add_f32 v117, v117, v81
    v_add_f32 v118, v118, v82
    v_add_f32 v119, v119, v83
    v_cvt_pk_bf16_f32 v116, v116, v117
    v_cvt_pk_bf16_f32 v117, v118, v119
    s_mov_b32 s15, 128
    buffer_store_dwordx2 v[116:117], v166, s[44:47], s15 offen
    v_add_f32 v120, v120, v84
    v_add_f32 v121, v121, v85
    v_add_f32 v122, v122, v86
    v_add_f32 v123, v123, v87
    v_add_f32 v120, v120, v88
    v_add_f32 v121, v121, v89
    v_add_f32 v122, v122, v90
    v_add_f32 v123, v123, v91
    v_add_f32 v120, v120, v92
    v_add_f32 v121, v121, v93
    v_add_f32 v122, v122, v94
    v_add_f32 v123, v123, v95
    v_add_f32 v120, v120, v96
    v_add_f32 v121, v121, v97
    v_add_f32 v122, v122, v98
    v_add_f32 v123, v123, v99
    v_cvt_pk_bf16_f32 v120, v120, v121
    v_cvt_pk_bf16_f32 v121, v122, v123
    s_mov_b32 s15, 41088
    buffer_store_dwordx2 v[120:121], v166, s[44:47], s15 offen
    s_branch parallel_sum__grouped_kv_mqa__dense_activation_silu__prompt_kernel_end
parallel_sum__grouped_kv_mqa__dense_activation_silu__prompt_kernel_ffn_odd:
    s_mul_i32 s18, s7, 40960
    s_lshl_b32 s13, s7, 11
    s_add_u32 s10, s17, s13
    s_lshl_b32 s13, s8, 2
    s_add_u32 s13, s13, s6
    s_add_u32 s13, s13, 32
    s_lshl_b32 s11, s13, 11
    s_add_u32 s11, s11, s17
    s_mul_i32 s19, s13, 40960
    v_lshrrev_b32 v144, 5, v0
    v_mul_lo_u32 v144, v144, s95
    v_and_b32 v145, 15, v0
    v_lshrrev_b32 v146, 2, v145
    v_add_u32 v144, v144, v146
    v_lshlrev_b32 v144, 7, v144
    v_bfe_u32 v146, v0, 4, 1
    v_lshl_add_u32 v144, v146, 5, v144
    v_and_b32 v146, 3, v145
    v_lshl_add_u32 v144, v146, 3, v144
    s_lshr_b32 s13, s6, 1
    s_lshl_b32 s15, s13, 6
    s_mul_i32 s13, s13, s94
    s_add_u32 s13, s13, s93
    s_and_b32 s43, s6, 1
    s_mul_i32 s43, s43, 3
    s_lshl_b32 s42, s43, 11
    s_add_u32 s15, s15, s42
    s_add_u32 s15, s15, 151040
    s_lshl_b32 s43, s43, 10
    s_add_u32 s13, s13, s43
    v_add_u32 v144, s15, v144
    v_add_u32 v145, s99, v144
    ds_read_b64_tr_b16 v[132:133], v144 offset:0
    ds_read_b64_tr_b16 v[134:135], v145 offset:0
    ds_read_b64_tr_b16 v[136:137], v144 offset:2048
    ds_read_b64_tr_b16 v[138:139], v145 offset:2048
    ds_read_b64_tr_b16 v[140:141], v144 offset:4096
    ds_read_b64_tr_b16 v[142:143], v145 offset:4096
    s_waitcnt lgkmcnt(0)
    buffer_store_dwordx4 v[132:135], v3, s[36:39], s13 offen offset:0 sc1
    buffer_store_dwordx4 v[136:139], v3, s[36:39], s13 offen offset:1024 sc1
    buffer_store_dwordx4 v[140:143], v3, s[36:39], s13 offen offset:2048 sc1
    s_barrier
    s_barrier
    s_add_u32 m0, s41, 0
    s_add_u32 s15, s40, 0
    buffer_load_dwordx4 v3, s[28:31], s15 offen offset:0 sc1 lds
    buffer_load_dwordx4 v3, s[28:31], s15 offen offset:1024 sc1 lds
    buffer_load_dwordx4 v3, s[28:31], s15 offen offset:2048 sc1 lds
    buffer_load_dwordx4 v3, s[28:31], s15 offen offset:3072 sc1 lds
    s_add_u32 m0, s41, 16384
    s_add_u32 s15, s40, 16384
    buffer_load_dwordx4 v3, s[28:31], s15 offen offset:0 sc1 lds
    buffer_load_dwordx4 v3, s[28:31], s15 offen offset:1024 sc1 lds
    buffer_load_dwordx4 v3, s[28:31], s15 offen offset:2048 sc1 lds
    buffer_load_dwordx4 v3, s[28:31], s15 offen offset:3072 sc1 lds
    buffer_load_dwordx4 v[68:71], v3, s[44:47], s18 offen offset:0 sc1
    buffer_load_dwordx4 v[72:75], v3, s[44:47], s18 offen offset:1024 sc1
    buffer_load_dwordx4 v[76:79], v3, s[44:47], s18 offen offset:2048 sc1
    buffer_load_dwordx4 v[80:83], v3, s[44:47], s18 offen offset:3072 sc1
    s_add_u32 s18, s18, 4096
    buffer_load_dwordx4 v[84:87], v3, s[44:47], s18 offen offset:0 sc1
    buffer_load_dwordx4 v[88:91], v3, s[44:47], s18 offen offset:1024 sc1
    buffer_load_dwordx4 v[92:95], v3, s[44:47], s18 offen offset:2048 sc1
    buffer_load_dwordx4 v[96:99], v3, s[44:47], s18 offen offset:3072 sc1
    ds_read_b128 v[100:103], v164 offset:0
    ds_read_b128 v[104:107], v165 offset:0
    ds_read_b128 v[108:111], v164 offset:1056
    ds_read_b128 v[112:115], v165 offset:1056
    s_waitcnt vmcnt(7) lgkmcnt(2)
    v_mfma_f32_32x32x16_bf16 v[4:19], v[68:71], v[100:103], 0
    v_mfma_f32_32x32x16_bf16 v[20:35], v[68:71], v[104:107], 0
    ds_read_b128 v[116:119], v164 offset:2112
    ds_read_b128 v[120:123], v165 offset:2112
    s_add_u32 s18, s18, 4096
    buffer_load_dwordx4 v[68:71], v3, s[44:47], s18 offen offset:0 sc1
    s_waitcnt vmcnt(7) lgkmcnt(2)
    v_mfma_f32_32x32x16_bf16 v[4:19], v[72:75], v[108:111], v[4:19]
    v_mfma_f32_32x32x16_bf16 v[20:35], v[72:75], v[112:115], v[20:35]
    ds_read_b128 v[100:103], v164 offset:3168
    ds_read_b128 v[104:107], v165 offset:3168
    buffer_load_dwordx4 v[72:75], v3, s[44:47], s18 offen offset:1024 sc1
    s_waitcnt vmcnt(7) lgkmcnt(2)
    v_mfma_f32_32x32x16_bf16 v[4:19], v[76:79], v[116:119], v[4:19]
    v_mfma_f32_32x32x16_bf16 v[20:35], v[76:79], v[120:123], v[20:35]
    ds_read_b128 v[108:111], v164 offset:4224
    ds_read_b128 v[112:115], v165 offset:4224
    buffer_load_dwordx4 v[76:79], v3, s[44:47], s18 offen offset:2048 sc1
    s_waitcnt vmcnt(7) lgkmcnt(2)
    v_mfma_f32_32x32x16_bf16 v[4:19], v[80:83], v[100:103], v[4:19]
    v_mfma_f32_32x32x16_bf16 v[20:35], v[80:83], v[104:107], v[20:35]
    ds_read_b128 v[116:119], v164 offset:5280
    ds_read_b128 v[120:123], v165 offset:5280
    buffer_load_dwordx4 v[80:83], v3, s[44:47], s18 offen offset:3072 sc1
    s_barrier
    s_add_u32 m0, s41, 32768
    s_add_u32 s15, s40, 32768
    buffer_load_dwordx4 v3, s[28:31], s15 offen offset:0 sc1 lds
    buffer_load_dwordx4 v3, s[28:31], s15 offen offset:1024 sc1 lds
    buffer_load_dwordx4 v3, s[28:31], s15 offen offset:2048 sc1 lds
    buffer_load_dwordx4 v3, s[28:31], s15 offen offset:3072 sc1 lds
    s_add_u32 m0, s41, 49152
    s_add_u32 s15, s40, 49152
    buffer_load_dwordx4 v3, s[28:31], s15 offen offset:0 sc1 lds
    buffer_load_dwordx4 v3, s[28:31], s15 offen offset:1024 sc1 lds
    buffer_load_dwordx4 v3, s[28:31], s15 offen offset:2048 sc1 lds
    buffer_load_dwordx4 v3, s[28:31], s15 offen offset:3072 sc1 lds
    s_cmp_lg_u32 s6, 3
    s_cbranch_scc1 g2f_83
    s_lshl_b32 s13, s2, 2
    s_add_u32 s13, s13, 3804160
    v_mov_b32 v162, 0
    v_mov_b32 v163, s98
    s_mov_b64 exec, 1
    buffer_store_dword v163, v162, s[36:39], s13 offen sc1
    s_mov_b64 exec, -1
g2f_83:
    s_waitcnt vmcnt(15) lgkmcnt(2)
    v_mfma_f32_32x32x16_bf16 v[4:19], v[84:87], v[108:111], v[4:19]
    v_mfma_f32_32x32x16_bf16 v[20:35], v[84:87], v[112:115], v[20:35]
    ds_read_b128 v[100:103], v164 offset:6336
    ds_read_b128 v[104:107], v165 offset:6336
    s_add_u32 s18, s18, 4096
    buffer_load_dwordx4 v[84:87], v3, s[44:47], s18 offen offset:0 sc1
    s_waitcnt vmcnt(15) lgkmcnt(2)
    v_mfma_f32_32x32x16_bf16 v[4:19], v[88:91], v[116:119], v[4:19]
    v_mfma_f32_32x32x16_bf16 v[20:35], v[88:91], v[120:123], v[20:35]
    ds_read_b128 v[108:111], v164 offset:7392
    ds_read_b128 v[112:115], v165 offset:7392
    buffer_load_dwordx4 v[88:91], v3, s[44:47], s18 offen offset:1024 sc1
    s_waitcnt vmcnt(15) lgkmcnt(2)
    v_mfma_f32_32x32x16_bf16 v[4:19], v[92:95], v[100:103], v[4:19]
    v_mfma_f32_32x32x16_bf16 v[20:35], v[92:95], v[104:107], v[20:35]
    ds_read_b128 v[116:119], v164 offset:8448
    ds_read_b128 v[120:123], v165 offset:8448
    buffer_load_dwordx4 v[92:95], v3, s[44:47], s18 offen offset:2048 sc1
    s_waitcnt vmcnt(15) lgkmcnt(2)
    v_mfma_f32_32x32x16_bf16 v[4:19], v[96:99], v[108:111], v[4:19]
    v_mfma_f32_32x32x16_bf16 v[20:35], v[96:99], v[112:115], v[20:35]
    ds_read_b128 v[100:103], v164 offset:9504
    ds_read_b128 v[104:107], v165 offset:9504
    buffer_load_dwordx4 v[96:99], v3, s[44:47], s18 offen offset:3072 sc1
    s_waitcnt vmcnt(15) lgkmcnt(2)
    v_mfma_f32_32x32x16_bf16 v[4:19], v[68:71], v[116:119], v[4:19]
    v_mfma_f32_32x32x16_bf16 v[20:35], v[68:71], v[120:123], v[20:35]
    ds_read_b128 v[108:111], v164 offset:10560
    ds_read_b128 v[112:115], v165 offset:10560
    s_add_u32 s18, s18, 4096
    buffer_load_dwordx4 v[68:71], v3, s[44:47], s18 offen offset:0 sc1
    s_waitcnt vmcnt(15) lgkmcnt(2)
    v_mfma_f32_32x32x16_bf16 v[4:19], v[72:75], v[100:103], v[4:19]
    v_mfma_f32_32x32x16_bf16 v[20:35], v[72:75], v[104:107], v[20:35]
    ds_read_b128 v[116:119], v164 offset:11616
    ds_read_b128 v[120:123], v165 offset:11616
    buffer_load_dwordx4 v[72:75], v3, s[44:47], s18 offen offset:1024 sc1
    s_waitcnt vmcnt(15) lgkmcnt(2)
    v_mfma_f32_32x32x16_bf16 v[4:19], v[76:79], v[108:111], v[4:19]
    v_mfma_f32_32x32x16_bf16 v[20:35], v[76:79], v[112:115], v[20:35]
    ds_read_b128 v[100:103], v164 offset:12672
    ds_read_b128 v[104:107], v165 offset:12672
    buffer_load_dwordx4 v[76:79], v3, s[44:47], s18 offen offset:2048 sc1
    s_waitcnt vmcnt(15) lgkmcnt(2)
    v_mfma_f32_32x32x16_bf16 v[4:19], v[80:83], v[116:119], v[4:19]
    v_mfma_f32_32x32x16_bf16 v[20:35], v[80:83], v[120:123], v[20:35]
    ds_read_b128 v[108:111], v164 offset:13728
    ds_read_b128 v[112:115], v165 offset:13728
    buffer_load_dwordx4 v[80:83], v3, s[44:47], s18 offen offset:3072 sc1
    s_waitcnt vmcnt(12)
    s_barrier
    s_add_u32 m0, s41, 0
    s_add_u32 s15, s40, 65536
    buffer_load_dwordx4 v3, s[28:31], s15 offen offset:0 sc1 lds
    buffer_load_dwordx4 v3, s[28:31], s15 offen offset:1024 sc1 lds
    buffer_load_dwordx4 v3, s[28:31], s15 offen offset:2048 sc1 lds
    buffer_load_dwordx4 v3, s[28:31], s15 offen offset:3072 sc1 lds
    s_waitcnt vmcnt(11) lgkmcnt(2)
    v_mfma_f32_32x32x16_bf16 v[4:19], v[84:87], v[100:103], v[4:19]
    v_mfma_f32_32x32x16_bf16 v[20:35], v[84:87], v[104:107], v[20:35]
    ds_read_b128 v[116:119], v164 offset:14784
    ds_read_b128 v[120:123], v165 offset:14784
    s_add_u32 s18, s18, 4096
    buffer_load_dwordx4 v[84:87], v3, s[44:47], s18 offen offset:0 sc1
    s_waitcnt vmcnt(11) lgkmcnt(2)
    v_mfma_f32_32x32x16_bf16 v[4:19], v[88:91], v[108:111], v[4:19]
    v_mfma_f32_32x32x16_bf16 v[20:35], v[88:91], v[112:115], v[20:35]
    ds_read_b128 v[100:103], v164 offset:15840
    ds_read_b128 v[104:107], v165 offset:15840
    buffer_load_dwordx4 v[88:91], v3, s[44:47], s18 offen offset:1024 sc1
    s_waitcnt vmcnt(11) lgkmcnt(2)
    v_mfma_f32_32x32x16_bf16 v[4:19], v[92:95], v[116:119], v[4:19]
    v_mfma_f32_32x32x16_bf16 v[20:35], v[92:95], v[120:123], v[20:35]
    ds_read_b128 v[108:111], v164 offset:16896
    ds_read_b128 v[112:115], v165 offset:16896
    buffer_load_dwordx4 v[92:95], v3, s[44:47], s18 offen offset:2048 sc1
    s_waitcnt vmcnt(11) lgkmcnt(2)
    v_mfma_f32_32x32x16_bf16 v[4:19], v[96:99], v[100:103], v[4:19]
    v_mfma_f32_32x32x16_bf16 v[20:35], v[96:99], v[104:107], v[20:35]
    ds_read_b128 v[116:119], v164 offset:17952
    ds_read_b128 v[120:123], v165 offset:17952
    buffer_load_dwordx4 v[96:99], v3, s[44:47], s18 offen offset:3072 sc1
    s_waitcnt vmcnt(11) lgkmcnt(2)
    v_mfma_f32_32x32x16_bf16 v[4:19], v[68:71], v[108:111], v[4:19]
    v_mfma_f32_32x32x16_bf16 v[20:35], v[68:71], v[112:115], v[20:35]
    ds_read_b128 v[100:103], v164 offset:19008
    ds_read_b128 v[104:107], v165 offset:19008
    s_add_u32 s18, s18, 4096
    buffer_load_dwordx4 v[68:71], v3, s[44:47], s18 offen offset:0 sc1
    s_waitcnt vmcnt(11) lgkmcnt(2)
    v_mfma_f32_32x32x16_bf16 v[4:19], v[72:75], v[116:119], v[4:19]
    v_mfma_f32_32x32x16_bf16 v[20:35], v[72:75], v[120:123], v[20:35]
    ds_read_b128 v[108:111], v164 offset:20064
    ds_read_b128 v[112:115], v165 offset:20064
    buffer_load_dwordx4 v[72:75], v3, s[44:47], s18 offen offset:1024 sc1
    s_waitcnt vmcnt(11) lgkmcnt(2)
    v_mfma_f32_32x32x16_bf16 v[4:19], v[76:79], v[100:103], v[4:19]
    v_mfma_f32_32x32x16_bf16 v[20:35], v[76:79], v[104:107], v[20:35]
    ds_read_b128 v[116:119], v164 offset:21120
    ds_read_b128 v[120:123], v165 offset:21120
    buffer_load_dwordx4 v[76:79], v3, s[44:47], s18 offen offset:2048 sc1
    s_waitcnt vmcnt(11) lgkmcnt(2)
    v_mfma_f32_32x32x16_bf16 v[4:19], v[80:83], v[108:111], v[4:19]
    v_mfma_f32_32x32x16_bf16 v[20:35], v[80:83], v[112:115], v[20:35]
    ds_read_b128 v[100:103], v164 offset:22176
    ds_read_b128 v[104:107], v165 offset:22176
    buffer_load_dwordx4 v[80:83], v3, s[44:47], s18 offen offset:3072 sc1
    s_barrier
    s_add_u32 m0, s41, 16384
    s_add_u32 s15, s40, 81920
    buffer_load_dwordx4 v3, s[28:31], s15 offen offset:0 sc1 lds
    buffer_load_dwordx4 v3, s[28:31], s15 offen offset:1024 sc1 lds
    buffer_load_dwordx4 v3, s[28:31], s15 offen offset:2048 sc1 lds
    buffer_load_dwordx4 v3, s[28:31], s15 offen offset:3072 sc1 lds
    s_waitcnt vmcnt(11) lgkmcnt(2)
    v_mfma_f32_32x32x16_bf16 v[4:19], v[84:87], v[116:119], v[4:19]
    v_mfma_f32_32x32x16_bf16 v[20:35], v[84:87], v[120:123], v[20:35]
    ds_read_b128 v[108:111], v164 offset:23232
    ds_read_b128 v[112:115], v165 offset:23232
    s_add_u32 s18, s18, 4096
    buffer_load_dwordx4 v[84:87], v3, s[44:47], s18 offen offset:0 sc1
    s_waitcnt vmcnt(11) lgkmcnt(2)
    v_mfma_f32_32x32x16_bf16 v[4:19], v[88:91], v[100:103], v[4:19]
    v_mfma_f32_32x32x16_bf16 v[20:35], v[88:91], v[104:107], v[20:35]
    ds_read_b128 v[116:119], v164 offset:24288
    ds_read_b128 v[120:123], v165 offset:24288
    buffer_load_dwordx4 v[88:91], v3, s[44:47], s18 offen offset:1024 sc1
    s_waitcnt vmcnt(11) lgkmcnt(2)
    v_mfma_f32_32x32x16_bf16 v[4:19], v[92:95], v[108:111], v[4:19]
    v_mfma_f32_32x32x16_bf16 v[20:35], v[92:95], v[112:115], v[20:35]
    ds_read_b128 v[100:103], v164 offset:25344
    ds_read_b128 v[104:107], v165 offset:25344
    buffer_load_dwordx4 v[92:95], v3, s[44:47], s18 offen offset:2048 sc1
    s_waitcnt vmcnt(11) lgkmcnt(2)
    v_mfma_f32_32x32x16_bf16 v[4:19], v[96:99], v[116:119], v[4:19]
    v_mfma_f32_32x32x16_bf16 v[20:35], v[96:99], v[120:123], v[20:35]
    ds_read_b128 v[108:111], v164 offset:26400
    ds_read_b128 v[112:115], v165 offset:26400
    buffer_load_dwordx4 v[96:99], v3, s[44:47], s18 offen offset:3072 sc1
    s_waitcnt vmcnt(11) lgkmcnt(2)
    v_mfma_f32_32x32x16_bf16 v[4:19], v[68:71], v[100:103], v[4:19]
    v_mfma_f32_32x32x16_bf16 v[20:35], v[68:71], v[104:107], v[20:35]
    ds_read_b128 v[116:119], v164 offset:27456
    ds_read_b128 v[120:123], v165 offset:27456
    s_add_u32 s18, s18, 4096
    buffer_load_dwordx4 v[68:71], v3, s[44:47], s18 offen offset:0 sc1
    s_waitcnt vmcnt(11) lgkmcnt(2)
    v_mfma_f32_32x32x16_bf16 v[4:19], v[72:75], v[108:111], v[4:19]
    v_mfma_f32_32x32x16_bf16 v[20:35], v[72:75], v[112:115], v[20:35]
    ds_read_b128 v[100:103], v164 offset:28512
    ds_read_b128 v[104:107], v165 offset:28512
    buffer_load_dwordx4 v[72:75], v3, s[44:47], s18 offen offset:1024 sc1
    s_waitcnt vmcnt(11) lgkmcnt(2)
    v_mfma_f32_32x32x16_bf16 v[4:19], v[76:79], v[116:119], v[4:19]
    v_mfma_f32_32x32x16_bf16 v[20:35], v[76:79], v[120:123], v[20:35]
    ds_read_b128 v[108:111], v164 offset:29568
    ds_read_b128 v[112:115], v165 offset:29568
    buffer_load_dwordx4 v[76:79], v3, s[44:47], s18 offen offset:2048 sc1
    s_waitcnt vmcnt(11) lgkmcnt(2)
    v_mfma_f32_32x32x16_bf16 v[4:19], v[80:83], v[100:103], v[4:19]
    v_mfma_f32_32x32x16_bf16 v[20:35], v[80:83], v[104:107], v[20:35]
    ds_read_b128 v[116:119], v164 offset:30624
    ds_read_b128 v[120:123], v165 offset:30624
    buffer_load_dwordx4 v[80:83], v3, s[44:47], s18 offen offset:3072 sc1
    s_waitcnt vmcnt(7) lgkmcnt(2)
    v_mfma_f32_32x32x16_bf16 v[4:19], v[84:87], v[108:111], v[4:19]
    v_mfma_f32_32x32x16_bf16 v[20:35], v[84:87], v[112:115], v[20:35]
    ds_read_b128 v[100:103], v164 offset:31680
    ds_read_b128 v[104:107], v165 offset:31680
    s_add_u32 s18, s18, 4096
    buffer_load_dwordx4 v[84:87], v3, s[44:47], s18 offen offset:0 sc1
    s_waitcnt vmcnt(7) lgkmcnt(2)
    v_mfma_f32_32x32x16_bf16 v[4:19], v[88:91], v[116:119], v[4:19]
    v_mfma_f32_32x32x16_bf16 v[20:35], v[88:91], v[120:123], v[20:35]
    ds_read_b128 v[108:111], v164 offset:32736
    ds_read_b128 v[112:115], v165 offset:32736
    buffer_load_dwordx4 v[88:91], v3, s[44:47], s18 offen offset:1024 sc1
    s_barrier
    s_add_u32 m0, s41, 32768
    s_add_u32 s15, s40, 98304
    buffer_load_dwordx4 v3, s[28:31], s15 offen offset:0 sc1 lds
    buffer_load_dwordx4 v3, s[28:31], s15 offen offset:1024 sc1 lds
    buffer_load_dwordx4 v3, s[28:31], s15 offen offset:2048 sc1 lds
    buffer_load_dwordx4 v3, s[28:31], s15 offen offset:3072 sc1 lds
    s_waitcnt vmcnt(11) lgkmcnt(2)
    v_mfma_f32_32x32x16_bf16 v[4:19], v[92:95], v[100:103], v[4:19]
    v_mfma_f32_32x32x16_bf16 v[20:35], v[92:95], v[104:107], v[20:35]
    ds_read_b128 v[116:119], v164 offset:33792
    ds_read_b128 v[120:123], v165 offset:33792
    buffer_load_dwordx4 v[92:95], v3, s[44:47], s18 offen offset:2048 sc1
    s_waitcnt vmcnt(11) lgkmcnt(2)
    v_mfma_f32_32x32x16_bf16 v[4:19], v[96:99], v[108:111], v[4:19]
    v_mfma_f32_32x32x16_bf16 v[20:35], v[96:99], v[112:115], v[20:35]
    ds_read_b128 v[100:103], v164 offset:34848
    ds_read_b128 v[104:107], v165 offset:34848
    buffer_load_dwordx4 v[96:99], v3, s[44:47], s18 offen offset:3072 sc1
    s_waitcnt vmcnt(11) lgkmcnt(2)
    v_mfma_f32_32x32x16_bf16 v[4:19], v[68:71], v[116:119], v[4:19]
    v_mfma_f32_32x32x16_bf16 v[20:35], v[68:71], v[120:123], v[20:35]
    ds_read_b128 v[108:111], v164 offset:35904
    ds_read_b128 v[112:115], v165 offset:35904
    s_mov_b32 s18, s19
    buffer_load_dwordx4 v[68:71], v3, s[44:47], s18 offen offset:0 sc1
    s_waitcnt vmcnt(11) lgkmcnt(2)
    v_mfma_f32_32x32x16_bf16 v[4:19], v[72:75], v[100:103], v[4:19]
    v_mfma_f32_32x32x16_bf16 v[20:35], v[72:75], v[104:107], v[20:35]
    ds_read_b128 v[116:119], v164 offset:36960
    ds_read_b128 v[120:123], v165 offset:36960
    buffer_load_dwordx4 v[72:75], v3, s[44:47], s18 offen offset:1024 sc1
    s_waitcnt vmcnt(11) lgkmcnt(2)
    v_mfma_f32_32x32x16_bf16 v[4:19], v[76:79], v[108:111], v[4:19]
    v_mfma_f32_32x32x16_bf16 v[20:35], v[76:79], v[112:115], v[20:35]
    ds_read_b128 v[100:103], v164 offset:38016
    ds_read_b128 v[104:107], v165 offset:38016
    buffer_load_dwordx4 v[76:79], v3, s[44:47], s18 offen offset:2048 sc1
    s_waitcnt vmcnt(11) lgkmcnt(2)
    v_mfma_f32_32x32x16_bf16 v[4:19], v[80:83], v[116:119], v[4:19]
    v_mfma_f32_32x32x16_bf16 v[20:35], v[80:83], v[120:123], v[20:35]
    ds_read_b128 v[108:111], v164 offset:39072
    ds_read_b128 v[112:115], v165 offset:39072
    buffer_load_dwordx4 v[80:83], v3, s[44:47], s18 offen offset:3072 sc1
    s_waitcnt vmcnt(11) lgkmcnt(2)
    v_mfma_f32_32x32x16_bf16 v[4:19], v[84:87], v[100:103], v[4:19]
    v_mfma_f32_32x32x16_bf16 v[20:35], v[84:87], v[104:107], v[20:35]
    ds_read_b128 v[116:119], v164 offset:40128
    ds_read_b128 v[120:123], v165 offset:40128
    s_add_u32 s18, s18, 4096
    buffer_load_dwordx4 v[84:87], v3, s[44:47], s18 offen offset:0 sc1
    s_waitcnt vmcnt(11) lgkmcnt(2)
    v_mfma_f32_32x32x16_bf16 v[4:19], v[88:91], v[108:111], v[4:19]
    v_mfma_f32_32x32x16_bf16 v[20:35], v[88:91], v[112:115], v[20:35]
    ds_read_b128 v[100:103], v164 offset:41184
    ds_read_b128 v[104:107], v165 offset:41184
    buffer_load_dwordx4 v[88:91], v3, s[44:47], s18 offen offset:1024 sc1
    s_waitcnt vmcnt(7) lgkmcnt(2)
    v_mfma_f32_32x32x16_bf16 v[4:19], v[92:95], v[116:119], v[4:19]
    v_mfma_f32_32x32x16_bf16 v[20:35], v[92:95], v[120:123], v[20:35]
    ds_read_b128 v[108:111], v164 offset:0
    ds_read_b128 v[112:115], v165 offset:0
    buffer_load_dwordx4 v[92:95], v3, s[44:47], s18 offen offset:2048 sc1
    s_waitcnt vmcnt(7) lgkmcnt(2)
    v_mfma_f32_32x32x16_bf16 v[4:19], v[96:99], v[100:103], v[4:19]
    v_mfma_f32_32x32x16_bf16 v[20:35], v[96:99], v[104:107], v[20:35]
    ds_read_b128 v[116:119], v164 offset:1056
    ds_read_b128 v[120:123], v165 offset:1056
    buffer_load_dwordx4 v[96:99], v3, s[44:47], s18 offen offset:3072 sc1
    s_barrier
    s_add_u32 m0, s41, 49152
    s_add_u32 s15, s40, 114688
    buffer_load_dwordx4 v3, s[28:31], s15 offen offset:0 sc1 lds
    buffer_load_dwordx4 v3, s[28:31], s15 offen offset:1024 sc1 lds
    buffer_load_dwordx4 v3, s[28:31], s15 offen offset:2048 sc1 lds
    buffer_load_dwordx4 v3, s[28:31], s15 offen offset:3072 sc1 lds
    s_waitcnt vmcnt(11) lgkmcnt(2)
    v_mfma_f32_32x32x16_bf16 v[36:51], v[68:71], v[108:111], 0
    v_mfma_f32_32x32x16_bf16 v[52:67], v[68:71], v[112:115], 0
    ds_read_b128 v[100:103], v164 offset:2112
    ds_read_b128 v[104:107], v165 offset:2112
    s_add_u32 s18, s18, 4096
    buffer_load_dwordx4 v[68:71], v3, s[44:47], s18 offen offset:0 sc1
    s_waitcnt vmcnt(11) lgkmcnt(2)
    v_mfma_f32_32x32x16_bf16 v[36:51], v[72:75], v[116:119], v[36:51]
    v_mfma_f32_32x32x16_bf16 v[52:67], v[72:75], v[120:123], v[52:67]
    ds_read_b128 v[108:111], v164 offset:3168
    ds_read_b128 v[112:115], v165 offset:3168
    buffer_load_dwordx4 v[72:75], v3, s[44:47], s18 offen offset:1024 sc1
    s_waitcnt vmcnt(11) lgkmcnt(2)
    v_mfma_f32_32x32x16_bf16 v[36:51], v[76:79], v[100:103], v[36:51]
    v_mfma_f32_32x32x16_bf16 v[52:67], v[76:79], v[104:107], v[52:67]
    ds_read_b128 v[116:119], v164 offset:4224
    ds_read_b128 v[120:123], v165 offset:4224
    buffer_load_dwordx4 v[76:79], v3, s[44:47], s18 offen offset:2048 sc1
    s_waitcnt vmcnt(11) lgkmcnt(2)
    v_mfma_f32_32x32x16_bf16 v[36:51], v[80:83], v[108:111], v[36:51]
    s_setprio 2
    v_exp_f32 v124, -v4
    v_exp_f32 v125, -v5
    v_exp_f32 v126, -v6
    v_exp_f32 v127, -v7
    v_exp_f32 v128, -v8
    s_setprio 0
    v_mfma_f32_32x32x16_bf16 v[52:67], v[80:83], v[112:115], v[52:67]
    ds_read_b128 v[100:103], v164 offset:5280
    ds_read_b128 v[104:107], v165 offset:5280
    buffer_load_dwordx4 v[80:83], v3, s[44:47], s18 offen offset:3072 sc1
    s_setprio 2
    v_exp_f32 v129, -v9
    v_exp_f32 v130, -v10
    v_exp_f32 v131, -v11
    v_add_f32 v124, 1.0, v124
    v_add_f32 v125, 1.0, v125
    s_setprio 0
    s_waitcnt vmcnt(11) lgkmcnt(2)
    v_mfma_f32_32x32x16_bf16 v[36:51], v[84:87], v[116:119], v[36:51]
    s_setprio 2
    v_add_f32 v126, 1.0, v126
    v_add_f32 v127, 1.0, v127
    v_add_f32 v128, 1.0, v128
    v_add_f32 v129, 1.0, v129
    v_add_f32 v130, 1.0, v130
    s_setprio 0
    v_mfma_f32_32x32x16_bf16 v[52:67], v[84:87], v[120:123], v[52:67]
    ds_read_b128 v[108:111], v164 offset:6336
    ds_read_b128 v[112:115], v165 offset:6336
    s_add_u32 s18, s18, 4096
    buffer_load_dwordx4 v[84:87], v3, s[44:47], s18 offen offset:0 sc1
    s_setprio 2
    v_add_f32 v131, 1.0, v131
    v_rcp_f32 v124, v124
    v_rcp_f32 v125, v125
    v_rcp_f32 v126, v126
    v_rcp_f32 v127, v127
    s_setprio 0
    s_waitcnt vmcnt(11) lgkmcnt(2)
    v_mfma_f32_32x32x16_bf16 v[36:51], v[88:91], v[100:103], v[36:51]
    s_setprio 2
    v_rcp_f32 v128, v128
    v_rcp_f32 v129, v129
    v_rcp_f32 v130, v130
    v_rcp_f32 v131, v131
    v_mul_f32 v4, v4, v124
    s_setprio 0
    v_mfma_f32_32x32x16_bf16 v[52:67], v[88:91], v[104:107], v[52:67]
    ds_read_b128 v[116:119], v164 offset:7392
    ds_read_b128 v[120:123], v165 offset:7392
    buffer_load_dwordx4 v[88:91], v3, s[44:47], s18 offen offset:1024 sc1
    s_setprio 2
    v_mul_f32 v5, v5, v125
    v_mul_f32 v6, v6, v126
    v_mul_f32 v7, v7, v127
    v_mul_f32 v8, v8, v128
    v_mul_f32 v9, v9, v129
    s_setprio 0
    s_waitcnt vmcnt(11) lgkmcnt(2)
    v_mfma_f32_32x32x16_bf16 v[36:51], v[92:95], v[108:111], v[36:51]
    s_setprio 2
    v_mul_f32 v10, v10, v130
    v_mul_f32 v11, v11, v131
    v_cvt_pk_bf16_f32 v4, v4, v5
    v_cvt_pk_bf16_f32 v5, v6, v7
    v_cvt_pk_bf16_f32 v6, v8, v9
    s_setprio 0
    v_mfma_f32_32x32x16_bf16 v[52:67], v[92:95], v[112:115], v[52:67]
    ds_read_b128 v[100:103], v164 offset:8448
    ds_read_b128 v[104:107], v165 offset:8448
    buffer_load_dwordx4 v[92:95], v3, s[44:47], s18 offen offset:2048 sc1
    s_setprio 2
    v_cvt_pk_bf16_f32 v7, v10, v11
    s_add_u32 s15, s10, 0
    buffer_store_dwordx4 v[4:7], v3, s[36:39], s15 offen sc1
    v_exp_f32 v124, -v12
    v_exp_f32 v125, -v13
    v_exp_f32 v126, -v14
    s_setprio 0
    s_waitcnt vmcnt(12) lgkmcnt(2)
    v_mfma_f32_32x32x16_bf16 v[36:51], v[96:99], v[116:119], v[36:51]
    s_setprio 2
    v_exp_f32 v127, -v15
    v_exp_f32 v128, -v16
    v_exp_f32 v129, -v17
    v_exp_f32 v130, -v18
    v_exp_f32 v131, -v19
    s_setprio 0
    v_mfma_f32_32x32x16_bf16 v[52:67], v[96:99], v[120:123], v[52:67]
    ds_read_b128 v[108:111], v164 offset:9504
    ds_read_b128 v[112:115], v165 offset:9504
    buffer_load_dwordx4 v[96:99], v3, s[44:47], s18 offen offset:3072 sc1
    s_setprio 2
    v_add_f32 v124, 1.0, v124
    v_add_f32 v125, 1.0, v125
    v_add_f32 v126, 1.0, v126
    v_add_f32 v127, 1.0, v127
    v_add_f32 v128, 1.0, v128
    s_setprio 0
    s_barrier
    s_add_u32 m0, s41, 0
    s_add_u32 s15, s40, 131072
    buffer_load_dwordx4 v3, s[28:31], s15 offen offset:0 sc1 lds
    buffer_load_dwordx4 v3, s[28:31], s15 offen offset:1024 sc1 lds
    buffer_load_dwordx4 v3, s[28:31], s15 offen offset:2048 sc1 lds
    buffer_load_dwordx4 v3, s[28:31], s15 offen offset:3072 sc1 lds
    s_waitcnt vmcnt(12) lgkmcnt(2)
    v_mfma_f32_32x32x16_bf16 v[36:51], v[68:71], v[100:103], v[36:51]
    s_setprio 2
    v_add_f32 v129, 1.0, v129
    v_add_f32 v130, 1.0, v130
    v_add_f32 v131, 1.0, v131
    v_rcp_f32 v124, v124
    v_rcp_f32 v125, v125
    s_setprio 0
    v_mfma_f32_32x32x16_bf16 v[52:67], v[68:71], v[104:107], v[52:67]
    ds_read_b128 v[116:119], v164 offset:10560
    ds_read_b128 v[120:123], v165 offset:10560
    s_add_u32 s18, s18, 4096
    buffer_load_dwordx4 v[68:71], v3, s[44:47], s18 offen offset:0 sc1
    s_setprio 2
    v_rcp_f32 v126, v126
    v_rcp_f32 v127, v127
    v_rcp_f32 v128, v128
    v_rcp_f32 v129, v129
    v_rcp_f32 v130, v130
    s_setprio 0
    s_waitcnt vmcnt(12) lgkmcnt(2)
    v_mfma_f32_32x32x16_bf16 v[36:51], v[72:75], v[108:111], v[36:51]
    s_setprio 2
    v_rcp_f32 v131, v131
    v_mul_f32 v12, v12, v124
    v_mul_f32 v13, v13, v125
    v_mul_f32 v14, v14, v126
    v_mul_f32 v15, v15, v127
    s_setprio 0
    v_mfma_f32_32x32x16_bf16 v[52:67], v[72:75], v[112:115], v[52:67]
    ds_read_b128 v[100:103], v164 offset:11616
    ds_read_b128 v[104:107], v165 offset:11616
    buffer_load_dwordx4 v[72:75], v3, s[44:47], s18 offen offset:1024 sc1
    s_setprio 2
    v_mul_f32 v16, v16, v128
    v_mul_f32 v17, v17, v129
    v_mul_f32 v18, v18, v130
    v_mul_f32 v19, v19, v131
    v_cvt_pk_bf16_f32 v12, v12, v13
    s_setprio 0
    s_waitcnt vmcnt(12) lgkmcnt(2)
    v_mfma_f32_32x32x16_bf16 v[36:51], v[76:79], v[116:119], v[36:51]
    s_setprio 2
    v_cvt_pk_bf16_f32 v13, v14, v15
    v_cvt_pk_bf16_f32 v14, v16, v17
    v_cvt_pk_bf16_f32 v15, v18, v19
    s_add_u32 s15, s10, 1024
    buffer_store_dwordx4 v[12:15], v3, s[36:39], s15 offen sc1
    s_setprio 0
    v_mfma_f32_32x32x16_bf16 v[52:67], v[76:79], v[120:123], v[52:67]
    ds_read_b128 v[108:111], v164 offset:12672
    ds_read_b128 v[112:115], v165 offset:12672
    buffer_load_dwordx4 v[76:79], v3, s[44:47], s18 offen offset:2048 sc1
    s_setprio 2
    v_exp_f32 v124, -v20
    v_exp_f32 v125, -v21
    v_exp_f32 v126, -v22
    v_exp_f32 v127, -v23
    v_exp_f32 v128, -v24
    s_setprio 0
    s_waitcnt vmcnt(13) lgkmcnt(2)
    v_mfma_f32_32x32x16_bf16 v[36:51], v[80:83], v[100:103], v[36:51]
    s_setprio 2
    v_exp_f32 v129, -v25
    v_exp_f32 v130, -v26
    v_exp_f32 v131, -v27
    v_add_f32 v124, 1.0, v124
    v_add_f32 v125, 1.0, v125
    s_setprio 0
    v_mfma_f32_32x32x16_bf16 v[52:67], v[80:83], v[104:107], v[52:67]
    ds_read_b128 v[116:119], v164 offset:13728
    ds_read_b128 v[120:123], v165 offset:13728
    buffer_load_dwordx4 v[80:83], v3, s[44:47], s18 offen offset:3072 sc1
    s_setprio 2
    v_add_f32 v126, 1.0, v126
    v_add_f32 v127, 1.0, v127
    v_add_f32 v128, 1.0, v128
    v_add_f32 v129, 1.0, v129
    v_add_f32 v130, 1.0, v130
    s_setprio 0
    s_waitcnt vmcnt(13) lgkmcnt(2)
    v_mfma_f32_32x32x16_bf16 v[36:51], v[84:87], v[108:111], v[36:51]
    s_setprio 2
    v_add_f32 v131, 1.0, v131
    v_rcp_f32 v124, v124
    v_rcp_f32 v125, v125
    v_rcp_f32 v126, v126
    v_rcp_f32 v127, v127
    s_setprio 0
    v_mfma_f32_32x32x16_bf16 v[52:67], v[84:87], v[112:115], v[52:67]
    ds_read_b128 v[100:103], v164 offset:14784
    ds_read_b128 v[104:107], v165 offset:14784
    s_add_u32 s18, s18, 4096
    buffer_load_dwordx4 v[84:87], v3, s[44:47], s18 offen offset:0 sc1
    s_setprio 2
    v_rcp_f32 v128, v128
    v_rcp_f32 v129, v129
    v_rcp_f32 v130, v130
    v_rcp_f32 v131, v131
    v_mul_f32 v20, v20, v124
    s_setprio 0
    s_waitcnt vmcnt(13) lgkmcnt(2)
    v_mfma_f32_32x32x16_bf16 v[36:51], v[88:91], v[116:119], v[36:51]
    s_setprio 2
    v_mul_f32 v21, v21, v125
    v_mul_f32 v22, v22, v126
    v_mul_f32 v23, v23, v127
    v_mul_f32 v24, v24, v128
    v_mul_f32 v25, v25, v129
    s_setprio 0
    v_mfma_f32_32x32x16_bf16 v[52:67], v[88:91], v[120:123], v[52:67]
    ds_read_b128 v[108:111], v164 offset:15840
    ds_read_b128 v[112:115], v165 offset:15840
    buffer_load_dwordx4 v[88:91], v3, s[44:47], s18 offen offset:1024 sc1
    s_setprio 2
    v_mul_f32 v26, v26, v130
    v_mul_f32 v27, v27, v131
    v_cvt_pk_bf16_f32 v20, v20, v21
    v_cvt_pk_bf16_f32 v21, v22, v23
    v_cvt_pk_bf16_f32 v22, v24, v25
    s_setprio 0
    s_waitcnt vmcnt(13) lgkmcnt(2)
    v_mfma_f32_32x32x16_bf16 v[36:51], v[92:95], v[100:103], v[36:51]
    s_setprio 2
    v_cvt_pk_bf16_f32 v23, v26, v27
    s_add_u32 s15, s10, 110592
    buffer_store_dwordx4 v[20:23], v3, s[36:39], s15 offen sc1
    v_exp_f32 v124, -v28
    v_exp_f32 v125, -v29
    v_exp_f32 v126, -v30
    s_setprio 0
    v_mfma_f32_32x32x16_bf16 v[52:67], v[92:95], v[104:107], v[52:67]
    ds_read_b128 v[116:119], v164 offset:16896
    ds_read_b128 v[120:123], v165 offset:16896
    buffer_load_dwordx4 v[92:95], v3, s[44:47], s18 offen offset:2048 sc1
    s_setprio 2
    v_exp_f32 v127, -v31
    v_exp_f32 v128, -v32
    v_exp_f32 v129, -v33
    v_exp_f32 v130, -v34
    v_exp_f32 v131, -v35
    s_setprio 0
    s_waitcnt vmcnt(13) lgkmcnt(2)
    v_mfma_f32_32x32x16_bf16 v[36:51], v[96:99], v[108:111], v[36:51]
    s_setprio 2
    v_add_f32 v124, 1.0, v124
    v_add_f32 v125, 1.0, v125
    v_add_f32 v126, 1.0, v126
    v_add_f32 v127, 1.0, v127
    v_add_f32 v128, 1.0, v128
    s_setprio 0
    v_mfma_f32_32x32x16_bf16 v[52:67], v[96:99], v[112:115], v[52:67]
    ds_read_b128 v[100:103], v164 offset:17952
    ds_read_b128 v[104:107], v165 offset:17952
    buffer_load_dwordx4 v[96:99], v3, s[44:47], s18 offen offset:3072 sc1
    s_setprio 2
    v_add_f32 v129, 1.0, v129
    v_add_f32 v130, 1.0, v130
    v_add_f32 v131, 1.0, v131
    v_rcp_f32 v124, v124
    v_rcp_f32 v125, v125
    s_setprio 0
    s_barrier
    s_add_u32 m0, s41, 16384
    s_add_u32 s15, s40, 147456
    buffer_load_dwordx4 v3, s[28:31], s15 offen offset:0 sc1 lds
    buffer_load_dwordx4 v3, s[28:31], s15 offen offset:1024 sc1 lds
    buffer_load_dwordx4 v3, s[28:31], s15 offen offset:2048 sc1 lds
    buffer_load_dwordx4 v3, s[28:31], s15 offen offset:3072 sc1 lds
    s_waitcnt vmcnt(13) lgkmcnt(2)
    v_mfma_f32_32x32x16_bf16 v[36:51], v[68:71], v[116:119], v[36:51]
    s_setprio 2
    v_rcp_f32 v126, v126
    v_rcp_f32 v127, v127
    v_rcp_f32 v128, v128
    v_rcp_f32 v129, v129
    v_rcp_f32 v130, v130
    s_setprio 0
    v_mfma_f32_32x32x16_bf16 v[52:67], v[68:71], v[120:123], v[52:67]
    ds_read_b128 v[108:111], v164 offset:19008
    ds_read_b128 v[112:115], v165 offset:19008
    s_add_u32 s18, s18, 4096
    buffer_load_dwordx4 v[68:71], v3, s[44:47], s18 offen offset:0 sc1
    s_setprio 2
    v_rcp_f32 v131, v131
    v_mul_f32 v28, v28, v124
    v_mul_f32 v29, v29, v125
    v_mul_f32 v30, v30, v126
    v_mul_f32 v31, v31, v127
    s_setprio 0
    s_waitcnt vmcnt(13) lgkmcnt(2)
    v_mfma_f32_32x32x16_bf16 v[36:51], v[72:75], v[100:103], v[36:51]
    s_setprio 2
    v_mul_f32 v32, v32, v128
    v_mul_f32 v33, v33, v129
    v_mul_f32 v34, v34, v130
    v_mul_f32 v35, v35, v131
    v_cvt_pk_bf16_f32 v28, v28, v29
    s_setprio 0
    v_mfma_f32_32x32x16_bf16 v[52:67], v[72:75], v[104:107], v[52:67]
    ds_read_b128 v[116:119], v164 offset:20064
    ds_read_b128 v[120:123], v165 offset:20064
    buffer_load_dwordx4 v[72:75], v3, s[44:47], s18 offen offset:1024 sc1
    s_setprio 2
    v_cvt_pk_bf16_f32 v29, v30, v31
    v_cvt_pk_bf16_f32 v30, v32, v33
    v_cvt_pk_bf16_f32 v31, v34, v35
    s_add_u32 s15, s10, 111616
    buffer_store_dwordx4 v[28:31], v3, s[36:39], s15 offen sc1
    s_setprio 0
    s_waitcnt vmcnt(13) lgkmcnt(2)
    v_mfma_f32_32x32x16_bf16 v[36:51], v[76:79], v[108:111], v[36:51]
    v_mfma_f32_32x32x16_bf16 v[52:67], v[76:79], v[112:115], v[52:67]
    ds_read_b128 v[100:103], v164 offset:21120
    ds_read_b128 v[104:107], v165 offset:21120
    buffer_load_dwordx4 v[76:79], v3, s[44:47], s18 offen offset:2048 sc1
    s_waitcnt vmcnt(13) lgkmcnt(2)
    v_mfma_f32_32x32x16_bf16 v[36:51], v[80:83], v[116:119], v[36:51]
    v_mfma_f32_32x32x16_bf16 v[52:67], v[80:83], v[120:123], v[52:67]
    ds_read_b128 v[108:111], v164 offset:22176
    ds_read_b128 v[112:115], v165 offset:22176
    buffer_load_dwordx4 v[80:83], v3, s[44:47], s18 offen offset:3072 sc1
    s_waitcnt vmcnt(13) lgkmcnt(2)
    v_mfma_f32_32x32x16_bf16 v[36:51], v[84:87], v[100:103], v[36:51]
    v_mfma_f32_32x32x16_bf16 v[52:67], v[84:87], v[104:107], v[52:67]
    ds_read_b128 v[116:119], v164 offset:23232
    ds_read_b128 v[120:123], v165 offset:23232
    s_add_u32 s18, s18, 4096
    buffer_load_dwordx4 v[84:87], v3, s[44:47], s18 offen offset:0 sc1
    s_waitcnt vmcnt(13) lgkmcnt(2)
    v_mfma_f32_32x32x16_bf16 v[36:51], v[88:91], v[108:111], v[36:51]
    v_mfma_f32_32x32x16_bf16 v[52:67], v[88:91], v[112:115], v[52:67]
    ds_read_b128 v[100:103], v164 offset:24288
    ds_read_b128 v[104:107], v165 offset:24288
    buffer_load_dwordx4 v[88:91], v3, s[44:47], s18 offen offset:1024 sc1
    s_waitcnt vmcnt(12) lgkmcnt(2)
    v_mfma_f32_32x32x16_bf16 v[36:51], v[92:95], v[116:119], v[36:51]
    v_mfma_f32_32x32x16_bf16 v[52:67], v[92:95], v[120:123], v[52:67]
    ds_read_b128 v[108:111], v164 offset:25344
    ds_read_b128 v[112:115], v165 offset:25344
    buffer_load_dwordx4 v[92:95], v3, s[44:47], s18 offen offset:2048 sc1
    s_waitcnt vmcnt(5)
    v_mov_b32 v162, 0
    v_mov_b32 v163, s98
    s_mov_b64 exec, 1
    buffer_store_dword v163, v162, s[36:39], s16 offen offset:0 sc1
    s_mov_b64 exec, -1
    s_waitcnt lgkmcnt(2)
    v_mfma_f32_32x32x16_bf16 v[36:51], v[96:99], v[100:103], v[36:51]
    v_mfma_f32_32x32x16_bf16 v[52:67], v[96:99], v[104:107], v[52:67]
    ds_read_b128 v[116:119], v164 offset:26400
    ds_read_b128 v[120:123], v165 offset:26400
    buffer_load_dwordx4 v[96:99], v3, s[44:47], s18 offen offset:3072 sc1
    s_barrier
    s_add_u32 m0, s41, 32768
    s_add_u32 s15, s40, 163840
    buffer_load_dwordx4 v3, s[28:31], s15 offen offset:0 sc1 lds
    buffer_load_dwordx4 v3, s[28:31], s15 offen offset:1024 sc1 lds
    buffer_load_dwordx4 v3, s[28:31], s15 offen offset:2048 sc1 lds
    buffer_load_dwordx4 v3, s[28:31], s15 offen offset:3072 sc1 lds
    s_waitcnt lgkmcnt(2)
    v_mfma_f32_32x32x16_bf16 v[36:51], v[68:71], v[108:111], v[36:51]
    v_mfma_f32_32x32x16_bf16 v[52:67], v[68:71], v[112:115], v[52:67]
    ds_read_b128 v[100:103], v164 offset:27456
    ds_read_b128 v[104:107], v165 offset:27456
    s_add_u32 s18, s18, 4096
    buffer_load_dwordx4 v[68:71], v3, s[44:47], s18 offen offset:0 sc1
    s_waitcnt lgkmcnt(2)
    v_mfma_f32_32x32x16_bf16 v[36:51], v[72:75], v[116:119], v[36:51]
    v_mfma_f32_32x32x16_bf16 v[52:67], v[72:75], v[120:123], v[52:67]
    ds_read_b128 v[108:111], v164 offset:28512
    ds_read_b128 v[112:115], v165 offset:28512
    buffer_load_dwordx4 v[72:75], v3, s[44:47], s18 offen offset:1024 sc1
    s_waitcnt vmcnt(12) lgkmcnt(2)
    v_mfma_f32_32x32x16_bf16 v[36:51], v[76:79], v[100:103], v[36:51]
    v_mfma_f32_32x32x16_bf16 v[52:67], v[76:79], v[104:107], v[52:67]
    ds_read_b128 v[116:119], v164 offset:29568
    ds_read_b128 v[120:123], v165 offset:29568
    buffer_load_dwordx4 v[76:79], v3, s[44:47], s18 offen offset:2048 sc1
    s_waitcnt vmcnt(12) lgkmcnt(2)
    v_mfma_f32_32x32x16_bf16 v[36:51], v[80:83], v[108:111], v[36:51]
    v_mfma_f32_32x32x16_bf16 v[52:67], v[80:83], v[112:115], v[52:67]
    ds_read_b128 v[100:103], v164 offset:30624
    ds_read_b128 v[104:107], v165 offset:30624
    buffer_load_dwordx4 v[80:83], v3, s[44:47], s18 offen offset:3072 sc1
    s_waitcnt vmcnt(12) lgkmcnt(2)
    v_mfma_f32_32x32x16_bf16 v[36:51], v[84:87], v[116:119], v[36:51]
    v_mfma_f32_32x32x16_bf16 v[52:67], v[84:87], v[120:123], v[52:67]
    ds_read_b128 v[108:111], v164 offset:31680
    ds_read_b128 v[112:115], v165 offset:31680
    s_add_u32 s18, s18, 4096
    buffer_load_dwordx4 v[84:87], v3, s[44:47], s18 offen offset:0 sc1
    s_waitcnt vmcnt(12) lgkmcnt(2)
    v_mfma_f32_32x32x16_bf16 v[36:51], v[88:91], v[100:103], v[36:51]
    v_mfma_f32_32x32x16_bf16 v[52:67], v[88:91], v[104:107], v[52:67]
    ds_read_b128 v[116:119], v164 offset:32736
    ds_read_b128 v[120:123], v165 offset:32736
    buffer_load_dwordx4 v[88:91], v3, s[44:47], s18 offen offset:1024 sc1
    s_waitcnt vmcnt(12) lgkmcnt(2)
    v_mfma_f32_32x32x16_bf16 v[36:51], v[92:95], v[108:111], v[36:51]
    v_mfma_f32_32x32x16_bf16 v[52:67], v[92:95], v[112:115], v[52:67]
    ds_read_b128 v[100:103], v164 offset:33792
    ds_read_b128 v[104:107], v165 offset:33792
    buffer_load_dwordx4 v[92:95], v3, s[44:47], s18 offen offset:2048 sc1
    s_waitcnt vmcnt(11) lgkmcnt(2)
    v_mfma_f32_32x32x16_bf16 v[36:51], v[96:99], v[116:119], v[36:51]
    v_mfma_f32_32x32x16_bf16 v[52:67], v[96:99], v[120:123], v[52:67]
    ds_read_b128 v[108:111], v164 offset:34848
    ds_read_b128 v[112:115], v165 offset:34848
    buffer_load_dwordx4 v[96:99], v3, s[44:47], s18 offen offset:3072 sc1
    s_barrier
    s_add_u32 m0, s41, 49152
    s_add_u32 s15, s40, 180224
    buffer_load_dwordx4 v3, s[28:31], s15 offen offset:0 sc1 lds
    buffer_load_dwordx4 v3, s[28:31], s15 offen offset:1024 sc1 lds
    buffer_load_dwordx4 v3, s[28:31], s15 offen offset:2048 sc1 lds
    buffer_load_dwordx4 v3, s[28:31], s15 offen offset:3072 sc1 lds
    s_waitcnt vmcnt(11) lgkmcnt(2)
    v_mfma_f32_32x32x16_bf16 v[36:51], v[68:71], v[100:103], v[36:51]
    v_mfma_f32_32x32x16_bf16 v[52:67], v[68:71], v[104:107], v[52:67]
    ds_read_b128 v[116:119], v164 offset:35904
    ds_read_b128 v[120:123], v165 offset:35904
    s_waitcnt vmcnt(10) lgkmcnt(2)
    v_mfma_f32_32x32x16_bf16 v[36:51], v[72:75], v[108:111], v[36:51]
    v_mfma_f32_32x32x16_bf16 v[52:67], v[72:75], v[112:115], v[52:67]
    ds_read_b128 v[100:103], v164 offset:36960
    ds_read_b128 v[104:107], v165 offset:36960
    s_waitcnt vmcnt(9) lgkmcnt(2)
    v_mfma_f32_32x32x16_bf16 v[36:51], v[76:79], v[116:119], v[36:51]
    v_mfma_f32_32x32x16_bf16 v[52:67], v[76:79], v[120:123], v[52:67]
    ds_read_b128 v[108:111], v164 offset:38016
    ds_read_b128 v[112:115], v165 offset:38016
    s_waitcnt vmcnt(8) lgkmcnt(2)
    v_mfma_f32_32x32x16_bf16 v[36:51], v[80:83], v[100:103], v[36:51]
    v_mfma_f32_32x32x16_bf16 v[52:67], v[80:83], v[104:107], v[52:67]
    ds_read_b128 v[116:119], v164 offset:39072
    ds_read_b128 v[120:123], v165 offset:39072
    s_waitcnt vmcnt(7) lgkmcnt(2)
    v_mfma_f32_32x32x16_bf16 v[36:51], v[84:87], v[108:111], v[36:51]
    v_mfma_f32_32x32x16_bf16 v[52:67], v[84:87], v[112:115], v[52:67]
    ds_read_b128 v[100:103], v164 offset:40128
    ds_read_b128 v[104:107], v165 offset:40128
    s_waitcnt vmcnt(6) lgkmcnt(2)
    v_mfma_f32_32x32x16_bf16 v[36:51], v[88:91], v[116:119], v[36:51]
    v_mfma_f32_32x32x16_bf16 v[52:67], v[88:91], v[120:123], v[52:67]
    ds_read_b128 v[108:111], v164 offset:41184
    ds_read_b128 v[112:115], v165 offset:41184
    s_waitcnt vmcnt(5) lgkmcnt(2)
    v_mfma_f32_32x32x16_bf16 v[36:51], v[92:95], v[100:103], v[36:51]
    v_mfma_f32_32x32x16_bf16 v[52:67], v[92:95], v[104:107], v[52:67]
    s_waitcnt vmcnt(4) lgkmcnt(0)
    v_mfma_f32_32x32x16_bf16 v[36:51], v[96:99], v[108:111], v[36:51]
    v_mfma_f32_32x32x16_bf16 v[52:67], v[96:99], v[112:115], v[52:67]
    s_barrier
    s_add_u32 m0, s41, 0
    s_add_u32 s15, s40, 196608
    buffer_load_dwordx4 v3, s[28:31], s15 offen offset:0 sc1 lds
    buffer_load_dwordx4 v3, s[28:31], s15 offen offset:1024 sc1 lds
    buffer_load_dwordx4 v3, s[28:31], s15 offen offset:2048 sc1 lds
    buffer_load_dwordx4 v3, s[28:31], s15 offen offset:3072 sc1 lds
    s_lshl_b32 s13, s6, 14
    s_mul_i32 s8, s12, 110592
    s_mul_i32 s15, s6, 11264
    s_add_u32 s15, s15, 65536
    s_add_u32 s9, s8, s15
    s_add_u32 s8, s8, s13
    s_add_u32 s19, s17, s15
    s_add_u32 s18, s17, s13
    v_and_b32 v160, 31, v0
    v_lshlrev_b32 v160, 2, v160
    buffer_load_dword v161, v160, s[36:39], s14 offen offset:0 sc1
    s_mov_b32 s13, 3804160
    buffer_load_dwordx4 v[132:135], v3, s[36:39], s13 offen sc1
    s_nop 7
    s_setprio 2
    v_exp_f32 v68, -v36
    v_exp_f32 v69, -v37
    v_exp_f32 v70, -v38
    v_exp_f32 v71, -v39
    v_exp_f32 v72, -v40
    v_exp_f32 v73, -v41
    v_exp_f32 v74, -v42
    v_exp_f32 v75, -v43
    v_add_f32 v68, 1.0, v68
    v_add_f32 v69, 1.0, v69
    v_add_f32 v70, 1.0, v70
    v_add_f32 v71, 1.0, v71
    v_add_f32 v72, 1.0, v72
    v_add_f32 v73, 1.0, v73
    v_add_f32 v74, 1.0, v74
    v_add_f32 v75, 1.0, v75
    v_rcp_f32 v68, v68
    v_rcp_f32 v69, v69
    v_rcp_f32 v70, v70
    v_rcp_f32 v71, v71
    v_rcp_f32 v72, v72
    v_rcp_f32 v73, v73
    v_rcp_f32 v74, v74
    v_rcp_f32 v75, v75
    v_mul_f32 v36, v36, v68
    v_mul_f32 v37, v37, v69
    v_mul_f32 v38, v38, v70
    v_mul_f32 v39, v39, v71
    v_mul_f32 v40, v40, v72
    v_mul_f32 v41, v41, v73
    v_mul_f32 v42, v42, v74
    v_mul_f32 v43, v43, v75
    v_cvt_pk_bf16_f32 v36, v36, v37
    v_cvt_pk_bf16_f32 v37, v38, v39
    v_cvt_pk_bf16_f32 v38, v40, v41
    v_cvt_pk_bf16_f32 v39, v42, v43
    s_add_u32 s15, s11, 0
    buffer_store_dwordx4 v[36:39], v3, s[36:39], s15 offen sc1
    v_exp_f32 v68, -v44
    v_exp_f32 v69, -v45
    v_exp_f32 v70, -v46
    v_exp_f32 v71, -v47
    v_exp_f32 v72, -v48
    v_exp_f32 v73, -v49
    v_exp_f32 v74, -v50
    v_exp_f32 v75, -v51
    v_add_f32 v68, 1.0, v68
    v_add_f32 v69, 1.0, v69
    v_add_f32 v70, 1.0, v70
    v_add_f32 v71, 1.0, v71
    v_add_f32 v72, 1.0, v72
    v_add_f32 v73, 1.0, v73
    v_add_f32 v74, 1.0, v74
    v_add_f32 v75, 1.0, v75
    v_rcp_f32 v68, v68
    v_rcp_f32 v69, v69
    v_rcp_f32 v70, v70
    v_rcp_f32 v71, v71
    v_rcp_f32 v72, v72
    v_rcp_f32 v73, v73
    v_rcp_f32 v74, v74
    v_rcp_f32 v75, v75
    v_mul_f32 v44, v44, v68
    v_mul_f32 v45, v45, v69
    v_mul_f32 v46, v46, v70
    v_mul_f32 v47, v47, v71
    v_mul_f32 v48, v48, v72
    v_mul_f32 v49, v49, v73
    v_mul_f32 v50, v50, v74
    v_mul_f32 v51, v51, v75
    v_cvt_pk_bf16_f32 v44, v44, v45
    v_cvt_pk_bf16_f32 v45, v46, v47
    v_cvt_pk_bf16_f32 v46, v48, v49
    v_cvt_pk_bf16_f32 v47, v50, v51
    s_add_u32 s15, s11, 1024
    buffer_store_dwordx4 v[44:47], v3, s[36:39], s15 offen sc1
    v_exp_f32 v68, -v52
    v_exp_f32 v69, -v53
    v_exp_f32 v70, -v54
    v_exp_f32 v71, -v55
    v_exp_f32 v72, -v56
    v_exp_f32 v73, -v57
    v_exp_f32 v74, -v58
    v_exp_f32 v75, -v59
    v_add_f32 v68, 1.0, v68
    v_add_f32 v69, 1.0, v69
    v_add_f32 v70, 1.0, v70
    v_add_f32 v71, 1.0, v71
    v_add_f32 v72, 1.0, v72
    v_add_f32 v73, 1.0, v73
    v_add_f32 v74, 1.0, v74
    v_add_f32 v75, 1.0, v75
    v_rcp_f32 v68, v68
    v_rcp_f32 v69, v69
    v_rcp_f32 v70, v70
    v_rcp_f32 v71, v71
    v_rcp_f32 v72, v72
    v_rcp_f32 v73, v73
    v_rcp_f32 v74, v74
    v_rcp_f32 v75, v75
    v_mul_f32 v52, v52, v68
    v_mul_f32 v53, v53, v69
    v_mul_f32 v54, v54, v70
    v_mul_f32 v55, v55, v71
    v_mul_f32 v56, v56, v72
    v_mul_f32 v57, v57, v73
    v_mul_f32 v58, v58, v74
    v_mul_f32 v59, v59, v75
    v_cvt_pk_bf16_f32 v52, v52, v53
    v_cvt_pk_bf16_f32 v53, v54, v55
    v_cvt_pk_bf16_f32 v54, v56, v57
    v_cvt_pk_bf16_f32 v55, v58, v59
    s_add_u32 s15, s11, 110592
    buffer_store_dwordx4 v[52:55], v3, s[36:39], s15 offen sc1
    v_exp_f32 v68, -v60
    v_exp_f32 v69, -v61
    v_exp_f32 v70, -v62
    v_exp_f32 v71, -v63
    v_exp_f32 v72, -v64
    v_exp_f32 v73, -v65
    v_exp_f32 v74, -v66
    v_exp_f32 v75, -v67
    v_add_f32 v68, 1.0, v68
    v_add_f32 v69, 1.0, v69
    v_add_f32 v70, 1.0, v70
    v_add_f32 v71, 1.0, v71
    v_add_f32 v72, 1.0, v72
    v_add_f32 v73, 1.0, v73
    v_add_f32 v74, 1.0, v74
    v_add_f32 v75, 1.0, v75
    v_rcp_f32 v68, v68
    v_rcp_f32 v69, v69
    v_rcp_f32 v70, v70
    v_rcp_f32 v71, v71
    v_rcp_f32 v72, v72
    v_rcp_f32 v73, v73
    v_rcp_f32 v74, v74
    v_rcp_f32 v75, v75
    v_mul_f32 v60, v60, v68
    v_mul_f32 v61, v61, v69
    v_mul_f32 v62, v62, v70
    v_mul_f32 v63, v63, v71
    v_mul_f32 v64, v64, v72
    v_mul_f32 v65, v65, v73
    v_mul_f32 v66, v66, v74
    v_mul_f32 v67, v67, v75
    v_cvt_pk_bf16_f32 v60, v60, v61
    v_cvt_pk_bf16_f32 v61, v62, v63
    v_cvt_pk_bf16_f32 v62, v64, v65
    v_cvt_pk_bf16_f32 v63, v66, v67
    s_add_u32 s15, s11, 111616
    buffer_store_dwordx4 v[60:63], v3, s[36:39], s15 offen sc1
    s_waitcnt vmcnt(5)
    v_cmp_ne_u32 vcc, s98, v161
    s_mov_b32 s13, 0x4000
    s_nop 3
    s_cbranch_vccz polld_85
poll_84:
    buffer_load_dword v161, v160, s[36:39], s14 offen offset:0 sc1
    s_waitcnt vmcnt(0)
    v_cmp_ne_u32 vcc, s98, v161
    s_sub_u32 s13, s13, 1
    s_nop 3
    s_cbranch_vccz polld_85
    s_cmp_eq_u32 s13, 0
    s_cbranch_scc1 polld_85
    s_sleep 2
    s_branch poll_84
polld_85:
    s_waitcnt vmcnt(4)
    s_mov_b32 s43, 0x4000
    s_mov_b32 s13, 3804160
g2p_86:
    v_xor_b32 v132, s98, v132
    v_xor_b32 v133, s98, v133
    v_xor_b32 v134, s98, v134
    v_xor_b32 v135, s98, v135
    v_or_b32 v132, v132, v133
    v_or_b32 v134, v134, v135
    v_or_b32 v132, v132, v134
    v_cmp_ne_u32 vcc, 0, v132
    s_sub_u32 s43, s43, 1
    s_nop 3
    s_cbranch_vccz g2d_87
    s_cmp_eq_u32 s43, 0
    s_cbranch_scc1 g2d_87
    s_sleep 2
    buffer_load_dwordx4 v[132:135], v3, s[36:39], s13 offen sc1
    s_waitcnt vmcnt(0)
    s_branch g2p_86
g2d_87:
    s_add_u32 s15, s8, 0
    buffer_load_dwordx4 v[100:103], v3, s[48:51], s15 offen offset:0 sc1
    s_add_u32 s15, s8, 110592
    buffer_load_dwordx4 v[104:107], v3, s[48:51], s15 offen offset:0 sc1
    s_add_u32 s15, s18, 0
    buffer_load_dwordx4 v[108:111], v3, s[36:39], s15 offen offset:0 sc1
    s_add_u32 s15, s18, 110592
    buffer_load_dwordx4 v[112:115], v3, s[36:39], s15 offen offset:0 sc1
    s_add_u32 s15, s8, 0
    buffer_load_dwordx4 v[116:119], v3, s[48:51], s15 offen offset:1024 sc1
    s_add_u32 s15, s8, 110592
    buffer_load_dwordx4 v[120:123], v3, s[48:51], s15 offen offset:1024 sc1
    s_add_u32 s15, s18, 0
    buffer_load_dwordx4 v[124:127], v3, s[36:39], s15 offen offset:1024 sc1
    s_add_u32 s15, s18, 110592
    buffer_load_dwordx4 v[128:131], v3, s[36:39], s15 offen offset:1024 sc1
    s_add_u32 s15, s8, 0
    buffer_load_dwordx4 v[132:135], v3, s[48:51], s15 offen offset:2048 sc1
    s_add_u32 s15, s8, 110592
    buffer_load_dwordx4 v[136:139], v3, s[48:51], s15 offen offset:2048 sc1
    s_add_u32 s15, s18, 0
    buffer_load_dwordx4 v[140:143], v3, s[36:39], s15 offen offset:2048 sc1
    s_add_u32 s15, s18, 110592
    buffer_load_dwordx4 v[144:147], v3, s[36:39], s15 offen offset:2048 sc1
    s_setprio 0
    s_barrier
    s_add_u32 m0, s41, 16384
    s_add_u32 s15, s40, 212992
    buffer_load_dwordx4 v3, s[28:31], s15 offen offset:0 sc1 lds
    buffer_load_dwordx4 v3, s[28:31], s15 offen offset:1024 sc1 lds
    buffer_load_dwordx4 v3, s[28:31], s15 offen offset:2048 sc1 lds
    buffer_load_dwordx4 v3, s[28:31], s15 offen offset:3072 sc1 lds
    s_waitcnt vmcnt(12)
    v_mfma_f32_32x32x16_bf16 v[4:19], v[100:103], v[108:111], 0
    v_mfma_f32_32x32x16_bf16 v[20:35], v[100:103], v[112:115], 0
    s_add_u32 s15, s8, 0
    buffer_load_dwordx4 v[100:103], v3, s[48:51], s15 offen offset:3072 sc1
    v_mfma_f32_32x32x16_bf16 v[52:67], v[104:107], v[112:115], 0
    v_mfma_f32_32x32x16_bf16 v[36:51], v[104:107], v[108:111], 0
    s_add_u32 s15, s8, 110592
    buffer_load_dwordx4 v[104:107], v3, s[48:51], s15 offen offset:3072 sc1
    s_add_u32 s15, s18, 0
    buffer_load_dwordx4 v[108:111], v3, s[36:39], s15 offen offset:3072 sc1
    s_add_u32 s15, s18, 110592
    buffer_load_dwordx4 v[112:115], v3, s[36:39], s15 offen offset:3072 sc1
    s_waitcnt vmcnt(12)
    v_mfma_f32_32x32x16_bf16 v[4:19], v[116:119], v[124:127], v[4:19]
    v_mfma_f32_32x32x16_bf16 v[20:35], v[116:119], v[128:131], v[20:35]
    s_add_u32 s15, s8, 4096
    buffer_load_dwordx4 v[116:119], v3, s[48:51], s15 offen offset:0 sc1
    v_mfma_f32_32x32x16_bf16 v[52:67], v[120:123], v[128:131], v[52:67]
    v_mfma_f32_32x32x16_bf16 v[36:51], v[120:123], v[124:127], v[36:51]
    s_add_u32 s15, s8, 114688
    buffer_load_dwordx4 v[120:123], v3, s[48:51], s15 offen offset:0 sc1
    s_add_u32 s15, s18, 4096
    buffer_load_dwordx4 v[124:127], v3, s[36:39], s15 offen offset:0 sc1
    s_add_u32 s15, s18, 114688
    buffer_load_dwordx4 v[128:131], v3, s[36:39], s15 offen offset:0 sc1
    v_mov_b32 v162, 0
    v_mov_b32 v163, s98
    s_mov_b64 exec, 1
    buffer_store_dword v163, v162, s[36:39], s16 offen offset:128 sc1
    s_mov_b64 exec, -1
    s_waitcnt vmcnt(13)
    v_mfma_f32_32x32x16_bf16 v[4:19], v[132:135], v[140:143], v[4:19]
    v_mfma_f32_32x32x16_bf16 v[20:35], v[132:135], v[144:147], v[20:35]
    s_add_u32 s15, s8, 4096
    buffer_load_dwordx4 v[132:135], v3, s[48:51], s15 offen offset:1024 sc1
    v_mfma_f32_32x32x16_bf16 v[52:67], v[136:139], v[144:147], v[52:67]
    v_mfma_f32_32x32x16_bf16 v[36:51], v[136:139], v[140:143], v[36:51]
    s_add_u32 s15, s8, 114688
    buffer_load_dwordx4 v[136:139], v3, s[48:51], s15 offen offset:1024 sc1
    s_add_u32 s15, s18, 4096
    buffer_load_dwordx4 v[140:143], v3, s[36:39], s15 offen offset:1024 sc1
    s_add_u32 s15, s18, 114688
    buffer_load_dwordx4 v[144:147], v3, s[36:39], s15 offen offset:1024 sc1
    s_waitcnt vmcnt(9)
    v_mfma_f32_32x32x16_bf16 v[4:19], v[100:103], v[108:111], v[4:19]
    v_mfma_f32_32x32x16_bf16 v[20:35], v[100:103], v[112:115], v[20:35]
    s_add_u32 s15, s8, 4096
    buffer_load_dwordx4 v[100:103], v3, s[48:51], s15 offen offset:2048 sc1
    v_mfma_f32_32x32x16_bf16 v[52:67], v[104:107], v[112:115], v[52:67]
    v_mfma_f32_32x32x16_bf16 v[36:51], v[104:107], v[108:111], v[36:51]
    s_add_u32 s15, s8, 114688
    buffer_load_dwordx4 v[104:107], v3, s[48:51], s15 offen offset:2048 sc1
    s_add_u32 s15, s18, 4096
    buffer_load_dwordx4 v[108:111], v3, s[36:39], s15 offen offset:2048 sc1
    s_add_u32 s15, s18, 114688
    buffer_load_dwordx4 v[112:115], v3, s[36:39], s15 offen offset:2048 sc1
    s_barrier
    s_add_u32 m0, s41, 32768
    s_add_u32 s15, s40, 229376
    buffer_load_dwordx4 v3, s[28:31], s15 offen offset:0 sc1 lds
    buffer_load_dwordx4 v3, s[28:31], s15 offen offset:1024 sc1 lds
    buffer_load_dwordx4 v3, s[28:31], s15 offen offset:2048 sc1 lds
    buffer_load_dwordx4 v3, s[28:31], s15 offen offset:3072 sc1 lds
    s_waitcnt vmcnt(13)
    v_mfma_f32_32x32x16_bf16 v[4:19], v[116:119], v[124:127], v[4:19]
    v_mfma_f32_32x32x16_bf16 v[20:35], v[116:119], v[128:131], v[20:35]
    s_add_u32 s15, s8, 4096
    buffer_load_dwordx4 v[116:119], v3, s[48:51], s15 offen offset:3072 sc1
    v_mfma_f32_32x32x16_bf16 v[52:67], v[120:123], v[128:131], v[52:67]
    v_mfma_f32_32x32x16_bf16 v[36:51], v[120:123], v[124:127], v[36:51]
    s_add_u32 s15, s8, 114688
    buffer_load_dwordx4 v[120:123], v3, s[48:51], s15 offen offset:3072 sc1
    s_add_u32 s15, s18, 4096
    buffer_load_dwordx4 v[124:127], v3, s[36:39], s15 offen offset:3072 sc1
    s_add_u32 s15, s18, 114688
    buffer_load_dwordx4 v[128:131], v3, s[36:39], s15 offen offset:3072 sc1
    s_waitcnt vmcnt(12)
    v_mfma_f32_32x32x16_bf16 v[4:19], v[132:135], v[140:143], v[4:19]
    v_mfma_f32_32x32x16_bf16 v[20:35], v[132:135], v[144:147], v[20:35]
    s_add_u32 s15, s8, 8192
    buffer_load_dwordx4 v[132:135], v3, s[48:51], s15 offen offset:0 sc1
    v_mfma_f32_32x32x16_bf16 v[52:67], v[136:139], v[144:147], v[52:67]
    v_mfma_f32_32x32x16_bf16 v[36:51], v[136:139], v[140:143], v[36:51]
    s_add_u32 s15, s8, 118784
    buffer_load_dwordx4 v[136:139], v3, s[48:51], s15 offen offset:0 sc1
    s_add_u32 s15, s18, 8192
    buffer_load_dwordx4 v[140:143], v3, s[36:39], s15 offen offset:0 sc1
    s_add_u32 s15, s18, 118784
    buffer_load_dwordx4 v[144:147], v3, s[36:39], s15 offen offset:0 sc1
    s_waitcnt vmcnt(12)
    v_mfma_f32_32x32x16_bf16 v[4:19], v[100:103], v[108:111], v[4:19]
    v_mfma_f32_32x32x16_bf16 v[20:35], v[100:103], v[112:115], v[20:35]
    s_add_u32 s15, s8, 8192
    buffer_load_dwordx4 v[100:103], v3, s[48:51], s15 offen offset:1024 sc1
    v_mfma_f32_32x32x16_bf16 v[52:67], v[104:107], v[112:115], v[52:67]
    v_mfma_f32_32x32x16_bf16 v[36:51], v[104:107], v[108:111], v[36:51]
    s_add_u32 s15, s8, 118784
    buffer_load_dwordx4 v[104:107], v3, s[48:51], s15 offen offset:1024 sc1
    s_add_u32 s15, s18, 8192
    buffer_load_dwordx4 v[108:111], v3, s[36:39], s15 offen offset:1024 sc1
    s_add_u32 s15, s18, 118784
    buffer_load_dwordx4 v[112:115], v3, s[36:39], s15 offen offset:1024 sc1
    s_waitcnt vmcnt(8)
    v_mfma_f32_32x32x16_bf16 v[4:19], v[116:119], v[124:127], v[4:19]
    v_mfma_f32_32x32x16_bf16 v[20:35], v[116:119], v[128:131], v[20:35]
    s_add_u32 s15, s8, 8192
    buffer_load_dwordx4 v[116:119], v3, s[48:51], s15 offen offset:2048 sc1
    v_mfma_f32_32x32x16_bf16 v[52:67], v[120:123], v[128:131], v[52:67]
    v_mfma_f32_32x32x16_bf16 v[36:51], v[120:123], v[124:127], v[36:51]
    s_add_u32 s15, s8, 118784
    buffer_load_dwordx4 v[120:123], v3, s[48:51], s15 offen offset:2048 sc1
    s_add_u32 s15, s18, 8192
    buffer_load_dwordx4 v[124:127], v3, s[36:39], s15 offen offset:2048 sc1
    s_add_u32 s15, s18, 118784
    buffer_load_dwordx4 v[128:131], v3, s[36:39], s15 offen offset:2048 sc1
    s_barrier
    s_add_u32 m0, s41, 49152
    s_add_u32 s15, s40, 245760
    buffer_load_dwordx4 v3, s[28:31], s15 offen offset:0 sc1 lds
    buffer_load_dwordx4 v3, s[28:31], s15 offen offset:1024 sc1 lds
    buffer_load_dwordx4 v3, s[28:31], s15 offen offset:2048 sc1 lds
    buffer_load_dwordx4 v3, s[28:31], s15 offen offset:3072 sc1 lds
    s_waitcnt vmcnt(12)
    v_mfma_f32_32x32x16_bf16 v[4:19], v[132:135], v[140:143], v[4:19]
    v_mfma_f32_32x32x16_bf16 v[20:35], v[132:135], v[144:147], v[20:35]
    s_add_u32 s15, s8, 8192
    buffer_load_dwordx4 v[132:135], v3, s[48:51], s15 offen offset:3072 sc1
    v_mfma_f32_32x32x16_bf16 v[52:67], v[136:139], v[144:147], v[52:67]
    v_mfma_f32_32x32x16_bf16 v[36:51], v[136:139], v[140:143], v[36:51]
    s_add_u32 s15, s8, 118784
    buffer_load_dwordx4 v[136:139], v3, s[48:51], s15 offen offset:3072 sc1
    s_add_u32 s15, s18, 8192
    buffer_load_dwordx4 v[140:143], v3, s[36:39], s15 offen offset:3072 sc1
    s_add_u32 s15, s18, 118784
    buffer_load_dwordx4 v[144:147], v3, s[36:39], s15 offen offset:3072 sc1
    s_waitcnt vmcnt(12)
    v_mfma_f32_32x32x16_bf16 v[4:19], v[100:103], v[108:111], v[4:19]
    v_mfma_f32_32x32x16_bf16 v[20:35], v[100:103], v[112:115], v[20:35]
    s_add_u32 s15, s8, 12288
    buffer_load_dwordx4 v[100:103], v3, s[48:51], s15 offen offset:0 sc1
    v_mfma_f32_32x32x16_bf16 v[52:67], v[104:107], v[112:115], v[52:67]
    v_mfma_f32_32x32x16_bf16 v[36:51], v[104:107], v[108:111], v[36:51]
    s_add_u32 s15, s8, 122880
    buffer_load_dwordx4 v[104:107], v3, s[48:51], s15 offen offset:0 sc1
    s_add_u32 s15, s18, 12288
    buffer_load_dwordx4 v[108:111], v3, s[36:39], s15 offen offset:0 sc1
    s_add_u32 s15, s18, 122880
    buffer_load_dwordx4 v[112:115], v3, s[36:39], s15 offen offset:0 sc1
    s_waitcnt vmcnt(12)
    v_mfma_f32_32x32x16_bf16 v[4:19], v[116:119], v[124:127], v[4:19]
    v_mfma_f32_32x32x16_bf16 v[20:35], v[116:119], v[128:131], v[20:35]
    s_add_u32 s15, s8, 12288
    buffer_load_dwordx4 v[116:119], v3, s[48:51], s15 offen offset:1024 sc1
    v_mfma_f32_32x32x16_bf16 v[52:67], v[120:123], v[128:131], v[52:67]
    v_mfma_f32_32x32x16_bf16 v[36:51], v[120:123], v[124:127], v[36:51]
    s_add_u32 s15, s8, 122880
    buffer_load_dwordx4 v[120:123], v3, s[48:51], s15 offen offset:1024 sc1
    s_add_u32 s15, s18, 12288
    buffer_load_dwordx4 v[124:127], v3, s[36:39], s15 offen offset:1024 sc1
    s_add_u32 s15, s18, 122880
    buffer_load_dwordx4 v[128:131], v3, s[36:39], s15 offen offset:1024 sc1
    s_waitcnt vmcnt(8)
    v_mfma_f32_32x32x16_bf16 v[4:19], v[132:135], v[140:143], v[4:19]
    v_mfma_f32_32x32x16_bf16 v[20:35], v[132:135], v[144:147], v[20:35]
    s_add_u32 s15, s8, 12288
    buffer_load_dwordx4 v[132:135], v3, s[48:51], s15 offen offset:2048 sc1
    v_mfma_f32_32x32x16_bf16 v[52:67], v[136:139], v[144:147], v[52:67]
    v_mfma_f32_32x32x16_bf16 v[36:51], v[136:139], v[140:143], v[36:51]
    s_add_u32 s15, s8, 122880
    buffer_load_dwordx4 v[136:139], v3, s[48:51], s15 offen offset:2048 sc1
    s_add_u32 s15, s18, 12288
    buffer_load_dwordx4 v[140:143], v3, s[36:39], s15 offen offset:2048 sc1
    s_add_u32 s15, s18, 122880
    buffer_load_dwordx4 v[144:147], v3, s[36:39], s15 offen offset:2048 sc1
    v_and_b32 v160, 31, v0
    v_lshlrev_b32 v160, 2, v160
    buffer_load_dword v161, v160, s[36:39], s14 offen offset:128 sc1
    s_barrier
    s_waitcnt vmcnt(9)
    v_mfma_f32_32x32x16_bf16 v[4:19], v[100:103], v[108:111], v[4:19]
    v_mfma_f32_32x32x16_bf16 v[20:35], v[100:103], v[112:115], v[20:35]
    s_add_u32 s15, s8, 12288
    buffer_load_dwordx4 v[100:103], v3, s[48:51], s15 offen offset:3072 sc1
    v_mfma_f32_32x32x16_bf16 v[52:67], v[104:107], v[112:115], v[52:67]
    v_mfma_f32_32x32x16_bf16 v[36:51], v[104:107], v[108:111], v[36:51]
    s_add_u32 s15, s8, 122880
    buffer_load_dwordx4 v[104:107], v3, s[48:51], s15 offen offset:3072 sc1
    s_add_u32 s15, s18, 12288
    buffer_load_dwordx4 v[108:111], v3, s[36:39], s15 offen offset:3072 sc1
    s_add_u32 s15, s18, 122880
    buffer_load_dwordx4 v[112:115], v3, s[36:39], s15 offen offset:3072 sc1
    s_waitcnt vmcnt(9)
    s_waitcnt vmcnt(4)
    v_cmp_ne_u32 vcc, s98, v161
    s_mov_b32 s13, 0x4000
    s_nop 3
    s_cbranch_vccz polld_89
poll_88:
    buffer_load_dword v161, v160, s[36:39], s14 offen offset:128 sc1
    s_waitcnt vmcnt(0)
    v_cmp_ne_u32 vcc, s98, v161
    s_sub_u32 s13, s13, 1
    s_nop 3
    s_cbranch_vccz polld_89
    s_cmp_eq_u32 s13, 0
    s_cbranch_scc1 polld_89
    s_sleep 2
    s_branch poll_88
polld_89:
    v_mfma_f32_32x32x16_bf16 v[4:19], v[116:119], v[124:127], v[4:19]
    v_mfma_f32_32x32x16_bf16 v[20:35], v[116:119], v[128:131], v[20:35]
    s_add_u32 s15, s9, 0
    buffer_load_dwordx4 v[116:119], v3, s[48:51], s15 offen offset:0 sc1
    v_mfma_f32_32x32x16_bf16 v[52:67], v[120:123], v[128:131], v[52:67]
    v_mfma_f32_32x32x16_bf16 v[36:51], v[120:123], v[124:127], v[36:51]
    s_add_u32 s15, s9, 110592
    buffer_load_dwordx4 v[120:123], v3, s[48:51], s15 offen offset:0 sc1
    s_add_u32 s15, s19, 0
    buffer_load_dwordx4 v[124:127], v3, s[36:39], s15 offen offset:0 sc1
    s_add_u32 s15, s19, 110592
    buffer_load_dwordx4 v[128:131], v3, s[36:39], s15 offen offset:0 sc1
    v_mfma_f32_32x32x16_bf16 v[4:19], v[132:135], v[140:143], v[4:19]
    v_mfma_f32_32x32x16_bf16 v[20:35], v[132:135], v[144:147], v[20:35]
    s_add_u32 s15, s9, 0
    buffer_load_dwordx4 v[132:135], v3, s[48:51], s15 offen offset:1024 sc1
    v_mfma_f32_32x32x16_bf16 v[52:67], v[136:139], v[144:147], v[52:67]
    v_mfma_f32_32x32x16_bf16 v[36:51], v[136:139], v[140:143], v[36:51]
    s_add_u32 s15, s9, 110592
    buffer_load_dwordx4 v[136:139], v3, s[48:51], s15 offen offset:1024 sc1
    s_add_u32 s15, s19, 0
    buffer_load_dwordx4 v[140:143], v3, s[36:39], s15 offen offset:1024 sc1
    s_add_u32 s15, s19, 110592
    buffer_load_dwordx4 v[144:147], v3, s[36:39], s15 offen offset:1024 sc1
    s_waitcnt vmcnt(8)
    v_mfma_f32_32x32x16_bf16 v[4:19], v[100:103], v[108:111], v[4:19]
    v_mfma_f32_32x32x16_bf16 v[20:35], v[100:103], v[112:115], v[20:35]
    s_add_u32 s15, s9, 0
    buffer_load_dwordx4 v[100:103], v3, s[48:51], s15 offen offset:2048 sc1
    v_mfma_f32_32x32x16_bf16 v[52:67], v[104:107], v[112:115], v[52:67]
    v_mfma_f32_32x32x16_bf16 v[36:51], v[104:107], v[108:111], v[36:51]
    s_add_u32 s15, s9, 110592
    buffer_load_dwordx4 v[104:107], v3, s[48:51], s15 offen offset:2048 sc1
    s_add_u32 s15, s19, 0
    buffer_load_dwordx4 v[108:111], v3, s[36:39], s15 offen offset:2048 sc1
    s_add_u32 s15, s19, 110592
    buffer_load_dwordx4 v[112:115], v3, s[36:39], s15 offen offset:2048 sc1
    s_barrier
    s_waitcnt vmcnt(8)
    v_mfma_f32_32x32x16_bf16 v[4:19], v[116:119], v[124:127], v[4:19]
    v_mfma_f32_32x32x16_bf16 v[20:35], v[116:119], v[128:131], v[20:35]
    s_add_u32 s15, s9, 0
    buffer_load_dwordx4 v[116:119], v3, s[48:51], s15 offen offset:3072 sc1
    v_mfma_f32_32x32x16_bf16 v[52:67], v[120:123], v[128:131], v[52:67]
    v_mfma_f32_32x32x16_bf16 v[36:51], v[120:123], v[124:127], v[36:51]
    s_add_u32 s15, s9, 110592
    buffer_load_dwordx4 v[120:123], v3, s[48:51], s15 offen offset:3072 sc1
    s_add_u32 s15, s19, 0
    buffer_load_dwordx4 v[124:127], v3, s[36:39], s15 offen offset:3072 sc1
    s_add_u32 s15, s19, 110592
    buffer_load_dwordx4 v[128:131], v3, s[36:39], s15 offen offset:3072 sc1
    s_waitcnt vmcnt(8)
    v_mfma_f32_32x32x16_bf16 v[4:19], v[132:135], v[140:143], v[4:19]
    v_mfma_f32_32x32x16_bf16 v[20:35], v[132:135], v[144:147], v[20:35]
    s_add_u32 s15, s9, 4096
    buffer_load_dwordx4 v[132:135], v3, s[48:51], s15 offen offset:0 sc1
    v_mfma_f32_32x32x16_bf16 v[52:67], v[136:139], v[144:147], v[52:67]
    v_mfma_f32_32x32x16_bf16 v[36:51], v[136:139], v[140:143], v[36:51]
    s_add_u32 s15, s9, 114688
    buffer_load_dwordx4 v[136:139], v3, s[48:51], s15 offen offset:0 sc1
    s_add_u32 s15, s19, 4096
    buffer_load_dwordx4 v[140:143], v3, s[36:39], s15 offen offset:0 sc1
    s_add_u32 s15, s19, 114688
    buffer_load_dwordx4 v[144:147], v3, s[36:39], s15 offen offset:0 sc1
    s_waitcnt vmcnt(8)
    v_mfma_f32_32x32x16_bf16 v[4:19], v[100:103], v[108:111], v[4:19]
    v_mfma_f32_32x32x16_bf16 v[20:35], v[100:103], v[112:115], v[20:35]
    s_add_u32 s15, s9, 4096
    buffer_load_dwordx4 v[100:103], v3, s[48:51], s15 offen offset:1024 sc1
    v_mfma_f32_32x32x16_bf16 v[52:67], v[104:107], v[112:115], v[52:67]
    v_mfma_f32_32x32x16_bf16 v[36:51], v[104:107], v[108:111], v[36:51]
    s_add_u32 s15, s9, 114688
    buffer_load_dwordx4 v[104:107], v3, s[48:51], s15 offen offset:1024 sc1
    s_add_u32 s15, s19, 4096
    buffer_load_dwordx4 v[108:111], v3, s[36:39], s15 offen offset:1024 sc1
    s_add_u32 s15, s19, 114688
    buffer_load_dwordx4 v[112:115], v3, s[36:39], s15 offen offset:1024 sc1
    s_waitcnt vmcnt(8)
    v_mfma_f32_32x32x16_bf16 v[4:19], v[116:119], v[124:127], v[4:19]
    v_mfma_f32_32x32x16_bf16 v[20:35], v[116:119], v[128:131], v[20:35]
    s_add_u32 s15, s9, 4096
    buffer_load_dwordx4 v[116:119], v3, s[48:51], s15 offen offset:2048 sc1
    v_mfma_f32_32x32x16_bf16 v[52:67], v[120:123], v[128:131], v[52:67]
    v_mfma_f32_32x32x16_bf16 v[36:51], v[120:123], v[124:127], v[36:51]
    s_add_u32 s15, s9, 114688
    buffer_load_dwordx4 v[120:123], v3, s[48:51], s15 offen offset:2048 sc1
    s_add_u32 s15, s19, 4096
    buffer_load_dwordx4 v[124:127], v3, s[36:39], s15 offen offset:2048 sc1
    s_add_u32 s15, s19, 114688
    buffer_load_dwordx4 v[128:131], v3, s[36:39], s15 offen offset:2048 sc1
    s_barrier
    s_waitcnt vmcnt(8)
    v_mfma_f32_32x32x16_bf16 v[4:19], v[132:135], v[140:143], v[4:19]
    v_mfma_f32_32x32x16_bf16 v[20:35], v[132:135], v[144:147], v[20:35]
    s_add_u32 s15, s9, 4096
    buffer_load_dwordx4 v[132:135], v3, s[48:51], s15 offen offset:3072 sc1
    v_mfma_f32_32x32x16_bf16 v[52:67], v[136:139], v[144:147], v[52:67]
    v_mfma_f32_32x32x16_bf16 v[36:51], v[136:139], v[140:143], v[36:51]
    s_add_u32 s15, s9, 114688
    buffer_load_dwordx4 v[136:139], v3, s[48:51], s15 offen offset:3072 sc1
    s_add_u32 s15, s19, 4096
    buffer_load_dwordx4 v[140:143], v3, s[36:39], s15 offen offset:3072 sc1
    s_add_u32 s15, s19, 114688
    buffer_load_dwordx4 v[144:147], v3, s[36:39], s15 offen offset:3072 sc1
    s_waitcnt vmcnt(8)
    v_mfma_f32_32x32x16_bf16 v[4:19], v[100:103], v[108:111], v[4:19]
    v_mfma_f32_32x32x16_bf16 v[20:35], v[100:103], v[112:115], v[20:35]
    s_add_u32 s15, s9, 8192
    buffer_load_dwordx4 v[100:103], v3, s[48:51], s15 offen offset:0 sc1
    v_mfma_f32_32x32x16_bf16 v[52:67], v[104:107], v[112:115], v[52:67]
    v_mfma_f32_32x32x16_bf16 v[36:51], v[104:107], v[108:111], v[36:51]
    s_add_u32 s15, s9, 118784
    buffer_load_dwordx4 v[104:107], v3, s[48:51], s15 offen offset:0 sc1
    s_add_u32 s15, s19, 8192
    buffer_load_dwordx4 v[108:111], v3, s[36:39], s15 offen offset:0 sc1
    s_add_u32 s15, s19, 118784
    buffer_load_dwordx4 v[112:115], v3, s[36:39], s15 offen offset:0 sc1
    s_waitcnt vmcnt(8)
    v_mfma_f32_32x32x16_bf16 v[4:19], v[116:119], v[124:127], v[4:19]
    v_mfma_f32_32x32x16_bf16 v[20:35], v[116:119], v[128:131], v[20:35]
    s_add_u32 s15, s9, 8192
    buffer_load_dwordx4 v[116:119], v3, s[48:51], s15 offen offset:1024 sc1
    v_mfma_f32_32x32x16_bf16 v[52:67], v[120:123], v[128:131], v[52:67]
    v_mfma_f32_32x32x16_bf16 v[36:51], v[120:123], v[124:127], v[36:51]
    s_add_u32 s15, s9, 118784
    buffer_load_dwordx4 v[120:123], v3, s[48:51], s15 offen offset:1024 sc1
    s_add_u32 s15, s19, 8192
    buffer_load_dwordx4 v[124:127], v3, s[36:39], s15 offen offset:1024 sc1
    s_add_u32 s15, s19, 118784
    buffer_load_dwordx4 v[128:131], v3, s[36:39], s15 offen offset:1024 sc1
    s_waitcnt vmcnt(8)
    v_mfma_f32_32x32x16_bf16 v[4:19], v[132:135], v[140:143], v[4:19]
    v_mfma_f32_32x32x16_bf16 v[20:35], v[132:135], v[144:147], v[20:35]
    s_add_u32 s15, s9, 8192
    buffer_load_dwordx4 v[132:135], v3, s[48:51], s15 offen offset:2048 sc1
    v_mfma_f32_32x32x16_bf16 v[52:67], v[136:139], v[144:147], v[52:67]
    v_mfma_f32_32x32x16_bf16 v[36:51], v[136:139], v[140:143], v[36:51]
    s_add_u32 s15, s9, 118784
    buffer_load_dwordx4 v[136:139], v3, s[48:51], s15 offen offset:2048 sc1
    s_add_u32 s15, s19, 8192
    buffer_load_dwordx4 v[140:143], v3, s[36:39], s15 offen offset:2048 sc1
    s_add_u32 s15, s19, 118784
    buffer_load_dwordx4 v[144:147], v3, s[36:39], s15 offen offset:2048 sc1
    s_waitcnt vmcnt(8)
    v_mfma_f32_32x32x16_bf16 v[4:19], v[100:103], v[108:111], v[4:19]
    v_mfma_f32_32x32x16_bf16 v[20:35], v[100:103], v[112:115], v[20:35]
    v_mfma_f32_32x32x16_bf16 v[52:67], v[104:107], v[112:115], v[52:67]
    v_mfma_f32_32x32x16_bf16 v[36:51], v[104:107], v[108:111], v[36:51]
    s_waitcnt vmcnt(4)
    v_mfma_f32_32x32x16_bf16 v[4:19], v[116:119], v[124:127], v[4:19]
    v_mfma_f32_32x32x16_bf16 v[20:35], v[116:119], v[128:131], v[20:35]
    v_mfma_f32_32x32x16_bf16 v[52:67], v[120:123], v[128:131], v[52:67]
    v_mfma_f32_32x32x16_bf16 v[36:51], v[120:123], v[124:127], v[36:51]
    s_waitcnt vmcnt(0)
    v_mfma_f32_32x32x16_bf16 v[4:19], v[132:135], v[140:143], v[4:19]
    v_mfma_f32_32x32x16_bf16 v[20:35], v[132:135], v[144:147], v[20:35]
    v_mfma_f32_32x32x16_bf16 v[52:67], v[136:139], v[144:147], v[52:67]
    v_mfma_f32_32x32x16_bf16 v[36:51], v[136:139], v[140:143], v[36:51]
    s_add_u32 s52, s20, 12582912
    s_addc_u32 s53, s21, 0
    s_mov_b32 s54, 819200
    s_mov_b32 s55, 0x20000
    s_add_u32 s56, s20, 13631488
    s_addc_u32 s57, s21, 0
    s_mov_b32 s58, 2621440
    s_mov_b32 s59, 0x20000
    s_mul_i32 s80, s3, 43
    s_lshr_b32 s80, s80, 7
    s_mul_i32 s81, s80, 3
    s_sub_u32 s81, s3, s81
    s_lshr_b32 s82, s4, 1
    s_mul_i32 s82, s82, 5
    s_and_b32 s83, s4, 1
    s_mul_i32 s84, s83, 3
    s_add_u32 s82, s82, s84
    s_add_u32 s82, s82, s81
    s_mul_i32 s84, s82, 40960
    s_mul_i32 s82, s80, 10240
    s_add_u32 s84, s84, s82
    s_lshl_b32 s86, s80, 0
    s_mul_i32 s86, s80, 10240
    s_cmp_eq_u32 s81, 2
    s_cselect_b32 s85, s83, 0
    s_xor_b32 s85, s85, 1
    s_add_u32 s80, s3, 0
    s_mul_i32 s81, s80, 52429
    s_lshr_b32 s81, s81, 18
    s_mul_i32 s82, s81, 5
    s_sub_u32 s82, s80, s82
    s_mul_i32 s81, s81, 10240
    s_lshl_b32 s82, s82, 10
    s_add_u32 s92, s81, s82
    s_add_u32 s80, s3, 12
    s_mul_i32 s81, s80, 52429
    s_lshr_b32 s81, s81, 18
    s_mul_i32 s82, s81, 5
    s_sub_u32 s82, s80, s82
    s_mul_i32 s81, s81, 10240
    s_lshl_b32 s82, s82, 10
    s_add_u32 s93, s81, s82
    s_add_u32 s80, s3, 24
    s_mul_i32 s81, s80, 52429
    s_lshr_b32 s81, s81, 18
    s_mul_i32 s82, s81, 5
    s_sub_u32 s82, s80, s82
    s_mul_i32 s81, s81, 10240
    s_lshl_b32 s82, s82, 10
    s_add_u32 s94, s81, s82
    s_add_u32 s80, s3, 36
    s_mul_i32 s81, s80, 52429
    s_lshr_b32 s81, s81, 18
    s_mul_i32 s82, s81, 5
    s_sub_u32 s82, s80, s82
    s_mul_i32 s81, s81, 10240
    s_lshl_b32 s82, s82, 10
    s_add_u32 s95, s81, s82
    s_mul_i32 s97, s5, 81920
    s_mov_b32 s44, s22
    s_mov_b32 s45, s23
    s_mov_b32 s46, 2621440
    s_mov_b32 s47, 0x20000
    v_and_b32 v166, 31, v0
    s_lshl_b32 s13, s5, 6
    v_add_u32 v166, s13, v166
    v_mul_u32_u24 v166, 1280, v166
    v_lshrrev_b32 v161, 5, v0
    v_lshl_add_u32 v166, v161, 3, v166
    s_lshl_b32 s13, s12, 6
    s_lshl_b32 s15, s6, 4
    s_add_u32 s13, s13, s15
    v_add_u32 v166, s13, v166
    s_mov_b32 s15, 0
    buffer_load_dwordx2 v[124:125], v166, s[44:47], s15 offen
    s_mov_b32 s15, 40960
    buffer_load_dwordx2 v[126:127], v166, s[44:47], s15 offen
    s_mov_b32 s15, 64
    buffer_load_dwordx2 v[128:129], v166, s[44:47], s15 offen
    s_mov_b32 s15, 41024
    buffer_load_dwordx2 v[130:131], v166, s[44:47], s15 offen
    s_mul_i32 s13, s6, 18432
    v_add_u32 v164, s13, v3
    s_cmp_lg_u32 s6, 0
    s_cbranch_scc1 rw_91
    s_nop 15
    ds_write_b128 v164, v[8:11] offset:0
    ds_write_b128 v164, v[12:15] offset:1024
    ds_write_b128 v164, v[16:19] offset:2048
    ds_write_b128 v164, v[24:27] offset:3072
    ds_write_b128 v164, v[28:31] offset:4096
    ds_write_b128 v164, v[32:35] offset:5120
    ds_write_b128 v164, v[40:43] offset:6144
    ds_write_b128 v164, v[44:47] offset:7168
    ds_write_b128 v164, v[48:51] offset:8192
    ds_write_b128 v164, v[56:59] offset:9216
    ds_write_b128 v164, v[60:63] offset:10240
    ds_write_b128 v164, v[64:67] offset:11264
    v_mov_b32 v100, v4
    v_mov_b32 v101, v5
    v_mov_b32 v102, v6
    v_mov_b32 v103, v7
    v_mov_b32 v104, v20
    v_mov_b32 v105, v21
    v_mov_b32 v106, v22
    v_mov_b32 v107, v23
    v_mov_b32 v108, v36
    v_mov_b32 v109, v37
    v_mov_b32 v110, v38
    v_mov_b32 v111, v39
    v_mov_b32 v112, v52
    v_mov_b32 v113, v53
    v_mov_b32 v114, v54
    v_mov_b32 v115, v55
    s_branch rw_done_90
rw_91:
    s_cmp_lg_u32 s6, 1
    s_cbranch_scc1 rw_92
    s_nop 15
    ds_write_b128 v164, v[4:7] offset:2048
    ds_write_b128 v164, v[12:15] offset:0
    ds_write_b128 v164, v[16:19] offset:1024
    ds_write_b128 v164, v[20:23] offset:5120
    ds_write_b128 v164, v[28:31] offset:3072
    ds_write_b128 v164, v[32:35] offset:4096
    ds_write_b128 v164, v[36:39] offset:8192
    ds_write_b128 v164, v[44:47] offset:6144
    ds_write_b128 v164, v[48:51] offset:7168
    ds_write_b128 v164, v[52:55] offset:11264
    ds_write_b128 v164, v[60:63] offset:9216
    ds_write_b128 v164, v[64:67] offset:10240
    v_mov_b32 v100, v8
    v_mov_b32 v101, v9
    v_mov_b32 v102, v10
    v_mov_b32 v103, v11
    v_mov_b32 v104, v24
    v_mov_b32 v105, v25
    v_mov_b32 v106, v26
    v_mov_b32 v107, v27
    v_mov_b32 v108, v40
    v_mov_b32 v109, v41
    v_mov_b32 v110, v42
    v_mov_b32 v111, v43
    v_mov_b32 v112, v56
    v_mov_b32 v113, v57
    v_mov_b32 v114, v58
    v_mov_b32 v115, v59
    s_branch rw_done_90
rw_92:
    s_cmp_lg_u32 s6, 2
    s_cbranch_scc1 rw_93
    s_nop 15
    ds_write_b128 v164, v[4:7] offset:1024
    ds_write_b128 v164, v[8:11] offset:2048
    ds_write_b128 v164, v[16:19] offset:0
    ds_write_b128 v164, v[20:23] offset:4096
    ds_write_b128 v164, v[24:27] offset:5120
    ds_write_b128 v164, v[32:35] offset:3072
    ds_write_b128 v164, v[36:39] offset:7168
    ds_write_b128 v164, v[40:43] offset:8192
    ds_write_b128 v164, v[48:51] offset:6144
    ds_write_b128 v164, v[52:55] offset:10240
    ds_write_b128 v164, v[56:59] offset:11264
    ds_write_b128 v164, v[64:67] offset:9216
    v_mov_b32 v100, v12
    v_mov_b32 v101, v13
    v_mov_b32 v102, v14
    v_mov_b32 v103, v15
    v_mov_b32 v104, v28
    v_mov_b32 v105, v29
    v_mov_b32 v106, v30
    v_mov_b32 v107, v31
    v_mov_b32 v108, v44
    v_mov_b32 v109, v45
    v_mov_b32 v110, v46
    v_mov_b32 v111, v47
    v_mov_b32 v112, v60
    v_mov_b32 v113, v61
    v_mov_b32 v114, v62
    v_mov_b32 v115, v63
    s_branch rw_done_90
rw_93:
    s_nop 15
    ds_write_b128 v164, v[4:7] offset:0
    ds_write_b128 v164, v[8:11] offset:1024
    ds_write_b128 v164, v[12:15] offset:2048
    ds_write_b128 v164, v[20:23] offset:3072
    ds_write_b128 v164, v[24:27] offset:4096
    ds_write_b128 v164, v[28:31] offset:5120
    ds_write_b128 v164, v[36:39] offset:6144
    ds_write_b128 v164, v[40:43] offset:7168
    ds_write_b128 v164, v[44:47] offset:8192
    ds_write_b128 v164, v[52:55] offset:9216
    ds_write_b128 v164, v[56:59] offset:10240
    ds_write_b128 v164, v[60:63] offset:11264
    v_mov_b32 v100, v16
    v_mov_b32 v101, v17
    v_mov_b32 v102, v18
    v_mov_b32 v103, v19
    v_mov_b32 v104, v32
    v_mov_b32 v105, v33
    v_mov_b32 v106, v34
    v_mov_b32 v107, v35
    v_mov_b32 v108, v48
    v_mov_b32 v109, v49
    v_mov_b32 v110, v50
    v_mov_b32 v111, v51
    v_mov_b32 v112, v64
    v_mov_b32 v113, v65
    v_mov_b32 v114, v66
    v_mov_b32 v115, v67
rw_done_90:
    s_waitcnt lgkmcnt(0)
    s_barrier
    s_add_u32 s80, s92, 0
    s_add_u32 m0, s80, 73728
    s_add_u32 s80, s80, s97
    buffer_load_dwordx4 v3, s[56:59], s80 offen sc1 lds
    s_add_u32 s80, s93, 0
    s_add_u32 m0, s80, 73728
    s_add_u32 s80, s80, s97
    buffer_load_dwordx4 v3, s[56:59], s80 offen sc1 lds
    s_add_u32 s80, s94, 0
    s_add_u32 m0, s80, 73728
    s_add_u32 s80, s80, s97
    buffer_load_dwordx4 v3, s[56:59], s80 offen sc1 lds
    s_cmp_ge_u32 s3, 4
    s_cbranch_scc1 t_no4_95
    s_add_u32 s80, s95, 0
    s_add_u32 m0, s80, 73728
    s_add_u32 s80, s80, s97
    buffer_load_dwordx4 v3, s[56:59], s80 offen sc1 lds
t_no4_95:
    s_add_u32 s80, s92, 5120
    s_add_u32 m0, s80, 73728
    s_add_u32 s80, s80, s97
    buffer_load_dwordx4 v3, s[56:59], s80 offen sc1 lds
    s_add_u32 s80, s93, 5120
    s_add_u32 m0, s80, 73728
    s_add_u32 s80, s80, s97
    buffer_load_dwordx4 v3, s[56:59], s80 offen sc1 lds
    s_add_u32 s80, s94, 5120
    s_add_u32 m0, s80, 73728
    s_add_u32 s80, s80, s97
    buffer_load_dwordx4 v3, s[56:59], s80 offen sc1 lds
    s_cmp_ge_u32 s3, 4
    s_cbranch_scc1 t_no4_96
    s_add_u32 s80, s95, 5120
    s_add_u32 m0, s80, 73728
    s_add_u32 s80, s80, s97
    buffer_load_dwordx4 v3, s[56:59], s80 offen sc1 lds
t_no4_96:
    s_add_u32 s13, s6, 1
    s_and_b32 s13, s13, 3
    s_mul_i32 s13, s13, 18432
    v_add_u32 v165, s13, v3
    ds_read_b128 v[4:7], v165 offset:2048
    ds_read_b128 v[8:11], v165 offset:5120
    ds_read_b128 v[12:15], v165 offset:8192
    ds_read_b128 v[16:19], v165 offset:11264
    s_add_u32 s13, s6, 2
    s_and_b32 s13, s13, 3
    s_mul_i32 s13, s13, 18432
    v_add_u32 v165, s13, v3
    ds_read_b128 v[28:31], v165 offset:1024
    ds_read_b128 v[32:35], v165 offset:4096
    ds_read_b128 v[36:39], v165 offset:7168
    ds_read_b128 v[40:43], v165 offset:10240
    s_add_u32 s13, s6, 3
    s_and_b32 s13, s13, 3
    s_mul_i32 s13, s13, 18432
    v_add_u32 v165, s13, v3
    ds_read_b128 v[52:55], v165 offset:0
    ds_read_b128 v[56:59], v165 offset:3072
    ds_read_b128 v[60:63], v165 offset:6144
    ds_read_b128 v[64:67], v165 offset:9216
    s_mov_b32 s8, 0x3f317218
    s_waitcnt vmcnt(6) lgkmcnt(0)
    v_add_f32 v100, v100, v4
    v_add_f32 v101, v101, v5
    v_add_f32 v102, v102, v6
    v_add_f32 v103, v103, v7
    v_add_f32 v100, v100, v28
    v_add_f32 v101, v101, v29
    v_add_f32 v102, v102, v30
    v_add_f32 v103, v103, v31
    v_add_f32 v100, v100, v52
    v_add_f32 v101, v101, v53
    v_add_f32 v102, v102, v54
    v_add_f32 v103, v103, v55
    v_lshlrev_b32 v76, 16, v124
    v_and_b32 v77, 0xffff0000, v124
    v_lshlrev_b32 v78, 16, v125
    v_and_b32 v79, 0xffff0000, v125
    v_fma_f32 v100, v100, s8, v76
    v_fma_f32 v101, v101, s8, v77
    v_fma_f32 v102, v102, s8, v78
    v_fma_f32 v103, v103, s8, v79
    v_add_f32 v104, v104, v8
    v_add_f32 v105, v105, v9
    v_add_f32 v106, v106, v10
    v_add_f32 v107, v107, v11
    v_add_f32 v104, v104, v32
    v_add_f32 v105, v105, v33
    v_add_f32 v106, v106, v34
    v_add_f32 v107, v107, v35
    v_add_f32 v104, v104, v56
    v_add_f32 v105, v105, v57
    v_add_f32 v106, v106, v58
    v_add_f32 v107, v107, v59
    v_lshlrev_b32 v76, 16, v126
    v_and_b32 v77, 0xffff0000, v126
    v_lshlrev_b32 v78, 16, v127
    v_and_b32 v79, 0xffff0000, v127
    v_fma_f32 v104, v104, s8, v76
    v_fma_f32 v105, v105, s8, v77
    v_fma_f32 v106, v106, s8, v78
    v_fma_f32 v107, v107, s8, v79
    v_add_f32 v108, v108, v12
    v_add_f32 v109, v109, v13
    v_add_f32 v110, v110, v14
    v_add_f32 v111, v111, v15
    v_add_f32 v108, v108, v36
    v_add_f32 v109, v109, v37
    v_add_f32 v110, v110, v38
    v_add_f32 v111, v111, v39
    v_add_f32 v108, v108, v60
    v_add_f32 v109, v109, v61
    v_add_f32 v110, v110, v62
    v_add_f32 v111, v111, v63
    v_lshlrev_b32 v76, 16, v128
    v_and_b32 v77, 0xffff0000, v128
    v_lshlrev_b32 v78, 16, v129
    v_and_b32 v79, 0xffff0000, v129
    v_fma_f32 v108, v108, s8, v76
    v_fma_f32 v109, v109, s8, v77
    v_fma_f32 v110, v110, s8, v78
    v_fma_f32 v111, v111, s8, v79
    v_add_f32 v112, v112, v16
    v_add_f32 v113, v113, v17
    v_add_f32 v114, v114, v18
    v_add_f32 v115, v115, v19
    v_add_f32 v112, v112, v40
    v_add_f32 v113, v113, v41
    v_add_f32 v114, v114, v42
    v_add_f32 v115, v115, v43
    v_add_f32 v112, v112, v64
    v_add_f32 v113, v113, v65
    v_add_f32 v114, v114, v66
    v_add_f32 v115, v115, v67
    v_lshlrev_b32 v76, 16, v130
    v_and_b32 v77, 0xffff0000, v130
    v_lshlrev_b32 v78, 16, v131
    v_and_b32 v79, 0xffff0000, v131
    v_fma_f32 v112, v112, s8, v76
    v_fma_f32 v113, v113, s8, v77
    v_fma_f32 v114, v114, s8, v78
    v_fma_f32 v115, v115, s8, v79
    s_add_u32 s80, s84, 0
    buffer_load_dwordx4 v[4:7], v3, s[52:55], s80 offen offset:0 sc1
    s_add_u32 s80, s84, 0
    buffer_load_dwordx4 v[8:11], v3, s[52:55], s80 offen offset:1024 sc1
    s_add_u32 s80, s84, 0
    buffer_load_dwordx4 v[12:15], v3, s[52:55], s80 offen offset:2048 sc1
    s_add_u32 s80, s84, 0
    buffer_load_dwordx4 v[16:19], v3, s[52:55], s80 offen offset:3072 sc1
    s_add_u32 s80, s84, 4096
    buffer_load_dwordx4 v[20:23], v3, s[52:55], s80 offen offset:0 sc1
    s_add_u32 s80, s84, 4096
    buffer_load_dwordx4 v[24:27], v3, s[52:55], s80 offen offset:1024 sc1
    s_add_u32 s80, s84, 4096
    buffer_load_dwordx4 v[28:31], v3, s[52:55], s80 offen offset:2048 sc1
    s_add_u32 s80, s84, 4096
    buffer_load_dwordx4 v[32:35], v3, s[52:55], s80 offen offset:3072 sc1
    s_add_u32 s80, s84, 8192
    buffer_load_dwordx4 v[36:39], v3, s[52:55], s80 offen offset:0 sc1
    s_add_u32 s80, s84, 8192
    buffer_load_dwordx4 v[40:43], v3, s[52:55], s80 offen offset:1024 sc1
    s_waitcnt vmcnt(13)
    s_add_u32 s80, s86, 73728
    v_add_u32 v1, s80, v3
    v_add_u32 v2, 40960, v1
    s_barrier
    s_cmp_eq_u32 s85, 0
    s_cbranch_scc1 t_skip_97
    s_waitcnt vmcnt(5)
    ds_read_b128 v[124:127], v1 offset:0
    ds_read_b128 v[128:131], v2 offset:0
    ds_read_b128 v[132:135], v1 offset:1024
    ds_read_b128 v[136:139], v2 offset:1024
    ds_read_b128 v[140:143], v1 offset:2048
    ds_read_b128 v[144:147], v2 offset:2048
    ds_read_b128 v[148:151], v1 offset:3072
    ds_read_b128 v[152:155], v2 offset:3072
    s_waitcnt lgkmcnt(6)
    v_mfma_f32_32x32x16_bf16 v[44:59], v[4:7], v[124:127], 0
    v_mfma_f32_32x32x16_bf16 v[60:75], v[4:7], v[128:131], 0
    ds_read_b128 v[124:127], v1 offset:4096
    ds_read_b128 v[128:131], v2 offset:4096
    s_waitcnt lgkmcnt(6)
    v_mfma_f32_32x32x16_bf16 v[44:59], v[8:11], v[132:135], v[44:59]
    v_mfma_f32_32x32x16_bf16 v[60:75], v[8:11], v[136:139], v[60:75]
    s_waitcnt lgkmcnt(4)
    v_mfma_f32_32x32x16_bf16 v[44:59], v[12:15], v[140:143], v[44:59]
    v_mfma_f32_32x32x16_bf16 v[60:75], v[12:15], v[144:147], v[60:75]
    s_waitcnt lgkmcnt(2)
    v_mfma_f32_32x32x16_bf16 v[44:59], v[16:19], v[148:151], v[44:59]
    v_mfma_f32_32x32x16_bf16 v[60:75], v[16:19], v[152:155], v[60:75]
    s_waitcnt lgkmcnt(0)
    v_mfma_f32_32x32x16_bf16 v[44:59], v[20:23], v[124:127], v[44:59]
    v_mfma_f32_32x32x16_bf16 v[60:75], v[20:23], v[128:131], v[60:75]
    s_waitcnt vmcnt(0)
    s_barrier
    ds_read_b128 v[132:135], v1 offset:5120
    ds_read_b128 v[136:139], v2 offset:5120
    ds_read_b128 v[140:143], v1 offset:6144
    ds_read_b128 v[144:147], v2 offset:6144
    ds_read_b128 v[148:151], v1 offset:7168
    ds_read_b128 v[152:155], v2 offset:7168
    ds_read_b128 v[124:127], v1 offset:8192
    ds_read_b128 v[128:131], v2 offset:8192
    s_waitcnt lgkmcnt(6)
    v_mfma_f32_32x32x16_bf16 v[44:59], v[24:27], v[132:135], v[44:59]
    v_mfma_f32_32x32x16_bf16 v[60:75], v[24:27], v[136:139], v[60:75]
    ds_read_b128 v[132:135], v1 offset:9216
    ds_read_b128 v[136:139], v2 offset:9216
    s_waitcnt lgkmcnt(6)
    v_mfma_f32_32x32x16_bf16 v[44:59], v[28:31], v[140:143], v[44:59]
    v_mfma_f32_32x32x16_bf16 v[60:75], v[28:31], v[144:147], v[60:75]
    s_waitcnt lgkmcnt(4)
    v_mfma_f32_32x32x16_bf16 v[44:59], v[32:35], v[148:151], v[44:59]
    v_mfma_f32_32x32x16_bf16 v[60:75], v[32:35], v[152:155], v[60:75]
    s_waitcnt lgkmcnt(2)
    v_mfma_f32_32x32x16_bf16 v[44:59], v[36:39], v[124:127], v[44:59]
    v_mfma_f32_32x32x16_bf16 v[60:75], v[36:39], v[128:131], v[60:75]
    s_waitcnt lgkmcnt(0)
    v_mfma_f32_32x32x16_bf16 v[44:59], v[40:43], v[132:135], v[44:59]
    v_mfma_f32_32x32x16_bf16 v[60:75], v[40:43], v[136:139], v[60:75]
    s_barrier
    s_lshl_b32 s80, s3, 13
    v_add_u32 v1, s80, v3
    s_nop 7
    ds_write_b128 v1, v[44:47] offset:0
    ds_write_b128 v1, v[48:51] offset:1024
    ds_write_b128 v1, v[52:55] offset:2048
    ds_write_b128 v1, v[56:59] offset:3072
    ds_write_b128 v1, v[60:63] offset:4096
    ds_write_b128 v1, v[64:67] offset:5120
    ds_write_b128 v1, v[68:71] offset:6144
    ds_write_b128 v1, v[72:75] offset:7168
    s_waitcnt lgkmcnt(0)
    s_branch t_done_98
t_skip_97:
    s_waitcnt vmcnt(0)
    s_barrier
    s_barrier
t_done_98:
    s_barrier
    s_mov_b32 s44, s88
    s_mov_b32 s45, s89
    s_mov_b32 s46, 2621440
    s_mov_b32 s47, 0x20000
    s_lshl_b32 s13, s6, 10
    v_add_u32 v1, s13, v3
    v_add_u32 v2, 49152, v1
    ds_read_b128 v[4:7], v1 offset:0
    ds_read_b128 v[8:11], v1 offset:24576
    ds_read_b128 v[12:15], v2 offset:0
    ds_read_b128 v[16:19], v2 offset:24576
    ds_read_b128 v[20:23], v1 offset:4096
    ds_read_b128 v[24:27], v1 offset:28672
    ds_read_b128 v[28:31], v2 offset:4096
    ds_read_b128 v[32:35], v2 offset:28672
    s_waitcnt lgkmcnt(0)
    ds_read_b128 v[36:39], v1 offset:8192
    ds_read_b128 v[40:43], v1 offset:32768
    ds_read_b128 v[44:47], v2 offset:8192
    ds_read_b128 v[48:51], v2 offset:32768
    ds_read_b128 v[52:55], v1 offset:12288
    ds_read_b128 v[56:59], v1 offset:36864
    ds_read_b128 v[60:63], v2 offset:12288
    ds_read_b128 v[64:67], v2 offset:36864
    s_waitcnt lgkmcnt(0)
    v_add_f32 v100, v100, v4
    v_add_f32 v101, v101, v5
    v_add_f32 v102, v102, v6
    v_add_f32 v103, v103, v7
    v_add_f32 v100, v100, v8
    v_add_f32 v101, v101, v9
    v_add_f32 v102, v102, v10
    v_add_f32 v103, v103, v11
    v_add_f32 v100, v100, v12
    v_add_f32 v101, v101, v13
    v_add_f32 v102, v102, v14
    v_add_f32 v103, v103, v15
    v_add_f32 v100, v100, v16
    v_add_f32 v101, v101, v17
    v_add_f32 v102, v102, v18
    v_add_f32 v103, v103, v19
    v_cvt_pk_bf16_f32 v100, v100, v101
    v_cvt_pk_bf16_f32 v101, v102, v103
    s_mov_b32 s15, 0
    buffer_store_dwordx2 v[100:101], v166, s[44:47], s15 offen
    v_add_f32 v104, v104, v20
    v_add_f32 v105, v105, v21
    v_add_f32 v106, v106, v22
    v_add_f32 v107, v107, v23
    v_add_f32 v104, v104, v24
    v_add_f32 v105, v105, v25
    v_add_f32 v106, v106, v26
    v_add_f32 v107, v107, v27
    v_add_f32 v104, v104, v28
    v_add_f32 v105, v105, v29
    v_add_f32 v106, v106, v30
    v_add_f32 v107, v107, v31
    v_add_f32 v104, v104, v32
    v_add_f32 v105, v105, v33
    v_add_f32 v106, v106, v34
    v_add_f32 v107, v107, v35
    v_cvt_pk_bf16_f32 v104, v104, v105
    v_cvt_pk_bf16_f32 v105, v106, v107
    s_mov_b32 s15, 40960
    buffer_store_dwordx2 v[104:105], v166, s[44:47], s15 offen
    v_add_f32 v108, v108, v36
    v_add_f32 v109, v109, v37
    v_add_f32 v110, v110, v38
    v_add_f32 v111, v111, v39
    v_add_f32 v108, v108, v40
    v_add_f32 v109, v109, v41
    v_add_f32 v110, v110, v42
    v_add_f32 v111, v111, v43
    v_add_f32 v108, v108, v44
    v_add_f32 v109, v109, v45
    v_add_f32 v110, v110, v46
    v_add_f32 v111, v111, v47
    v_add_f32 v108, v108, v48
    v_add_f32 v109, v109, v49
    v_add_f32 v110, v110, v50
    v_add_f32 v111, v111, v51
    v_cvt_pk_bf16_f32 v108, v108, v109
    v_cvt_pk_bf16_f32 v109, v110, v111
    s_mov_b32 s15, 64
    buffer_store_dwordx2 v[108:109], v166, s[44:47], s15 offen
    v_add_f32 v112, v112, v52
    v_add_f32 v113, v113, v53
    v_add_f32 v114, v114, v54
    v_add_f32 v115, v115, v55
    v_add_f32 v112, v112, v56
    v_add_f32 v113, v113, v57
    v_add_f32 v114, v114, v58
    v_add_f32 v115, v115, v59
    v_add_f32 v112, v112, v60
    v_add_f32 v113, v113, v61
    v_add_f32 v114, v114, v62
    v_add_f32 v115, v115, v63
    v_add_f32 v112, v112, v64
    v_add_f32 v113, v113, v65
    v_add_f32 v114, v114, v66
    v_add_f32 v115, v115, v67
    v_cvt_pk_bf16_f32 v112, v112, v113
    v_cvt_pk_bf16_f32 v113, v114, v115
    s_mov_b32 s15, 41024
    buffer_store_dwordx2 v[112:113], v166, s[44:47], s15 offen
    s_branch parallel_sum__grouped_kv_mqa__dense_activation_silu__prompt_kernel_end
parallel_sum__grouped_kv_mqa__dense_activation_silu__prompt_kernel_end:
    s_endpgm
.section .rodata,"a"
.p2align 6
.amdhsa_kernel parallel_sum__grouped_kv_mqa__dense_activation_silu__prompt_kernel
  .amdhsa_next_free_vgpr 168
  .amdhsa_next_free_sgpr 102
  .amdhsa_accum_offset 168
  .amdhsa_group_segment_fixed_size 0
  .amdhsa_kernarg_size 88
  .amdhsa_user_sgpr_count 2
  .amdhsa_user_sgpr_kernarg_segment_ptr 1
  .amdhsa_system_sgpr_workgroup_id_x 1
  .amdhsa_float_denorm_mode_32 3
.end_amdhsa_kernel
.text
```
